```python
import torch

def _softmax(x, axis=-1):
    return torch.softmax(x, dim=axis)
def _gelu(x):
    return torch.nn.functional.gelu(x, approximate="tanh")
def _silu(x):
    return torch.nn.functional.silu(x)
def _sigmoid(x):
    return torch.sigmoid(x)
def _layernorm(x, axis=-1, eps=1e-5):
    m = x.mean(dim=axis, keepdim=True)
    v = x.var(dim=axis, keepdim=True, unbiased=False)
    return (x - m) / torch.sqrt(v + eps)
def _scatter_add(tgt, idx, src, axis=0):
    return tgt.clone().index_add_(axis, idx, src)
def _segment_sum(src, seg, n):
    out = torch.zeros((n,) + src.shape[1:], dtype=src.dtype)
    return out.index_add_(0, seg, src)
def _pad(x, pw):
    flat = tuple(v for pair in reversed(pw) for v in pair)
    return torch.nn.functional.pad(x, flat)

kernel_name = 'recurrent_scan__ssm_conv_s5__swiglu_ffn__prompt'

def setup_inputs():

    _w = (lambda a: (lambda t: t.to(torch.bfloat16) if t.is_floating_point() else t)(torch.as_tensor(a)))
    def _A_setup():
        B, S, D = 1, 2048, 512
        P = D
        Lambda_re = -0.5 * (lambda _x: torch.exp(torch.as_tensor(_x)))((lambda *s: torch.randn(*s, dtype=torch.bfloat16) * 0.2)(P))
        Lambda_im = (lambda *s: torch.randn(*s, dtype=torch.bfloat16) * 0.4)(P) * 1.0
        B_re = (lambda *s: torch.randn(*s, dtype=torch.bfloat16) * 0.2)(P, D) * (D ** -0.5)
        B_im = (lambda *s: torch.randn(*s, dtype=torch.bfloat16) * 0.2)(P, D) * (D ** -0.5)
        C_re = (lambda *s: torch.randn(*s, dtype=torch.bfloat16) * 0.2)(D, P) * (P ** -0.5)
        C_im = (lambda *s: torch.randn(*s, dtype=torch.bfloat16) * 0.2)(D, P) * (P ** -0.5)
        log_dt = (lambda *s: torch.randn(*s, dtype=torch.bfloat16) * 0.2)(P) * 0.3 - 2.0
        Dskip = (lambda *s: torch.randn(*s, dtype=torch.bfloat16) * 0.05)(D)
        return {
            "x": _w((lambda *s: torch.randn(*s, dtype=torch.bfloat16) * 0.05)(B, S, D)),
            "Lambda_re": _w(Lambda_re),
            "Lambda_im": _w(Lambda_im),
            "B_re": _w(B_re),
            "B_im": _w(B_im),
            "C_re": _w(C_re),
            "C_im": _w(C_im),
            "log_dt": _w(log_dt),
            "Dskip": _w(Dskip),
        }
    _A_in = _A_setup()

    def _B_setup():
        B, S, D, F = 1, 2048, 512, 1792
        return {
            "x": _w((lambda *s: torch.randn(*s, dtype=torch.bfloat16) * 0.05)(B, S, D)),
            "w_gate": _w((lambda *s: torch.randn(*s, dtype=torch.bfloat16) * 0.05)(D, F)),
            "w_up": _w((lambda *s: torch.randn(*s, dtype=torch.bfloat16) * 0.05)(D, F)),
            "w_down": _w((lambda *s: torch.randn(*s, dtype=torch.bfloat16) * 0.05)(F, D)),
        }
    _B_in = _B_setup()

    return {
        "A_x": _A_in["x"],
        "A_Lambda_re": _A_in["Lambda_re"],
        "A_Lambda_im": _A_in["Lambda_im"],
        "A_B_re": _A_in["B_re"],
        "A_B_im": _A_in["B_im"],
        "A_C_re": _A_in["C_re"],
        "A_C_im": _A_in["C_im"],
        "A_log_dt": _A_in["log_dt"],
        "A_Dskip": _A_in["Dskip"],
        "B_x": _B_in["x"],
        "B_w_gate": _B_in["w_gate"],
        "B_w_up": _B_in["w_up"],
        "B_w_down": _B_in["w_down"],
    }

def reference(A_x, A_Lambda_re, A_Lambda_im, A_B_re, A_B_im, A_C_re, A_C_im, A_log_dt, A_Dskip, B_x, B_w_gate, B_w_up, B_w_down):
    def _A_ref(x, Lambda_re, Lambda_im, B_re, B_im, C_re, C_im, log_dt, Dskip):
        Bsz, L, H = x.shape
        Lam = Lambda_re + 1j * Lambda_im
        Bmat = B_re + 1j * B_im
        Cmat = C_re + 1j * C_im
        dt = torch.exp(log_dt)
        Lam_bar = torch.exp(dt * Lam)
        B_bar = ((Lam_bar - 1.0) / Lam)[:, None] * Bmat
        Bu = torch.einsum("bld,pd->blp", x + 0j, B_bar)
        h = torch.zeros_like(Bu[:, 0, :])
        hs = []
        for t in range(L):
            h = Lam_bar[None, :] * h + Bu[:, t, :]
            hs.append(h)
        hseq = torch.stack(hs, 1)
        y = 2.0 * torch.einsum("blp,dp->bld", hseq, Cmat).real + x * Dskip[None, None, :]
        return y

    def _B_ref(x, w_gate, w_up, w_down):
        g = _silu(x @ w_gate)
        u = x @ w_up
        return (g * u) @ w_down

    x = A_x
    xn = _layernorm(x, axis=-1)
    s = _A_ref(xn, A_Lambda_re, A_Lambda_im, A_B_re, A_B_im, A_C_re, A_C_im, A_log_dt, A_Dskip)
    g = _silu(_B_ref(xn, B_w_gate, B_w_up, B_w_down))
    return x + s * g
```

```asm
; @launch grid=(256,1,1) block=(512,1,1) lds=163840
.amdgcn_target "amdgcn-amd-amdhsa--gfx950"
.text
.globl recurrent_scan__ssm_conv_s5__swiglu_ffn__prompt_kernel
.p2align 8
.type recurrent_scan__ssm_conv_s5__swiglu_ffn__prompt_kernel,@function
recurrent_scan__ssm_conv_s5__swiglu_ffn__prompt_kernel:
    s_cmp_ge_u32 s2, 256
    s_cbranch_scc1 L_end
    s_load_dwordx16 s[8:23], s[0:1], 0
    s_load_dwordx16 s[24:39], s[0:1], 64
    v_lshrrev_b32 v1, 6, v0
    v_and_b32 v0, 63, v0
    v_readfirstlane_b32 s3, v1
    s_and_b32 s7, s2, 7
    s_lshr_b32 s4, s2, 3
    s_and_b32 s5, s7, 1
    s_lshr_b32 s6, s7, 1
    s_and_b32 s92, s3, 3
    s_lshr_b32 s93, s3, 2
    s_and_b32 s7, s4, 7
    s_lshr_b32 s4, s4, 3
    s_lshl_b32 s88, s5, 3
    s_add_u32 s88, s88, s7
    s_mul_i32 s89, s6, 3
    s_add_u32 s89, s89, s4
    s_add_u32 s3, s6, 12
    s_cmp_eq_u32 s4, 3
    s_cselect_b32 s89, s3, s89
    s_lshl_b32 s90, s6, 3
    s_add_u32 s90, s90, s7
    s_lshl_b32 s91, s5, 2
    s_add_u32 s91, s91, s4
    s_lshr_b32 s94, s90, 1
    s_lshr_b32 s101, s2, 3
    s_cmp_eq_u32 s93, 0
    s_cbranch_scc1 L_P0
    s_lshl_b32 s86, s92, 12
    s_lshl_b32 s87, s89, 7
    v_bfe_u32 v10, v0, 5, 1
    v_bfe_u32 v11, v0, 3, 2
    v_lshl_add_u32 v10, v10, 4, v11
    s_lshl_b32 s4, s88, 7
    s_lshl_b32 s5, s92, 5
    s_add_u32 s4, s4, s5
    v_add_u32 v10, s4, v10
    v_lshlrev_b32 v10, 10, v10
    v_and_b32 v11, 7, v0
    v_lshrrev_b32 v12, 4, v0
    v_xor_b32 v12, v11, v12
    v_lshl_add_u32 v24, v12, 4, v10
    v_xor_b32 v25, 64, v24
    v_add_u32 v25, 4096, v25
    v_add_u32 v26, 8192, v24
    v_add_u32 v27, 8192, v25
    v_lshrrev_b32 v10, 3, v0
    s_lshl_b32 s4, s92, 4
    v_add_u32 v10, s4, v10
    s_mov_b32 s5, 3584
    v_mul_lo_u32 v10, s5, v10
    v_bfe_u32 v12, v0, 4, 1
    v_lshlrev_b32 v12, 1, v12
    v_xor_b32 v12, v12, v11
    v_lshl_add_u32 v28, v12, 4, v10
    v_xor_b32 v29, 64, v28
    s_waitcnt lgkmcnt(0)
    s_mov_b32 s40, s8
    s_mov_b32 s41, s9
    s_mov_b32 s42, 0x200000
    s_mov_b32 s43, 0x20000
    s_mov_b32 s44, s28
    s_mov_b32 s45, s29
    s_mov_b32 s46, 0x1c0000
    s_mov_b32 s47, 0x20000
    s_mov_b32 s48, s30
    s_mov_b32 s49, s31
    s_mov_b32 s50, 0x1c0000
    s_mov_b32 s51, 0x20000
    s_mov_b32 s100, 0
    s_add_u32 m0, s86, 0x0
    s_nop 0
    buffer_load_dwordx4 v24, s[40:43], s100 offen lds
    s_add_u32 m0, s86, 0x400
    s_nop 0
    buffer_load_dwordx4 v25, s[40:43], s100 offen lds
    s_add_u32 m0, s86, 0x800
    s_nop 0
    buffer_load_dwordx4 v26, s[40:43], s100 offen lds
    s_add_u32 m0, s86, 0xc00
    s_nop 0
    buffer_load_dwordx4 v27, s[40:43], s100 offen lds
    s_add_u32 s100, s87, 0x0
    s_add_u32 m0, s86, 0x4000
    s_nop 0
    buffer_load_dwordx4 v28, s[44:47], s100 offen lds
    s_add_u32 m0, s86, 0x4400
    s_nop 0
    buffer_load_dwordx4 v29, s[48:51], s100 offen lds
    s_add_u32 s100, s87, 0x7000
    s_add_u32 m0, s86, 0x4800
    s_nop 0
    buffer_load_dwordx4 v28, s[44:47], s100 offen lds
    s_add_u32 m0, s86, 0x4c00
    s_nop 0
    buffer_load_dwordx4 v29, s[48:51], s100 offen lds
    s_branch L_P1b
L_P0:
    s_memrealtime s[76:77]
    v_lshrrev_b32 v10, 3, v0
    s_mov_b32 s5, 3584
    v_mul_lo_u32 v10, s5, v10
    v_and_b32 v11, 7, v0
    v_lshl_add_u32 v10, v11, 4, v10
    v_lshlrev_b32 v11, 4, v0
    s_lshl_b32 s4, s88, 7
    s_lshl_b32 s5, s89, 3
    s_add_u32 s4, s4, s5
    s_lshl_b32 s5, s92, 1
    s_add_u32 s4, s4, s5
    s_lshl_b32 s96, s4, 10
    s_lshl_b32 s4, s89, 7
    s_cmp_ge_u32 s92, 2
    s_cselect_b32 s5, 2048, 0
    s_cmp_lt_u32 s89, 12
    s_cselect_b32 s5, s5, 0
    s_add_u32 s4, s4, s5
    s_mul_i32 s5, s88, 0x1c000
    s_add_u32 s95, s4, s5
    v_mov_b32 v30, 0
    s_waitcnt lgkmcnt(0)
    s_mov_b32 s80, s36
    s_mov_b32 s81, s37
    s_mov_b32 s82, 0x100
    s_mov_b32 s83, 0x20000
    s_and_b32 s4, s76, 0x0fffffff
    s_lshl_b32 s4, s4, 3
    s_or_b32 s4, s4, 0x80000000
    s_or_b32 s5, s88, s89
    s_or_b32 s5, s5, s92
    s_cmp_eq_u32 s5, 0
    s_cselect_b32 s5, 0, 0x7ff00000
    v_mov_b32 v17, s5
    v_mov_b32 v18, 0x7ff00000
    v_cmp_eq_u32 vcc, 0, v0
    s_nop 1
    v_cndmask_b32 v17, v18, v17, vcc
    v_mov_b32 v19, s4
    buffer_store_dword v19, v17, s[80:83], 0 offen sc0 sc1
    s_mov_b32 s40, s8
    s_mov_b32 s41, s9
    s_mov_b32 s42, 0x200000
    s_mov_b32 s43, 0x20000
    buffer_load_dwordx4 v[68:71], v11, s[40:43], s96 offen
    buffer_load_dwordx4 v[72:75], v11, s[40:43], s96 offen offset:1024
    s_and_b32 s4, s92, 1
    s_cmp_eq_u32 s4, 0
    s_cselect_b32 s84, s28, s30
    s_cselect_b32 s85, s29, s31
    s_mov_b32 s86, 0x1c0000
    s_mov_b32 s87, 0x20000
    buffer_load_dwordx4 v[48:51], v10, s[84:87], s95 offen
    s_add_u32 s95, s95, 28672
    buffer_load_dwordx4 v[52:55], v10, s[84:87], s95 offen
    s_add_u32 s95, s95, 28672
    buffer_load_dwordx4 v[56:59], v10, s[84:87], s95 offen
    s_add_u32 s95, s95, 28672
    buffer_load_dwordx4 v[60:63], v10, s[84:87], s95 offen
    s_getpc_b64 s[96:97]
L_cw1:
    s_sub_u32 s96, s96, L_cw1-recurrent_scan__ssm_conv_s5__swiglu_ffn__prompt_kernel
    s_subb_u32 s97, s97, 0
    s_mul_i32 s4, s101, 18
    s_mul_i32 s5, s92, 5
    s_add_u32 s4, s4, s5
    v_min_u32 v12, 4, v0
    v_add_u32 v12, s4, v12
    v_lshlrev_b32 v12, 7, v12
    v_mov_b32 v13, L_end-recurrent_scan__ssm_conv_s5__swiglu_ffn__prompt_kernel
    v_min_u32 v12, v12, v13
    global_load_dword v94, v12, s[96:97]
    s_mov_b32 s60, s38
    s_mov_b32 s61, s39
    s_mov_b32 s62, 0x10000000
    s_mov_b32 s63, 0x20000
    s_lshl_b32 s4, s88, 4
    s_add_u32 s4, s4, s89
    s_lshl_b32 s5, s4, 7
    s_cmp_eq_u32 s92, 0
    s_cselect_b32 s5, s5, 0x7ff00000
    v_mov_b32 v24, s5
    v_mov_b32 v13, 0x7ff00000
    v_cmp_eq_u32 vcc, 0, v0
    s_nop 1
    v_cndmask_b32 v24, v13, v24, vcc
    v_and_b32 v10, 15, v0
    s_lshl_b32 s4, s94, 4
    v_add_u32 v12, s4, v10
    v_lshlrev_b32 v25, 7, v12
    s_mul_i32 s4, s92, 0x2c000
    v_lshlrev_b32 v1, 4, v0
    v_add_u32 v1, s4, v1
    v_and_b32 v10, 31, v0
    v_lshrrev_b32 v11, 5, v0
    v_bfe_u32 v12, v0, 1, 3
    v_xor_b32 v12, v12, v11
    v_lshlrev_b32 v12, 4, v12
    s_lshl_b32 s4, s92, 12
    v_lshl_add_u32 v8, v10, 7, v12
    v_add_u32 v8, s4, v8
    v_bfe_u32 v12, v0, 4, 1
    v_bfe_u32 v13, v0, 2, 2
    v_bfe_u32 v14, v0, 3, 1
    v_lshl_add_u32 v14, v12, 1, v14
    v_lshlrev_b32 v15, 11, v11
    v_lshl_add_u32 v15, v12, 10, v15
    v_lshl_add_u32 v15, v13, 7, v15
    v_and_b32 v10, 1, v0
    v_lshl_add_u32 v15, v10, 4, v15
    v_bfe_u32 v10, v0, 1, 1
    v_lshl_add_u32 v15, v10, 3, v15
    s_lshl_b32 s4, s93, 1
    v_xor_b32 v10, s4, v14
    v_lshl_add_u32 v2, v10, 5, v15
    v_xor_b32 v3, 32, v2
    v_mov_b32 v100, 0x3f803f80
    v_mov_b32 v101, 0x00003f80
    v_mov_b32 v102, 0x3f800000
    s_waitcnt vmcnt(6)
    v_dot2_f32_bf16 v96, v68, v100, 0
    v_dot2_f32_bf16 v98, v68, v68, 0
    s_waitcnt vmcnt(5)
    v_dot2_f32_bf16 v97, v72, v100, 0
    v_dot2_f32_bf16 v99, v72, v72, 0
    v_dot2_f32_bf16 v96, v69, v100, v96
    v_dot2_f32_bf16 v98, v69, v69, v98
    v_dot2_f32_bf16 v97, v73, v100, v97
    v_dot2_f32_bf16 v99, v73, v73, v99
    v_dot2_f32_bf16 v96, v70, v100, v96
    v_dot2_f32_bf16 v98, v70, v70, v98
    v_dot2_f32_bf16 v97, v74, v100, v97
    v_dot2_f32_bf16 v99, v74, v74, v99
    v_dot2_f32_bf16 v96, v71, v100, v96
    v_dot2_f32_bf16 v98, v71, v71, v98
    v_dot2_f32_bf16 v97, v75, v100, v97
    v_dot2_f32_bf16 v99, v75, v75, v99
    buffer_load_dword v27, v30, s[80:83], 0 offen sc0 sc1
    v_add_f32_dpp v96, v96, v96 row_ror:8 row_mask:0xf bank_mask:0xf
    v_add_f32_dpp v97, v97, v97 row_ror:8 row_mask:0xf bank_mask:0xf
    v_add_f32_dpp v98, v98, v98 row_ror:8 row_mask:0xf bank_mask:0xf
    v_add_f32_dpp v99, v99, v99 row_ror:8 row_mask:0xf bank_mask:0xf
    v_add_f32_dpp v96, v96, v96 row_ror:4 row_mask:0xf bank_mask:0xf
    v_add_f32_dpp v97, v97, v97 row_ror:4 row_mask:0xf bank_mask:0xf
    v_add_f32_dpp v98, v98, v98 row_ror:4 row_mask:0xf bank_mask:0xf
    v_add_f32_dpp v99, v99, v99 row_ror:4 row_mask:0xf bank_mask:0xf
    v_add_f32_dpp v96, v96, v96 row_ror:2 row_mask:0xf bank_mask:0xf
    v_add_f32_dpp v97, v97, v97 row_ror:2 row_mask:0xf bank_mask:0xf
    v_add_f32_dpp v98, v98, v98 row_ror:2 row_mask:0xf bank_mask:0xf
    v_add_f32_dpp v99, v99, v99 row_ror:2 row_mask:0xf bank_mask:0xf
    v_add_f32_dpp v96, v96, v96 row_ror:1 row_mask:0xf bank_mask:0xf
    v_add_f32_dpp v97, v97, v97 row_ror:1 row_mask:0xf bank_mask:0xf
    v_add_f32_dpp v98, v98, v98 row_ror:1 row_mask:0xf bank_mask:0xf
    v_add_f32_dpp v99, v99, v99 row_ror:1 row_mask:0xf bank_mask:0xf
    v_mov_b32 v104, v96
    v_mov_b32 v105, v97
    v_mov_b32 v106, v98
    v_mov_b32 v107, v99
    v_permlane16_swap_b32 v96, v104
    v_permlane16_swap_b32 v97, v105
    v_permlane16_swap_b32 v98, v106
    v_permlane16_swap_b32 v99, v107
    v_add_f32 v96, v96, v104
    v_add_f32 v97, v97, v105
    v_add_f32 v98, v98, v106
    v_add_f32 v99, v99, v107
    v_mov_b32 v104, v96
    v_mov_b32 v105, v97
    v_mov_b32 v106, v98
    v_mov_b32 v107, v99
    v_permlane32_swap_b32 v96, v104
    v_permlane32_swap_b32 v97, v105
    v_permlane32_swap_b32 v98, v106
    v_permlane32_swap_b32 v99, v107
    v_add_f32 v96, v96, v104
    v_add_f32 v97, v97, v105
    v_add_f32 v98, v98, v106
    v_add_f32 v99, v99, v107
    v_mul_f32 v96, 0x3b000000, v96
    v_mul_f32 v98, 0x3b000000, v98
    v_mul_f32 v97, 0x3b000000, v97
    v_mul_f32 v99, 0x3b000000, v99
    v_fma_f32 v98, -v96, v96, v98
    v_fma_f32 v99, -v97, v97, v99
    v_max_f32 v98, 0, v98
    v_add_f32 v98, 0x3727c5ac, v98
    v_max_f32 v99, 0, v99
    v_add_f32 v99, 0x3727c5ac, v99
    v_rsq_f32 v98, v98
    v_rsq_f32 v99, v99
    s_waitcnt vmcnt(5)
    v_dot2_f32_bf16 v80, v48, v101, 0
    v_dot2_f32_bf16 v81, v48, v102, 0
    v_dot2_f32_bf16 v82, v49, v101, 0
    v_dot2_f32_bf16 v83, v49, v102, 0
    v_dot2_f32_bf16 v84, v50, v101, 0
    v_dot2_f32_bf16 v85, v50, v102, 0
    v_dot2_f32_bf16 v86, v51, v101, 0
    v_dot2_f32_bf16 v87, v51, v102, 0
    s_waitcnt vmcnt(4)
    v_dot2_f32_bf16 v80, v52, v101, v80
    v_dot2_f32_bf16 v81, v52, v102, v81
    v_dot2_f32_bf16 v82, v53, v101, v82
    v_dot2_f32_bf16 v83, v53, v102, v83
    v_dot2_f32_bf16 v84, v54, v101, v84
    v_dot2_f32_bf16 v85, v54, v102, v85
    v_dot2_f32_bf16 v86, v55, v101, v86
    v_dot2_f32_bf16 v87, v55, v102, v87
    s_waitcnt vmcnt(3)
    v_dot2_f32_bf16 v80, v56, v101, v80
    v_dot2_f32_bf16 v81, v56, v102, v81
    v_dot2_f32_bf16 v82, v57, v101, v82
    v_dot2_f32_bf16 v83, v57, v102, v83
    v_dot2_f32_bf16 v84, v58, v101, v84
    v_dot2_f32_bf16 v85, v58, v102, v85
    v_dot2_f32_bf16 v86, v59, v101, v86
    v_dot2_f32_bf16 v87, v59, v102, v87
    s_waitcnt vmcnt(2)
    v_dot2_f32_bf16 v80, v60, v101, v80
    v_dot2_f32_bf16 v81, v60, v102, v81
    v_dot2_f32_bf16 v82, v61, v101, v82
    v_dot2_f32_bf16 v83, v61, v102, v83
    v_dot2_f32_bf16 v84, v62, v101, v84
    v_dot2_f32_bf16 v85, v62, v102, v85
    v_dot2_f32_bf16 v86, v63, v101, v86
    v_dot2_f32_bf16 v87, v63, v102, v87
    v_cmp_eq_u32 vcc, 0, v0
    s_nop 1
    v_cndmask_b32 v52, v97, v96, vcc
    v_cndmask_b32 v54, v99, v98, vcc
    v_lshlrev_b32 v60, 4, v0
    v_mov_b32 v11, 0x7ff00000
    v_cmp_gt_u32 vcc, 2, v0
    s_nop 1
    v_cndmask_b32 v60, v11, v60, vcc
    v_and_b32 v61, 7, v0
    v_lshlrev_b32 v61, 6, v61
    v_bfe_u32 v11, v0, 5, 1
    v_lshl_add_u32 v61, v11, 5, v61
    v_bfe_u32 v11, v0, 4, 1
    v_lshl_add_u32 v61, v11, 4, v61
    v_permlane32_swap_b32 v80, v84
    v_permlane32_swap_b32 v81, v85
    v_permlane32_swap_b32 v82, v86
    v_permlane32_swap_b32 v83, v87
    v_add_f32 v80, v80, v84
    v_add_f32 v81, v81, v85
    v_add_f32 v82, v82, v86
    v_add_f32 v83, v83, v87
    s_nop 0
    v_permlane16_swap_b32 v80, v82
    v_permlane16_swap_b32 v81, v83
    v_add_f32 v80, v80, v82
    v_add_f32 v81, v81, v83
    s_nop 0
    v_add_f32_dpp v56, v80, v80 row_ror:8 row_mask:0xf bank_mask:0xf
    v_add_f32_dpp v58, v81, v81 row_ror:8 row_mask:0xf bank_mask:0xf
    s_waitcnt vmcnt(0)
    v_readfirstlane_b32 s26, v27
    s_nop 3
    s_cmp_lg_u32 s26, 0
    s_cbranch_scc1 L_tagd3
    s_mov_b32 s97, 400000
L_tag2:
    s_sleep 1
    buffer_load_dword v27, v30, s[80:83], 0 offen sc0 sc1
    s_waitcnt vmcnt(0)
    v_readfirstlane_b32 s26, v27
    s_nop 4
    s_cmp_lg_u32 s26, 0
    s_cbranch_scc1 L_tagd3
    s_sub_u32 s97, s97, 1
    s_cmp_lg_u32 s97, 0
    s_cbranch_scc1 L_tag2
L_tagd3:
    s_nop 0
    v_mov_b32 v15, 0x27b00
    v_mov_b32 v16, s26
    ds_write_b32 v15, v16
    v_mov_b32 v53, s26
    v_mov_b32 v55, s26
    v_mov_b32 v57, s26
    v_mov_b32 v59, s26
    s_lshl_b32 s4, s88, 11
    s_lshl_b32 s5, s89, 7
    s_add_u32 s4, s4, s5
    s_lshl_b32 s5, s92, 5
    s_add_u32 s4, s4, s5
    s_add_u32 s95, s4, 0x8000
    buffer_store_dwordx4 v[52:55], v60, s[60:63], s95 offen sc0 sc1
    s_lshl_b32 s4, s89, 16
    s_lshl_b32 s5, s88, 12
    s_add_u32 s4, s4, s5
    s_add_u32 s6, s4, 0x100000
    s_lshl_b32 s5, s92, 9
    s_add_u32 s95, s6, s5
    buffer_store_dwordx4 v[56:59], v61, s[60:63], s95 offen sc0 sc1
    s_cmp_ge_u32 s89, 12
    s_cbranch_scc1 L_light0
    s_branch L_heavy0
L_P1b:
    s_lshl_b32 s84, s92, 11
    s_lshl_b32 s85, s89, 15
    v_lshrrev_b32 v10, 5, v0
    s_lshl_b32 s4, s92, 2
    s_add_u32 s4, s4, 0
    v_add_u32 v10, s4, v10
    v_and_b32 v11, 31, v0
    v_xor_b32 v11, v11, v10
    v_lshlrev_b32 v11, 4, v11
    v_lshl_add_u32 v30, v10, 10, v11
    v_lshrrev_b32 v10, 5, v0
    s_lshl_b32 s4, s92, 2
    s_add_u32 s4, s4, 2
    v_add_u32 v10, s4, v10
    v_and_b32 v11, 31, v0
    v_xor_b32 v11, v11, v10
    v_lshlrev_b32 v11, 4, v11
    v_lshl_add_u32 v31, v10, 10, v11
    s_mov_b32 s52, s14
    s_mov_b32 s53, s15
    s_mov_b32 s54, 0x80000
    s_mov_b32 s55, 0x20000
    s_mov_b32 s56, s16
    s_mov_b32 s57, s17
    s_mov_b32 s58, 0x80000
    s_mov_b32 s59, 0x20000
    s_mov_b32 s60, s38
    s_mov_b32 s61, s39
    s_mov_b32 s62, 0x10000000
    s_mov_b32 s63, 0x20000
    s_mov_b32 s64, s32
    s_mov_b32 s65, s33
    s_mov_b32 s66, 0x1c0000
    s_mov_b32 s67, 0x20000
    s_mov_b32 s68, s18
    s_mov_b32 s69, s19
    s_mov_b32 s70, 0x80000
    s_mov_b32 s71, 0x20000
    s_mov_b32 s72, s20
    s_mov_b32 s73, s21
    s_mov_b32 s74, 0x80000
    s_mov_b32 s75, 0x20000
    s_mul_i32 s83, s90, 0x58000
    s_add_u32 s83, s83, 0x200000
    s_mul_i32 s4, s92, 0x2c000
    v_lshlrev_b32 v1, 4, v0
    v_add_u32 v1, s4, v1
    v_and_b32 v10, 31, v0
    v_lshrrev_b32 v11, 5, v0
    v_bfe_u32 v12, v0, 1, 3
    v_xor_b32 v12, v12, v11
    v_lshlrev_b32 v12, 4, v12
    s_lshl_b32 s4, s92, 12
    v_lshl_add_u32 v8, v10, 7, v12
    v_add_u32 v8, s4, v8
    v_bfe_u32 v12, v0, 4, 1
    v_bfe_u32 v13, v0, 2, 2
    v_bfe_u32 v14, v0, 3, 1
    v_lshl_add_u32 v14, v12, 1, v14
    v_lshlrev_b32 v15, 11, v11
    v_lshl_add_u32 v15, v12, 10, v15
    v_lshl_add_u32 v15, v13, 7, v15
    v_and_b32 v10, 1, v0
    v_lshl_add_u32 v15, v10, 4, v15
    v_bfe_u32 v10, v0, 1, 1
    v_lshl_add_u32 v15, v10, 3, v15
    s_lshl_b32 s4, s93, 1
    v_xor_b32 v10, s4, v14
    v_lshl_add_u32 v2, v10, 5, v15
    v_xor_b32 v3, 32, v2
    s_mov_b32 s100, 128
    s_add_u32 m0, s86, 0x8000
    s_nop 0
    buffer_load_dwordx4 v24, s[40:43], s100 offen lds
    s_add_u32 m0, s86, 0x8400
    s_nop 0
    buffer_load_dwordx4 v25, s[40:43], s100 offen lds
    s_add_u32 m0, s86, 0x8800
    s_nop 0
    buffer_load_dwordx4 v26, s[40:43], s100 offen lds
    s_add_u32 m0, s86, 0x8c00
    s_nop 0
    buffer_load_dwordx4 v27, s[40:43], s100 offen lds
    s_add_u32 s100, s87, 0x38000
    s_add_u32 m0, s86, 0xc000
    s_nop 0
    buffer_load_dwordx4 v28, s[44:47], s100 offen lds
    s_add_u32 m0, s86, 0xc400
    s_nop 0
    buffer_load_dwordx4 v29, s[48:51], s100 offen lds
    s_add_u32 s100, s87, 0x3f000
    s_add_u32 m0, s86, 0xc800
    s_nop 0
    buffer_load_dwordx4 v28, s[44:47], s100 offen lds
    s_add_u32 m0, s86, 0xcc00
    s_nop 0
    buffer_load_dwordx4 v29, s[48:51], s100 offen lds
    s_mov_b32 s100, 256
    s_add_u32 m0, s86, 0x10000
    s_nop 0
    buffer_load_dwordx4 v24, s[40:43], s100 offen lds
    s_add_u32 m0, s86, 0x10400
    s_nop 0
    buffer_load_dwordx4 v25, s[40:43], s100 offen lds
    s_add_u32 m0, s86, 0x10800
    s_nop 0
    buffer_load_dwordx4 v26, s[40:43], s100 offen lds
    s_add_u32 m0, s86, 0x10c00
    s_nop 0
    buffer_load_dwordx4 v27, s[40:43], s100 offen lds
    s_add_u32 s100, s87, 0x70000
    s_add_u32 m0, s86, 0x14000
    s_nop 0
    buffer_load_dwordx4 v28, s[44:47], s100 offen lds
    s_add_u32 m0, s86, 0x14400
    s_nop 0
    buffer_load_dwordx4 v29, s[48:51], s100 offen lds
    s_add_u32 s100, s87, 0x77000
    s_add_u32 m0, s86, 0x14800
    s_nop 0
    buffer_load_dwordx4 v28, s[44:47], s100 offen lds
    s_add_u32 m0, s86, 0x14c00
    s_nop 0
    buffer_load_dwordx4 v29, s[48:51], s100 offen lds
    s_cmp_ge_u32 s89, 12
    s_cbranch_scc1 L_light1
L_heavy1:
    v_add_u32 v48, 0x0, v8
    v_add_u32 v4, 0x4000, v2
    v_add_u32 v5, 0x4000, v3
    v_xor_b32 v49, 32, v48
    v_xor_b32 v50, 64, v48
    v_xor_b32 v51, 96, v48
    s_waitcnt vmcnt(20)
    s_waitcnt vmcnt(16)
    s_barrier
    ds_read_b128 v[128:131], v48
    ds_read_b64_tr_b16 v[32:33], v4 offset:0
    ds_read_b64_tr_b16 v[34:35], v4 offset:512
    ds_read_b64_tr_b16 v[36:37], v5 offset:0
    ds_read_b64_tr_b16 v[38:39], v5 offset:512
    ds_read_b128 v[132:135], v49
    ds_read_b128 v[136:139], v50
    ds_read_b128 v[140:143], v51
    ds_read_b64_tr_b16 v[40:41], v4 offset:4096
    ds_read_b64_tr_b16 v[42:43], v4 offset:4608
    ds_read_b64_tr_b16 v[44:45], v5 offset:4096
    ds_read_b64_tr_b16 v[46:47], v5 offset:4608
    ds_read_b64_tr_b16 v[80:81], v4 offset:8192
    ds_read_b64_tr_b16 v[82:83], v4 offset:8704
    ds_read_b64_tr_b16 v[84:85], v5 offset:8192
    ds_read_b64_tr_b16 v[86:87], v5 offset:8704
    s_waitcnt lgkmcnt(13)
    v_mfma_f32_32x32x16_bf16 v[96:111], v[32:35], v[128:131], 0
    s_mov_b32 s100, 384
    s_add_u32 m0, s86, 0x18000
    s_nop 0
    buffer_load_dwordx4 v24, s[40:43], s100 offen lds
    s_waitcnt lgkmcnt(11)
    v_mfma_f32_32x32x16_bf16 v[112:127], v[36:39], v[128:131], 0
    s_add_u32 m0, s86, 0x18400
    s_nop 0
    buffer_load_dwordx4 v25, s[40:43], s100 offen lds
    ds_read_b64_tr_b16 v[32:33], v4 offset:12288
    ds_read_b64_tr_b16 v[34:35], v4 offset:12800
    ds_read_b64_tr_b16 v[36:37], v5 offset:12288
    ds_read_b64_tr_b16 v[38:39], v5 offset:12800
    s_waitcnt lgkmcnt(10)
    v_mfma_f32_32x32x16_bf16 v[96:111], v[40:43], v[132:135], v[96:111]
    s_add_u32 m0, s86, 0x18800
    s_nop 0
    buffer_load_dwordx4 v26, s[40:43], s100 offen lds
    s_waitcnt lgkmcnt(8)
    v_mfma_f32_32x32x16_bf16 v[112:127], v[44:47], v[132:135], v[112:127]
    s_add_u32 m0, s86, 0x18c00
    s_nop 0
    buffer_load_dwordx4 v27, s[40:43], s100 offen lds
    v_add_u32 v72, 0x8000, v8
    v_add_u32 v76, 0xc000, v2
    v_add_u32 v77, 0xc000, v3
    v_xor_b32 v73, 32, v72
    s_add_u32 s100, s87, 0xa8000
    s_add_u32 m0, s86, 0x1c000
    s_nop 0
    buffer_load_dwordx4 v28, s[44:47], s100 offen lds
    s_add_u32 m0, s86, 0x1c400
    s_nop 0
    buffer_load_dwordx4 v29, s[48:51], s100 offen lds
    s_add_u32 s100, s87, 0xaf000
    s_add_u32 m0, s86, 0x1c800
    s_nop 0
    buffer_load_dwordx4 v28, s[44:47], s100 offen lds
    s_add_u32 m0, s86, 0x1cc00
    s_nop 0
    buffer_load_dwordx4 v29, s[48:51], s100 offen lds
    s_mov_b32 s100, 512
    s_add_u32 m0, s86, 0x20000
    s_nop 0
    buffer_load_dwordx4 v24, s[40:43], s100 offen lds
    s_add_u32 m0, s86, 0x20400
    s_nop 0
    buffer_load_dwordx4 v25, s[40:43], s100 offen lds
    s_add_u32 m0, s86, 0x20800
    s_nop 0
    buffer_load_dwordx4 v26, s[40:43], s100 offen lds
    s_add_u32 m0, s86, 0x20c00
    s_nop 0
    buffer_load_dwordx4 v27, s[40:43], s100 offen lds
    v_xor_b32 v74, 64, v72
    v_xor_b32 v75, 96, v72
    s_waitcnt vmcnt(24)
    s_waitcnt vmcnt(20)
    s_waitcnt lgkmcnt(0)
    s_barrier
    ds_read_b128 v[144:147], v72
    ds_read_b64_tr_b16 v[40:41], v76 offset:0
    ds_read_b64_tr_b16 v[42:43], v76 offset:512
    ds_read_b64_tr_b16 v[44:45], v77 offset:0
    ds_read_b64_tr_b16 v[46:47], v77 offset:512
    ds_read_b128 v[148:151], v73
    ds_read_b128 v[152:155], v74
    ds_read_b128 v[156:159], v75
    v_mfma_f32_32x32x16_bf16 v[96:111], v[80:83], v[136:139], v[96:111]
    s_add_u32 s100, s87, 0xe0000
    s_add_u32 m0, s86, 0x0
    s_nop 0
    buffer_load_dwordx4 v28, s[44:47], s100 offen lds
    v_mfma_f32_32x32x16_bf16 v[112:127], v[84:87], v[136:139], v[112:127]
    s_add_u32 m0, s86, 0x400
    s_nop 0
    buffer_load_dwordx4 v29, s[48:51], s100 offen lds
    ds_read_b64_tr_b16 v[80:81], v76 offset:4096
    ds_read_b64_tr_b16 v[82:83], v76 offset:4608
    ds_read_b64_tr_b16 v[84:85], v77 offset:4096
    ds_read_b64_tr_b16 v[86:87], v77 offset:4608
    v_mfma_f32_32x32x16_bf16 v[96:111], v[32:35], v[140:143], v[96:111]
    s_add_u32 s100, s87, 0xe7000
    s_add_u32 m0, s86, 0x800
    s_nop 0
    buffer_load_dwordx4 v28, s[44:47], s100 offen lds
    v_mfma_f32_32x32x16_bf16 v[112:127], v[36:39], v[140:143], v[112:127]
    s_add_u32 m0, s86, 0xc00
    s_nop 0
    buffer_load_dwordx4 v29, s[48:51], s100 offen lds
    v_add_u32 v48, 0x10000, v8
    v_add_u32 v4, 0x14000, v2
    v_add_u32 v5, 0x14000, v3
    v_xor_b32 v49, 32, v48
    ds_read_b64_tr_b16 v[32:33], v76 offset:8192
    ds_read_b64_tr_b16 v[34:35], v76 offset:8704
    ds_read_b64_tr_b16 v[36:37], v77 offset:8192
    ds_read_b64_tr_b16 v[38:39], v77 offset:8704
    s_waitcnt lgkmcnt(13)
    v_mfma_f32_32x32x16_bf16 v[96:111], v[40:43], v[144:147], v[96:111]
    s_mov_b32 s100, 640
    s_add_u32 m0, s86, 0x4000
    s_nop 0
    buffer_load_dwordx4 v24, s[40:43], s100 offen lds
    v_xor_b32 v50, 64, v48
    v_xor_b32 v51, 96, v48
    s_waitcnt lgkmcnt(11)
    v_mfma_f32_32x32x16_bf16 v[112:127], v[44:47], v[144:147], v[112:127]
    s_add_u32 m0, s86, 0x4400
    s_nop 0
    buffer_load_dwordx4 v25, s[40:43], s100 offen lds
    ds_read_b64_tr_b16 v[40:41], v76 offset:12288
    ds_read_b64_tr_b16 v[42:43], v76 offset:12800
    ds_read_b64_tr_b16 v[44:45], v77 offset:12288
    ds_read_b64_tr_b16 v[46:47], v77 offset:12800
    s_waitcnt lgkmcnt(10)
    v_mfma_f32_32x32x16_bf16 v[96:111], v[80:83], v[148:151], v[96:111]
    s_add_u32 m0, s86, 0x4800
    s_nop 0
    buffer_load_dwordx4 v26, s[40:43], s100 offen lds
    s_waitcnt lgkmcnt(8)
    v_mfma_f32_32x32x16_bf16 v[112:127], v[84:87], v[148:151], v[112:127]
    s_add_u32 m0, s86, 0x4c00
    s_nop 0
    buffer_load_dwordx4 v27, s[40:43], s100 offen lds
    s_waitcnt vmcnt(24)
    s_waitcnt vmcnt(20)
    s_waitcnt lgkmcnt(0)
    s_barrier
    ds_read_b128 v[160:163], v48
    ds_read_b64_tr_b16 v[80:81], v4 offset:0
    ds_read_b64_tr_b16 v[82:83], v4 offset:512
    ds_read_b64_tr_b16 v[84:85], v5 offset:0
    ds_read_b64_tr_b16 v[86:87], v5 offset:512
    ds_read_b128 v[164:167], v49
    ds_read_b128 v[168:171], v50
    ds_read_b128 v[172:175], v51
    v_mfma_f32_32x32x16_bf16 v[96:111], v[32:35], v[152:155], v[96:111]
    s_add_u32 s100, s87, 0x118000
    s_add_u32 m0, s86, 0x8000
    s_nop 0
    buffer_load_dwordx4 v28, s[44:47], s100 offen lds
    v_mfma_f32_32x32x16_bf16 v[112:127], v[36:39], v[152:155], v[112:127]
    s_add_u32 m0, s86, 0x8400
    s_nop 0
    buffer_load_dwordx4 v29, s[48:51], s100 offen lds
    ds_read_b64_tr_b16 v[32:33], v4 offset:4096
    ds_read_b64_tr_b16 v[34:35], v4 offset:4608
    ds_read_b64_tr_b16 v[36:37], v5 offset:4096
    ds_read_b64_tr_b16 v[38:39], v5 offset:4608
    v_mfma_f32_32x32x16_bf16 v[96:111], v[40:43], v[156:159], v[96:111]
    s_add_u32 s100, s87, 0x11f000
    s_add_u32 m0, s86, 0x8800
    s_nop 0
    buffer_load_dwordx4 v28, s[44:47], s100 offen lds
    v_mfma_f32_32x32x16_bf16 v[112:127], v[44:47], v[156:159], v[112:127]
    s_add_u32 m0, s86, 0x8c00
    s_nop 0
    buffer_load_dwordx4 v29, s[48:51], s100 offen lds
    v_add_u32 v72, 0x18000, v8
    v_add_u32 v76, 0x1c000, v2
    v_add_u32 v77, 0x1c000, v3
    v_xor_b32 v73, 32, v72
    ds_read_b64_tr_b16 v[40:41], v4 offset:8192
    ds_read_b64_tr_b16 v[42:43], v4 offset:8704
    ds_read_b64_tr_b16 v[44:45], v5 offset:8192
    ds_read_b64_tr_b16 v[46:47], v5 offset:8704
    s_waitcnt lgkmcnt(13)
    v_mfma_f32_32x32x16_bf16 v[96:111], v[80:83], v[160:163], v[96:111]
    s_mov_b32 s100, 768
    s_add_u32 m0, s86, 0xc000
    s_nop 0
    buffer_load_dwordx4 v24, s[40:43], s100 offen lds
    v_xor_b32 v74, 64, v72
    v_xor_b32 v75, 96, v72
    s_waitcnt lgkmcnt(11)
    v_mfma_f32_32x32x16_bf16 v[112:127], v[84:87], v[160:163], v[112:127]
    s_add_u32 m0, s86, 0xc400
    s_nop 0
    buffer_load_dwordx4 v25, s[40:43], s100 offen lds
    ds_read_b64_tr_b16 v[80:81], v4 offset:12288
    ds_read_b64_tr_b16 v[82:83], v4 offset:12800
    ds_read_b64_tr_b16 v[84:85], v5 offset:12288
    ds_read_b64_tr_b16 v[86:87], v5 offset:12800
    s_waitcnt lgkmcnt(10)
    v_mfma_f32_32x32x16_bf16 v[96:111], v[32:35], v[164:167], v[96:111]
    s_add_u32 m0, s86, 0xc800
    s_nop 0
    buffer_load_dwordx4 v26, s[40:43], s100 offen lds
    s_waitcnt lgkmcnt(8)
    v_mfma_f32_32x32x16_bf16 v[112:127], v[36:39], v[164:167], v[112:127]
    s_add_u32 m0, s86, 0xcc00
    s_nop 0
    buffer_load_dwordx4 v27, s[40:43], s100 offen lds
    s_waitcnt vmcnt(24)
    s_waitcnt vmcnt(20)
    s_waitcnt lgkmcnt(0)
    s_barrier
    ds_read_b128 v[176:179], v72
    ds_read_b64_tr_b16 v[32:33], v76 offset:0
    ds_read_b64_tr_b16 v[34:35], v76 offset:512
    ds_read_b64_tr_b16 v[36:37], v77 offset:0
    ds_read_b64_tr_b16 v[38:39], v77 offset:512
    ds_read_b128 v[180:183], v73
    ds_read_b128 v[184:187], v74
    ds_read_b128 v[188:191], v75
    v_mfma_f32_32x32x16_bf16 v[96:111], v[40:43], v[168:171], v[96:111]
    s_add_u32 s100, s87, 0x150000
    s_add_u32 m0, s86, 0x10000
    s_nop 0
    buffer_load_dwordx4 v28, s[44:47], s100 offen lds
    v_mfma_f32_32x32x16_bf16 v[112:127], v[44:47], v[168:171], v[112:127]
    s_add_u32 m0, s86, 0x10400
    s_nop 0
    buffer_load_dwordx4 v29, s[48:51], s100 offen lds
    ds_read_b64_tr_b16 v[40:41], v76 offset:4096
    ds_read_b64_tr_b16 v[42:43], v76 offset:4608
    ds_read_b64_tr_b16 v[44:45], v77 offset:4096
    ds_read_b64_tr_b16 v[46:47], v77 offset:4608
    v_mfma_f32_32x32x16_bf16 v[96:111], v[80:83], v[172:175], v[96:111]
    s_add_u32 s100, s87, 0x157000
    s_add_u32 m0, s86, 0x10800
    s_nop 0
    buffer_load_dwordx4 v28, s[44:47], s100 offen lds
    v_mfma_f32_32x32x16_bf16 v[112:127], v[84:87], v[172:175], v[112:127]
    s_add_u32 m0, s86, 0x10c00
    s_nop 0
    buffer_load_dwordx4 v29, s[48:51], s100 offen lds
    v_add_u32 v48, 0x20000, v8
    v_add_u32 v4, 0x0, v2
    v_add_u32 v5, 0x0, v3
    v_xor_b32 v49, 32, v48
    ds_read_b64_tr_b16 v[80:81], v76 offset:8192
    ds_read_b64_tr_b16 v[82:83], v76 offset:8704
    ds_read_b64_tr_b16 v[84:85], v77 offset:8192
    ds_read_b64_tr_b16 v[86:87], v77 offset:8704
    s_waitcnt lgkmcnt(13)
    v_mfma_f32_32x32x16_bf16 v[96:111], v[32:35], v[176:179], v[96:111]
    s_mov_b32 s100, 896
    s_add_u32 m0, s86, 0x14000
    s_nop 0
    buffer_load_dwordx4 v24, s[40:43], s100 offen lds
    v_xor_b32 v50, 64, v48
    v_xor_b32 v51, 96, v48
    s_waitcnt lgkmcnt(11)
    v_mfma_f32_32x32x16_bf16 v[112:127], v[36:39], v[176:179], v[112:127]
    s_add_u32 m0, s86, 0x14400
    s_nop 0
    buffer_load_dwordx4 v25, s[40:43], s100 offen lds
    ds_read_b64_tr_b16 v[32:33], v76 offset:12288
    ds_read_b64_tr_b16 v[34:35], v76 offset:12800
    ds_read_b64_tr_b16 v[36:37], v77 offset:12288
    ds_read_b64_tr_b16 v[38:39], v77 offset:12800
    s_waitcnt lgkmcnt(10)
    v_mfma_f32_32x32x16_bf16 v[96:111], v[40:43], v[180:183], v[96:111]
    s_add_u32 m0, s86, 0x14800
    s_nop 0
    buffer_load_dwordx4 v26, s[40:43], s100 offen lds
    s_waitcnt lgkmcnt(8)
    v_mfma_f32_32x32x16_bf16 v[112:127], v[44:47], v[180:183], v[112:127]
    s_add_u32 m0, s86, 0x14c00
    s_nop 0
    buffer_load_dwordx4 v27, s[40:43], s100 offen lds
    s_waitcnt vmcnt(24)
    s_waitcnt vmcnt(20)
    s_waitcnt lgkmcnt(0)
    s_barrier
    ds_read_b128 v[192:195], v48
    ds_read_b64_tr_b16 v[40:41], v4 offset:0
    ds_read_b64_tr_b16 v[42:43], v4 offset:512
    ds_read_b64_tr_b16 v[44:45], v5 offset:0
    ds_read_b64_tr_b16 v[46:47], v5 offset:512
    ds_read_b128 v[196:199], v49
    ds_read_b128 v[200:203], v50
    ds_read_b128 v[204:207], v51
    v_mfma_f32_32x32x16_bf16 v[96:111], v[80:83], v[184:187], v[96:111]
    s_add_u32 s100, s87, 0x188000
    s_add_u32 m0, s86, 0x18000
    s_nop 0
    buffer_load_dwordx4 v28, s[44:47], s100 offen lds
    v_mfma_f32_32x32x16_bf16 v[112:127], v[84:87], v[184:187], v[112:127]
    s_add_u32 m0, s86, 0x18400
    s_nop 0
    buffer_load_dwordx4 v29, s[48:51], s100 offen lds
    ds_read_b64_tr_b16 v[80:81], v4 offset:4096
    ds_read_b64_tr_b16 v[82:83], v4 offset:4608
    ds_read_b64_tr_b16 v[84:85], v5 offset:4096
    ds_read_b64_tr_b16 v[86:87], v5 offset:4608
    v_mfma_f32_32x32x16_bf16 v[96:111], v[32:35], v[188:191], v[96:111]
    s_add_u32 s100, s87, 0x18f000
    s_add_u32 m0, s86, 0x18800
    s_nop 0
    buffer_load_dwordx4 v28, s[44:47], s100 offen lds
    v_mfma_f32_32x32x16_bf16 v[112:127], v[36:39], v[188:191], v[112:127]
    s_add_u32 m0, s86, 0x18c00
    s_nop 0
    buffer_load_dwordx4 v29, s[48:51], s100 offen lds
    v_add_u32 v72, 0x4000, v8
    v_add_u32 v76, 0x8000, v2
    v_add_u32 v77, 0x8000, v3
    v_xor_b32 v73, 32, v72
    ds_read_b64_tr_b16 v[32:33], v4 offset:8192
    ds_read_b64_tr_b16 v[34:35], v4 offset:8704
    ds_read_b64_tr_b16 v[36:37], v5 offset:8192
    ds_read_b64_tr_b16 v[38:39], v5 offset:8704
    s_waitcnt lgkmcnt(13)
    v_mfma_f32_32x32x16_bf16 v[96:111], v[40:43], v[192:195], v[96:111]
    s_add_u32 s100, s85, 0x0
    s_add_u32 m0, s84, 0x1c000
    s_nop 0
    buffer_load_dwordx4 v30, s[52:55], s100 offen lds
    v_xor_b32 v74, 64, v72
    v_xor_b32 v75, 96, v72
    s_lshr_b32 s4, s92, 1
    s_mul_i32 s4, s4, 0x2c000
    s_and_b32 s5, s92, 1
    s_lshl_b32 s5, s5, 12
    s_add_u32 s4, s4, s5
    v_lshlrev_b32 v24, 4, v0
    s_waitcnt lgkmcnt(11)
    v_mfma_f32_32x32x16_bf16 v[112:127], v[44:47], v[192:195], v[112:127]
    s_add_u32 m0, s84, 0x1e000
    s_nop 0
    buffer_load_dwordx4 v30, s[56:59], s100 offen lds
    v_add_u32 v24, s4, v24
    v_lshrrev_b32 v10, 3, v0
    s_lshl_b32 s4, s92, 5
    v_add_u32 v10, s4, v10
    ds_read_b64_tr_b16 v[40:41], v4 offset:12288
    ds_read_b64_tr_b16 v[42:43], v4 offset:12800
    ds_read_b64_tr_b16 v[44:45], v5 offset:12288
    ds_read_b64_tr_b16 v[46:47], v5 offset:12800
    s_waitcnt lgkmcnt(10)
    v_mfma_f32_32x32x16_bf16 v[96:111], v[80:83], v[196:199], v[96:111]
    s_add_u32 m0, s84, 0x1c400
    s_nop 0
    buffer_load_dwordx4 v31, s[52:55], s100 offen lds
    v_lshlrev_b32 v10, 10, v10
    v_bfe_u32 v11, v0, 4, 1
    v_lshlrev_b32 v11, 2, v11
    v_and_b32 v12, 7, v0
    s_waitcnt lgkmcnt(8)
    v_mfma_f32_32x32x16_bf16 v[112:127], v[84:87], v[196:199], v[112:127]
    s_add_u32 m0, s84, 0x1e400
    s_nop 0
    buffer_load_dwordx4 v31, s[56:59], s100 offen lds
    v_xor_b32 v11, v11, v12
    v_lshl_add_u32 v25, v11, 4, v10
    s_lshl_b32 s4, s91, 7
    v_add_u32 v25, s4, v25
    v_lshrrev_b32 v10, 3, v0
    s_waitcnt vmcnt(24)
    s_waitcnt vmcnt(20)
    s_waitcnt lgkmcnt(0)
    s_barrier
    ds_read_b128 v[208:211], v72
    ds_read_b64_tr_b16 v[80:81], v76 offset:0
    ds_read_b64_tr_b16 v[82:83], v76 offset:512
    ds_read_b64_tr_b16 v[84:85], v77 offset:0
    ds_read_b64_tr_b16 v[86:87], v77 offset:512
    ds_read_b128 v[212:215], v73
    ds_read_b128 v[216:219], v74
    ds_read_b128 v[220:223], v75
    v_mfma_f32_32x32x16_bf16 v[96:111], v[32:35], v[200:203], v[96:111]
    s_add_u32 s100, s85, 0x4000
    s_add_u32 m0, s84, 0x20000
    s_nop 0
    buffer_load_dwordx4 v30, s[52:55], s100 offen lds
    v_mfma_f32_32x32x16_bf16 v[112:127], v[36:39], v[200:203], v[112:127]
    s_add_u32 m0, s84, 0x22000
    s_nop 0
    buffer_load_dwordx4 v30, s[56:59], s100 offen lds
    ds_read_b64_tr_b16 v[32:33], v76 offset:4096
    ds_read_b64_tr_b16 v[34:35], v76 offset:4608
    ds_read_b64_tr_b16 v[36:37], v77 offset:4096
    ds_read_b64_tr_b16 v[38:39], v77 offset:4608
    v_mfma_f32_32x32x16_bf16 v[96:111], v[40:43], v[204:207], v[96:111]
    s_add_u32 m0, s84, 0x20400
    s_nop 0
    buffer_load_dwordx4 v31, s[52:55], s100 offen lds
    v_mfma_f32_32x32x16_bf16 v[112:127], v[44:47], v[204:207], v[112:127]
    s_add_u32 m0, s84, 0x22400
    s_nop 0
    buffer_load_dwordx4 v31, s[56:59], s100 offen lds
    v_add_u32 v48, 0xc000, v8
    v_add_u32 v4, 0x10000, v2
    v_add_u32 v5, 0x10000, v3
    v_xor_b32 v49, 32, v48
    ds_read_b64_tr_b16 v[40:41], v76 offset:8192
    ds_read_b64_tr_b16 v[42:43], v76 offset:8704
    ds_read_b64_tr_b16 v[44:45], v77 offset:8192
    ds_read_b64_tr_b16 v[46:47], v77 offset:8704
    s_waitcnt lgkmcnt(13)
    v_mfma_f32_32x32x16_bf16 v[96:111], v[80:83], v[208:211], v[96:111]
    s_add_u32 s100, s85, 0x200
    s_add_u32 m0, s84, 0x0
    s_nop 0
    buffer_load_dwordx4 v30, s[52:55], s100 offen lds
    v_xor_b32 v50, 64, v48
    v_xor_b32 v51, 96, v48
    s_lshl_b32 s4, s92, 4
    s_lshl_b32 s5, s91, 6
    s_add_u32 s4, s4, s5
    s_add_u32 s4, s4, 0
    v_add_u32 v10, s4, v10
    s_waitcnt lgkmcnt(11)
    v_mfma_f32_32x32x16_bf16 v[112:127], v[84:87], v[208:211], v[112:127]
    s_add_u32 m0, s84, 0x2000
    s_nop 0
    buffer_load_dwordx4 v30, s[56:59], s100 offen lds
    v_lshlrev_b32 v10, 10, v10
    v_lshrrev_b32 v11, 4, v0
    v_and_b32 v12, 7, v0
    v_xor_b32 v11, v11, v12
    ds_read_b64_tr_b16 v[80:81], v76 offset:12288
    ds_read_b64_tr_b16 v[82:83], v76 offset:12800
    ds_read_b64_tr_b16 v[84:85], v77 offset:12288
    ds_read_b64_tr_b16 v[86:87], v77 offset:12800
    s_waitcnt lgkmcnt(10)
    v_mfma_f32_32x32x16_bf16 v[96:111], v[32:35], v[212:215], v[96:111]
    s_add_u32 m0, s84, 0x400
    s_nop 0
    buffer_load_dwordx4 v31, s[52:55], s100 offen lds
    v_lshl_add_u32 v26, v11, 4, v10
    v_lshrrev_b32 v10, 3, v0
    s_lshl_b32 s4, s92, 4
    s_lshl_b32 s5, s91, 6
    s_add_u32 s4, s4, s5
    s_add_u32 s4, s4, 8
    s_waitcnt lgkmcnt(8)
    v_mfma_f32_32x32x16_bf16 v[112:127], v[36:39], v[212:215], v[112:127]
    s_add_u32 m0, s84, 0x2400
    s_nop 0
    buffer_load_dwordx4 v31, s[56:59], s100 offen lds
    v_add_u32 v10, s4, v10
    v_lshlrev_b32 v10, 10, v10
    v_lshrrev_b32 v11, 4, v0
    v_xor_b32 v11, 4, v11
    s_waitcnt vmcnt(24)
    s_waitcnt vmcnt(20)
    s_waitcnt lgkmcnt(0)
    s_barrier
    ds_read_b128 v[224:227], v48
    ds_read_b64_tr_b16 v[32:33], v4 offset:0
    ds_read_b64_tr_b16 v[34:35], v4 offset:512
    ds_read_b64_tr_b16 v[36:37], v5 offset:0
    ds_read_b64_tr_b16 v[38:39], v5 offset:512
    ds_read_b128 v[228:231], v49
    ds_read_b128 v[232:235], v50
    ds_read_b128 v[236:239], v51
    v_mfma_f32_32x32x16_bf16 v[96:111], v[40:43], v[216:219], v[96:111]
    s_add_u32 s100, s85, 0x4200
    s_add_u32 m0, s84, 0x4000
    s_nop 0
    buffer_load_dwordx4 v30, s[52:55], s100 offen lds
    v_mfma_f32_32x32x16_bf16 v[112:127], v[44:47], v[216:219], v[112:127]
    s_add_u32 m0, s84, 0x6000
    s_nop 0
    buffer_load_dwordx4 v30, s[56:59], s100 offen lds
    ds_read_b64_tr_b16 v[40:41], v4 offset:4096
    ds_read_b64_tr_b16 v[42:43], v4 offset:4608
    ds_read_b64_tr_b16 v[44:45], v5 offset:4096
    ds_read_b64_tr_b16 v[46:47], v5 offset:4608
    v_mfma_f32_32x32x16_bf16 v[96:111], v[80:83], v[220:223], v[96:111]
    s_add_u32 m0, s84, 0x4400
    s_nop 0
    buffer_load_dwordx4 v31, s[52:55], s100 offen lds
    v_mfma_f32_32x32x16_bf16 v[112:127], v[84:87], v[220:223], v[112:127]
    s_add_u32 m0, s84, 0x6400
    s_nop 0
    buffer_load_dwordx4 v31, s[56:59], s100 offen lds
    v_add_u32 v72, 0x14000, v8
    v_add_u32 v76, 0x18000, v2
    v_add_u32 v77, 0x18000, v3
    v_xor_b32 v73, 32, v72
    ds_read_b64_tr_b16 v[80:81], v4 offset:8192
    ds_read_b64_tr_b16 v[82:83], v4 offset:8704
    ds_read_b64_tr_b16 v[84:85], v5 offset:8192
    ds_read_b64_tr_b16 v[86:87], v5 offset:8704
    s_waitcnt lgkmcnt(13)
    v_mfma_f32_32x32x16_bf16 v[96:111], v[32:35], v[224:227], v[96:111]
    s_add_u32 s100, s87, 0x800
    s_add_u32 m0, s86, 0x8000
    s_nop 0
    buffer_load_dwordx4 v28, s[44:47], s100 offen lds
    v_xor_b32 v74, 64, v72
    v_xor_b32 v75, 96, v72
    v_and_b32 v12, 7, v0
    v_xor_b32 v11, v11, v12
    s_waitcnt lgkmcnt(11)
    v_mfma_f32_32x32x16_bf16 v[112:127], v[36:39], v[224:227], v[112:127]
    s_add_u32 m0, s86, 0x8400
    s_nop 0
    buffer_load_dwordx4 v29, s[48:51], s100 offen lds
    v_lshl_add_u32 v27, v11, 4, v10
    v_mov_b32 v15, 0x27b00
    ds_read_b32 v16, v15
    s_waitcnt lgkmcnt(0)
    v_readfirstlane_b32 s26, v16
    ds_read_b64_tr_b16 v[32:33], v4 offset:12288
    ds_read_b64_tr_b16 v[34:35], v4 offset:12800
    ds_read_b64_tr_b16 v[36:37], v5 offset:12288
    ds_read_b64_tr_b16 v[38:39], v5 offset:12800
    v_mfma_f32_32x32x16_bf16 v[96:111], v[40:43], v[228:231], v[96:111]
    s_add_u32 s100, s87, 0x7800
    s_add_u32 m0, s86, 0x8800
    s_nop 0
    buffer_load_dwordx4 v28, s[44:47], s100 offen lds
    v_mfma_f32_32x32x16_bf16 v[112:127], v[44:47], v[228:231], v[112:127]
    s_add_u32 m0, s86, 0x8c00
    s_nop 0
    buffer_load_dwordx4 v29, s[48:51], s100 offen lds
    s_waitcnt vmcnt(24)
    s_waitcnt vmcnt(20)
    s_waitcnt lgkmcnt(0)
    s_barrier
    ds_read_b128 v[240:243], v72
    ds_read_b64_tr_b16 v[40:41], v76 offset:0
    ds_read_b64_tr_b16 v[42:43], v76 offset:512
    ds_read_b64_tr_b16 v[44:45], v77 offset:0
    ds_read_b64_tr_b16 v[46:47], v77 offset:512
    ds_read_b128 v[244:247], v73
    ds_read_b128 v[248:251], v74
    ds_read_b128 v[252:255], v75
    v_mfma_f32_32x32x16_bf16 v[96:111], v[80:83], v[232:235], v[96:111]
    s_add_u32 s100, s87, 0x38800
    s_add_u32 m0, s86, 0xc000
    s_nop 0
    buffer_load_dwordx4 v28, s[44:47], s100 offen lds
    v_mfma_f32_32x32x16_bf16 v[112:127], v[84:87], v[232:235], v[112:127]
    s_add_u32 m0, s86, 0xc400
    s_nop 0
    buffer_load_dwordx4 v29, s[48:51], s100 offen lds
    ds_read_b64_tr_b16 v[80:81], v76 offset:4096
    ds_read_b64_tr_b16 v[82:83], v76 offset:4608
    ds_read_b64_tr_b16 v[84:85], v77 offset:4096
    ds_read_b64_tr_b16 v[86:87], v77 offset:4608
    v_mfma_f32_32x32x16_bf16 v[96:111], v[32:35], v[236:239], v[96:111]
    s_add_u32 s100, s87, 0x3f800
    s_add_u32 m0, s86, 0xc800
    s_nop 0
    buffer_load_dwordx4 v28, s[44:47], s100 offen lds
    v_mfma_f32_32x32x16_bf16 v[112:127], v[36:39], v[236:239], v[112:127]
    s_add_u32 m0, s86, 0xcc00
    s_nop 0
    buffer_load_dwordx4 v29, s[48:51], s100 offen lds
    ds_read_b64_tr_b16 v[32:33], v76 offset:8192
    ds_read_b64_tr_b16 v[34:35], v76 offset:8704
    ds_read_b64_tr_b16 v[36:37], v77 offset:8192
    ds_read_b64_tr_b16 v[38:39], v77 offset:8704
    s_waitcnt lgkmcnt(13)
    v_mfma_f32_32x32x16_bf16 v[96:111], v[40:43], v[240:243], v[96:111]
    s_add_u32 s100, s87, 0x70800
    s_add_u32 m0, s86, 0x10000
    s_nop 0
    buffer_load_dwordx4 v28, s[44:47], s100 offen lds
    s_waitcnt lgkmcnt(11)
    v_mfma_f32_32x32x16_bf16 v[112:127], v[44:47], v[240:243], v[112:127]
    s_add_u32 m0, s86, 0x10400
    s_nop 0
    buffer_load_dwordx4 v29, s[48:51], s100 offen lds
    ds_read_b64_tr_b16 v[40:41], v76 offset:12288
    ds_read_b64_tr_b16 v[42:43], v76 offset:12800
    ds_read_b64_tr_b16 v[44:45], v77 offset:12288
    ds_read_b64_tr_b16 v[46:47], v77 offset:12800
    s_waitcnt lgkmcnt(10)
    v_mfma_f32_32x32x16_bf16 v[96:111], v[80:83], v[244:247], v[96:111]
    s_add_u32 s100, s87, 0x77800
    s_add_u32 m0, s86, 0x10800
    s_nop 0
    buffer_load_dwordx4 v28, s[44:47], s100 offen lds
    s_waitcnt lgkmcnt(8)
    v_mfma_f32_32x32x16_bf16 v[112:127], v[84:87], v[244:247], v[112:127]
    s_add_u32 m0, s86, 0x10c00
    s_nop 0
    buffer_load_dwordx4 v29, s[48:51], s100 offen lds
    s_waitcnt lgkmcnt(6)
    v_mfma_f32_32x32x16_bf16 v[96:111], v[32:35], v[248:251], v[96:111]
    s_waitcnt lgkmcnt(4)
    v_mfma_f32_32x32x16_bf16 v[112:127], v[36:39], v[248:251], v[112:127]
    s_waitcnt lgkmcnt(2)
    v_mfma_f32_32x32x16_bf16 v[96:111], v[40:43], v[252:255], v[96:111]
    s_waitcnt lgkmcnt(0)
    v_mfma_f32_32x32x16_bf16 v[112:127], v[44:47], v[252:255], v[112:127]
    s_waitcnt vmcnt(24)
    s_waitcnt vmcnt(20)
    s_barrier
    s_mov_b32 s7, 0x20000
    v_and_b32 v49, 31, v0
    v_lshrrev_b32 v50, 5, v0
    v_and_b32 v51, 15, v0
    v_xor_b32 v50, v50, v51
    v_lshlrev_b32 v50, 4, v50
    v_lshl_add_u32 v8, v49, 9, v50
    v_add_u32 v48, s7, v8
    v_xor_b32 v49, 0, v48
    ds_read_b128 v[32:35], v49
    v_xor_b32 v50, 32, v48
    ds_read_b128 v[36:39], v50
    v_xor_b32 v49, 64, v48
    ds_read_b128 v[40:43], v49
    v_xor_b32 v50, 96, v48
    ds_read_b128 v[44:47], v50
    s_waitcnt lgkmcnt(3)
    v_mfma_f32_32x32x16_bf16 v[80:95], v[128:131], v[32:35], 0
    s_add_u32 s100, s87, 0xa8800
    s_add_u32 m0, s86, 0x14000
    s_nop 0
    buffer_load_dwordx4 v28, s[44:47], s100 offen lds
    v_xor_b32 v49, 128, v48
    ds_read_b128 v[32:35], v49
    s_waitcnt lgkmcnt(3)
    v_mfma_f32_32x32x16_bf16 v[80:95], v[132:135], v[36:39], v[80:95]
    s_add_u32 m0, s86, 0x14400
    s_nop 0
    buffer_load_dwordx4 v29, s[48:51], s100 offen lds
    v_xor_b32 v50, 160, v48
    ds_read_b128 v[36:39], v50
    s_waitcnt lgkmcnt(3)
    v_mfma_f32_32x32x16_bf16 v[80:95], v[136:139], v[40:43], v[80:95]
    s_add_u32 s100, s87, 0xaf800
    s_add_u32 m0, s86, 0x14800
    s_nop 0
    buffer_load_dwordx4 v28, s[44:47], s100 offen lds
    v_xor_b32 v49, 192, v48
    ds_read_b128 v[40:43], v49
    s_waitcnt lgkmcnt(3)
    v_mfma_f32_32x32x16_bf16 v[80:95], v[140:143], v[44:47], v[80:95]
    s_add_u32 m0, s86, 0x14c00
    s_nop 0
    buffer_load_dwordx4 v29, s[48:51], s100 offen lds
    v_lshlrev_b32 v9, 4, v0
    v_add_u32 v9, s86, v9
    v_lshrrev_b32 v10, 3, v0
    s_lshl_b32 s4, s90, 6
    s_lshl_b32 s5, s92, 4
    s_add_u32 s4, s4, s5
    v_add_u32 v10, s4, v10
    v_xor_b32 v50, 224, v48
    ds_read_b128 v[44:47], v50
    s_waitcnt lgkmcnt(3)
    v_mfma_f32_32x32x16_bf16 v[80:95], v[144:147], v[32:35], v[80:95]
    s_add_u32 s100, s87, 0xe0800
    s_add_u32 m0, s86, 0x18000
    s_nop 0
    buffer_load_dwordx4 v28, s[44:47], s100 offen lds
    v_lshlrev_b32 v10, 10, v10
    v_and_b32 v11, 7, v0
    v_lshl_add_u32 v10, v11, 4, v10
    s_lshl_b32 s4, s91, 7
    v_add_u32 v30, s4, v10
    s_lshl_b32 s6, s93, 9
    s_add_u32 s6, s6, 0x24000
    v_and_b32 v18, 31, v0
    v_lshlrev_b32 v18, 3, v18
    v_add_u32 v18, s6, v18
    ds_read_b64 v[56:57], v18
    v_mov_b32 v58, 0
    v_mov_b32 v59, 0
    v_xor_b32 v49, 256, v48
    ds_read_b128 v[32:35], v49
    s_waitcnt lgkmcnt(4)
    v_mfma_f32_32x32x16_bf16 v[80:95], v[148:151], v[36:39], v[80:95]
    s_add_u32 m0, s86, 0x18400
    s_nop 0
    buffer_load_dwordx4 v29, s[48:51], s100 offen lds
    v_xor_b32 v50, 288, v48
    ds_read_b128 v[36:39], v50
    s_waitcnt lgkmcnt(4)
    v_mfma_f32_32x32x16_bf16 v[80:95], v[152:155], v[40:43], v[80:95]
    s_add_u32 s100, s87, 0xe7800
    s_add_u32 m0, s86, 0x18800
    s_nop 0
    buffer_load_dwordx4 v28, s[44:47], s100 offen lds
    s_lshl_b32 s6, s93, 9
    s_add_u32 s6, s6, 0x24100
    v_and_b32 v18, 31, v0
    v_lshlrev_b32 v18, 3, v18
    v_add_u32 v18, s6, v18
    ds_read_b64 v[60:61], v18
    v_mov_b32 v62, 0
    v_mov_b32 v63, 0
    v_xor_b32 v49, 320, v48
    ds_read_b128 v[40:43], v49
    s_waitcnt lgkmcnt(5)
    v_mfma_f32_32x32x16_bf16 v[80:95], v[156:159], v[44:47], v[80:95]
    s_add_u32 m0, s86, 0x18c00
    s_nop 0
    buffer_load_dwordx4 v29, s[48:51], s100 offen lds
    v_bfe_u32 v10, v0, 2, 1
    v_lshlrev_b32 v10, 4, v10
    v_bfe_u32 v11, v0, 3, 2
    v_xor_b32 v50, 352, v48
    ds_read_b128 v[44:47], v50
    s_waitcnt lgkmcnt(4)
    v_mfma_f32_32x32x16_bf16 v[80:95], v[160:163], v[32:35], v[80:95]
    v_lshl_add_u32 v10, v11, 2, v10
    v_and_b32 v11, 3, v0
    v_add_u32 v10, v10, v11
    s_lshl_b32 s4, s92, 5
    v_add_u32 v10, s4, v10
    v_lshlrev_b32 v10, 2, v10
    v_xor_b32 v49, 384, v48
    ds_read_b128 v[32:35], v49
    s_waitcnt lgkmcnt(4)
    v_mfma_f32_32x32x16_bf16 v[80:95], v[164:167], v[36:39], v[80:95]
    v_add_u32 v10, 0x24a00, v10
    ds_read_b32 v11, v10
    ds_read_b32 v12, v10 offset:512
    v_cmp_gt_u32 vcc, 32, v0
    v_mov_b32 v22, 0
    v_mov_b32 v23, 0
    v_xor_b32 v50, 416, v48
    ds_read_b128 v[36:39], v50
    s_waitcnt lgkmcnt(5)
    v_mfma_f32_32x32x16_bf16 v[80:95], v[168:171], v[40:43], v[80:95]
    s_waitcnt lgkmcnt(2)
    v_sub_f32 v11, 0, v11
    v_cvt_pk_bf16_f32 v20, v11, v11
    s_waitcnt lgkmcnt(1)
    v_mul_f32 v6, 0xbfb8aa3b, v12
    v_mul_f32 v7, v12, v12
    v_and_b32 v13, 0xffff0000, v20
    v_xor_b32 v49, 448, v48
    ds_read_b128 v[40:43], v49
    v_mfma_f32_32x32x16_bf16 v[80:95], v[172:175], v[44:47], v[80:95]
    v_sub_f32 v13, v11, v13
    v_rcp_f32 v7, v7
    v_cvt_pk_bf16_f32 v21, v13, 0
    v_cndmask_b32 v20, 0, v20, vcc
    v_xor_b32 v50, 480, v48
    ds_read_b128 v[44:47], v50
    v_mfma_f32_32x32x16_bf16 v[80:95], v[176:179], v[32:35], v[80:95]
    v_cndmask_b32 v21, 0, v21, vcc
    s_nop 1
    v_mfma_f32_32x32x16_bf16 v[96:111], v[56:59], v[20:23], v[96:111]
    v_mfma_f32_32x32x16_bf16 v[112:127], v[60:63], v[20:23], v[112:127]
    s_waitcnt vmcnt(24)
    s_waitcnt vmcnt(20)
    s_waitcnt lgkmcnt(0)
    s_barrier
    s_mov_b32 s7, 0x4000
    v_add_u32 v48, s7, v8
    v_xor_b32 v49, 0, v48
    ds_read_b128 v[32:35], v49
    v_mfma_f32_32x32x16_bf16 v[80:95], v[180:183], v[36:39], v[80:95]
    s_add_u32 s100, s87, 0x118800
    s_add_u32 m0, s86, 0x1c000
    s_nop 0
    buffer_load_dwordx4 v28, s[44:47], s100 offen lds
    v_xor_b32 v50, 32, v48
    ds_read_b128 v[36:39], v50
    v_mfma_f32_32x32x16_bf16 v[80:95], v[184:187], v[40:43], v[80:95]
    s_add_u32 m0, s86, 0x1c400
    s_nop 0
    buffer_load_dwordx4 v29, s[48:51], s100 offen lds
    v_xor_b32 v49, 64, v48
    ds_read_b128 v[40:43], v49
    v_mfma_f32_32x32x16_bf16 v[80:95], v[188:191], v[44:47], v[80:95]
    s_add_u32 s100, s87, 0x11f800
    s_add_u32 m0, s86, 0x1c800
    s_nop 0
    buffer_load_dwordx4 v28, s[44:47], s100 offen lds
    v_xor_b32 v50, 96, v48
    ds_read_b128 v[44:47], v50
    s_waitcnt lgkmcnt(3)
    v_mfma_f32_32x32x16_bf16 v[80:95], v[192:195], v[32:35], v[80:95]
    s_add_u32 m0, s86, 0x1cc00
    s_nop 0
    buffer_load_dwordx4 v29, s[48:51], s100 offen lds
    s_lshl_b32 s6, s93, 8
    s_add_u32 s6, s6, 0x24800
    v_and_b32 v18, 31, v0
    v_lshlrev_b32 v18, 3, v18
    v_add_u32 v18, s6, v18
    ds_read_b64 v[64:65], v18
    v_mov_b32 v66, 0
    v_mov_b32 v67, 0
    v_xor_b32 v49, 128, v48
    ds_read_b128 v[32:35], v49
    s_waitcnt lgkmcnt(4)
    v_mfma_f32_32x32x16_bf16 v[80:95], v[196:199], v[36:39], v[80:95]
    s_add_u32 s100, s87, 0x150800
    s_add_u32 m0, s86, 0x20000
    s_nop 0
    buffer_load_dwordx4 v28, s[44:47], s100 offen lds
    s_lshl_b32 s4, s89, 2
    s_lshl_b32 s5, s93, 1
    s_add_u32 s4, s4, s5
    s_add_u32 s4, s4, 0
    s_lshl_b32 s4, s4, 10
    s_mul_i32 s5, s88, 0xb0000
    s_add_u32 s4, s4, s5
    s_add_u32 s9, s4, 0x200000
    v_mul_f32 v10, v6, v96
    v_xor_b32 v50, 160, v48
    ds_read_b128 v[36:39], v50
    s_waitcnt lgkmcnt(4)
    v_mfma_f32_32x32x16_bf16 v[80:95], v[200:203], v[40:43], v[80:95]
    s_add_u32 m0, s86, 0x20400
    s_nop 0
    buffer_load_dwordx4 v29, s[48:51], s100 offen lds
    v_mul_f32 v11, v6, v97
    v_mul_f32 v12, v6, v98
    v_mul_f32 v13, v6, v99
    v_exp_f32 v10, v10
    v_xor_b32 v49, 192, v48
    ds_read_b128 v[40:43], v49
    s_waitcnt lgkmcnt(4)
    v_mfma_f32_32x32x16_bf16 v[80:95], v[204:207], v[44:47], v[80:95]
    s_add_u32 s100, s87, 0x157800
    s_add_u32 m0, s86, 0x20800
    s_nop 0
    buffer_load_dwordx4 v28, s[44:47], s100 offen lds
    v_exp_f32 v11, v11
    v_exp_f32 v12, v12
    v_exp_f32 v13, v13
    v_xor_b32 v50, 224, v48
    ds_read_b128 v[44:47], v50
    s_waitcnt lgkmcnt(3)
    v_mfma_f32_32x32x16_bf16 v[80:95], v[208:211], v[32:35], v[80:95]
    s_add_u32 m0, s86, 0x20c00
    s_nop 0
    buffer_load_dwordx4 v29, s[48:51], s100 offen lds
    v_mul_f32 v14, v96, v104
    v_mul_f32 v15, v97, v105
    v_mul_f32 v16, v98, v106
    v_mul_f32 v17, v99, v107
    v_xor_b32 v49, 256, v48
    ds_read_b128 v[32:35], v49
    s_waitcnt lgkmcnt(3)
    v_mfma_f32_32x32x16_bf16 v[80:95], v[212:215], v[36:39], v[80:95]
    v_fma_f32 v10, v10, v7, v7
    v_fma_f32 v11, v11, v7, v7
    v_fma_f32 v12, v12, v7, v7
    v_fma_f32 v13, v13, v7, v7
    v_rcp_f32 v10, v10
    v_xor_b32 v50, 288, v48
    ds_read_b128 v[36:39], v50
    s_waitcnt lgkmcnt(3)
    v_mfma_f32_32x32x16_bf16 v[80:95], v[216:219], v[40:43], v[80:95]
    v_rcp_f32 v11, v11
    v_rcp_f32 v12, v12
    v_xor_b32 v49, 320, v48
    ds_read_b128 v[40:43], v49
    s_waitcnt lgkmcnt(3)
    v_mfma_f32_32x32x16_bf16 v[80:95], v[220:223], v[44:47], v[80:95]
    v_rcp_f32 v13, v13
    v_mul_f32 v14, v14, v10
    v_mul_f32 v15, v15, v11
    v_mul_f32 v16, v16, v12
    v_xor_b32 v50, 352, v48
    ds_read_b128 v[44:47], v50
    s_waitcnt lgkmcnt(3)
    v_mfma_f32_32x32x16_bf16 v[80:95], v[224:227], v[32:35], v[80:95]
    v_mul_f32 v17, v17, v13
    v_cvt_pk_bf16_f32 v96, v14, v15
    v_cvt_pk_bf16_f32 v97, v16, v17
    v_mul_f32 v10, v6, v100
    v_mul_f32 v11, v6, v101
    v_xor_b32 v49, 384, v48
    ds_read_b128 v[32:35], v49
    s_waitcnt lgkmcnt(3)
    v_mfma_f32_32x32x16_bf16 v[80:95], v[228:231], v[36:39], v[80:95]
    v_mul_f32 v12, v6, v102
    v_mul_f32 v13, v6, v103
    v_exp_f32 v10, v10
    v_exp_f32 v11, v11
    v_xor_b32 v50, 416, v48
    ds_read_b128 v[36:39], v50
    s_waitcnt lgkmcnt(3)
    v_mfma_f32_32x32x16_bf16 v[80:95], v[232:235], v[40:43], v[80:95]
    v_exp_f32 v12, v12
    v_exp_f32 v13, v13
    v_xor_b32 v49, 448, v48
    ds_read_b128 v[40:43], v49
    s_waitcnt lgkmcnt(3)
    v_mfma_f32_32x32x16_bf16 v[80:95], v[236:239], v[44:47], v[80:95]
    v_mul_f32 v14, v100, v108
    v_mul_f32 v15, v101, v109
    v_mul_f32 v16, v102, v110
    v_mul_f32 v17, v103, v111
    v_fma_f32 v10, v10, v7, v7
    v_xor_b32 v50, 480, v48
    ds_read_b128 v[44:47], v50
    s_waitcnt lgkmcnt(3)
    v_mfma_f32_32x32x16_bf16 v[80:95], v[240:243], v[32:35], v[80:95]
    v_fma_f32 v11, v11, v7, v7
    v_fma_f32 v12, v12, v7, v7
    v_fma_f32 v13, v13, v7, v7
    v_rcp_f32 v10, v10
    s_waitcnt lgkmcnt(2)
    v_mfma_f32_32x32x16_bf16 v[80:95], v[244:247], v[36:39], v[80:95]
    v_rcp_f32 v11, v11
    v_rcp_f32 v12, v12
    v_rcp_f32 v13, v13
    s_waitcnt lgkmcnt(1)
    v_mfma_f32_32x32x16_bf16 v[80:95], v[248:251], v[40:43], v[80:95]
    v_mul_f32 v14, v14, v10
    v_mul_f32 v15, v15, v11
    v_mul_f32 v16, v16, v12
    v_mul_f32 v17, v17, v13
    s_waitcnt lgkmcnt(0)
    v_mfma_f32_32x32x16_bf16 v[80:95], v[252:255], v[44:47], v[80:95]
    v_cvt_pk_bf16_f32 v98, v14, v15
    v_cvt_pk_bf16_f32 v99, v16, v17
    buffer_store_dwordx4 v[96:99], v1, s[60:63], s9 offen offset:0 sc1
    v_mul_f32 v10, v6, v112
    v_mul_f32 v11, v6, v113
    v_mul_f32 v12, v6, v114
    v_mul_f32 v13, v6, v115
    v_exp_f32 v10, v10
    v_exp_f32 v11, v11
    v_exp_f32 v12, v12
    v_exp_f32 v13, v13
    v_mul_f32 v14, v112, v120
    v_mul_f32 v15, v113, v121
    v_mul_f32 v16, v114, v122
    v_mul_f32 v17, v115, v123
    v_fma_f32 v10, v10, v7, v7
    v_fma_f32 v11, v11, v7, v7
    v_fma_f32 v12, v12, v7, v7
    v_fma_f32 v13, v13, v7, v7
    v_rcp_f32 v10, v10
    v_rcp_f32 v11, v11
    v_rcp_f32 v12, v12
    v_rcp_f32 v13, v13
    v_mul_f32 v14, v14, v10
    v_mul_f32 v15, v15, v11
    v_mul_f32 v16, v16, v12
    v_mul_f32 v17, v17, v13
    v_cvt_pk_bf16_f32 v112, v14, v15
    v_cvt_pk_bf16_f32 v113, v16, v17
    v_mul_f32 v10, v6, v116
    v_mul_f32 v11, v6, v117
    v_mul_f32 v12, v6, v118
    v_mul_f32 v13, v6, v119
    v_exp_f32 v10, v10
    v_exp_f32 v11, v11
    v_exp_f32 v12, v12
    v_exp_f32 v13, v13
    v_mul_f32 v14, v116, v124
    v_mul_f32 v15, v117, v125
    v_mul_f32 v16, v118, v126
    v_mul_f32 v17, v119, v127
    v_fma_f32 v10, v10, v7, v7
    v_fma_f32 v11, v11, v7, v7
    v_fma_f32 v12, v12, v7, v7
    v_fma_f32 v13, v13, v7, v7
    v_rcp_f32 v10, v10
    v_rcp_f32 v11, v11
    v_rcp_f32 v12, v12
    v_rcp_f32 v13, v13
    v_mul_f32 v14, v14, v10
    v_mul_f32 v15, v15, v11
    v_mul_f32 v16, v16, v12
    v_mul_f32 v17, v17, v13
    v_cvt_pk_bf16_f32 v114, v14, v15
    v_cvt_pk_bf16_f32 v115, v16, v17
    buffer_store_dwordx4 v[112:115], v1, s[60:63], s9 offen offset:1024 sc1
    v_mfma_f32_32x32x16_bf16 v[80:95], v[20:23], v[64:67], v[80:95]
    s_waitcnt vmcnt(26)
    s_waitcnt vmcnt(22)
    s_barrier
    v_add_u32 v4, 0x8000, v2
    v_add_u32 v5, 0x8000, v3
    ds_read_b64_tr_b16 v[32:33], v4 offset:0
    ds_read_b64_tr_b16 v[34:35], v4 offset:512
    ds_read_b64_tr_b16 v[36:37], v5 offset:0
    ds_read_b64_tr_b16 v[38:39], v5 offset:512
    ds_read_b64_tr_b16 v[40:41], v4 offset:4096
    ds_read_b64_tr_b16 v[42:43], v4 offset:4608
    ds_read_b64_tr_b16 v[44:45], v5 offset:4096
    ds_read_b64_tr_b16 v[46:47], v5 offset:4608
    s_waitcnt lgkmcnt(6)
    v_mfma_f32_32x32x16_bf16 v[48:63], v[32:35], v[128:131], 0
    s_add_u32 s100, s87, 0x188800
    s_add_u32 m0, s86, 0x0
    s_nop 0
    buffer_load_dwordx4 v28, s[44:47], s100 offen lds
    s_waitcnt lgkmcnt(4)
    v_mfma_f32_32x32x16_bf16 v[64:79], v[36:39], v[128:131], 0
    s_add_u32 m0, s86, 0x400
    s_nop 0
    buffer_load_dwordx4 v29, s[48:51], s100 offen lds
    ds_read_b64_tr_b16 v[32:33], v4 offset:8192
    ds_read_b64_tr_b16 v[34:35], v4 offset:8704
    ds_read_b64_tr_b16 v[36:37], v5 offset:8192
    ds_read_b64_tr_b16 v[38:39], v5 offset:8704
    s_waitcnt lgkmcnt(6)
    v_mfma_f32_32x32x16_bf16 v[48:63], v[40:43], v[132:135], v[48:63]
    s_add_u32 s100, s87, 0x18f800
    s_add_u32 m0, s86, 0x800
    s_nop 0
    buffer_load_dwordx4 v28, s[44:47], s100 offen lds
    s_waitcnt lgkmcnt(4)
    v_mfma_f32_32x32x16_bf16 v[64:79], v[44:47], v[132:135], v[64:79]
    s_add_u32 m0, s86, 0xc00
    s_nop 0
    buffer_load_dwordx4 v29, s[48:51], s100 offen lds
    v_and_b32 v10, 15, v0
    s_lshl_b32 s4, s93, 4
    v_add_u32 v10, s4, v10
    v_lshlrev_b32 v10, 6, v10
    v_add_u32 v10, 0x24e00, v10
    ds_read_b64_tr_b16 v[40:41], v4 offset:12288
    ds_read_b64_tr_b16 v[42:43], v4 offset:12800
    ds_read_b64_tr_b16 v[44:45], v5 offset:12288
    ds_read_b64_tr_b16 v[46:47], v5 offset:12800
    v_add_u32 v4, 0xc000, v2
    v_add_u32 v5, 0xc000, v3
    ds_read_b64_tr_b16 v[128:129], v4 offset:0
    ds_read_b64_tr_b16 v[130:131], v4 offset:512
    ds_read_b64_tr_b16 v[132:133], v5 offset:0
    ds_read_b64_tr_b16 v[134:135], v5 offset:512
    s_waitcnt lgkmcnt(10)
    v_mfma_f32_32x32x16_bf16 v[48:63], v[32:35], v[136:139], v[48:63]
    s_mov_b32 s100, 0x0
    s_add_u32 m0, s86, 0x4000
    s_nop 0
    buffer_load_dwordx4 v25, s[64:67], s100 offen lds
    v_lshrrev_b32 v11, 4, v0
    v_lshlrev_b32 v11, 5, v11
    s_lshl_b32 s4, s92, 7
    s_add_u32 s4, s4, 0x24c00
    v_add_u32 v11, s4, v11
    s_waitcnt lgkmcnt(8)
    v_mfma_f32_32x32x16_bf16 v[64:79], v[36:39], v[136:139], v[64:79]
    s_mov_b32 s100, 0x2000
    s_add_u32 m0, s86, 0x4400
    s_nop 0
    buffer_load_dwordx4 v25, s[64:67], s100 offen lds
    ds_read_b128 v[108:111], v11
    ds_read_b128 v[112:115], v11 offset:16
    ds_read_b128 v[96:99], v10
    ds_read_b128 v[100:103], v10 offset:16
    ds_read_b128 v[104:107], v10 offset:32
    v_permlane16_swap_b32 v80, v88
    ds_read_b64_tr_b16 v[32:33], v4 offset:4096
    ds_read_b64_tr_b16 v[34:35], v4 offset:4608
    ds_read_b64_tr_b16 v[36:37], v5 offset:4096
    ds_read_b64_tr_b16 v[38:39], v5 offset:4608
    s_waitcnt lgkmcnt(15)
    v_mfma_f32_32x32x16_bf16 v[48:63], v[40:43], v[140:143], v[48:63]
    s_mov_b32 s100, 0x4000
    s_add_u32 m0, s86, 0x4800
    s_nop 0
    buffer_load_dwordx4 v25, s[64:67], s100 offen lds
    v_permlane16_swap_b32 v81, v89
    v_permlane16_swap_b32 v82, v90
    v_permlane16_swap_b32 v83, v91
    v_permlane16_swap_b32 v84, v92
    s_waitcnt lgkmcnt(13)
    v_mfma_f32_32x32x16_bf16 v[64:79], v[44:47], v[140:143], v[64:79]
    s_mov_b32 s100, 0x6000
    s_add_u32 m0, s86, 0x4c00
    s_nop 0
    buffer_load_dwordx4 v25, s[64:67], s100 offen lds
    v_permlane16_swap_b32 v85, v93
    v_permlane16_swap_b32 v86, v94
    v_permlane16_swap_b32 v87, v95
    s_waitcnt lgkmcnt(8)
    v_mul_f32 v80, v108, v80
    ds_read_b64_tr_b16 v[40:41], v4 offset:8192
    ds_read_b64_tr_b16 v[42:43], v4 offset:8704
    ds_read_b64_tr_b16 v[44:45], v5 offset:8192
    ds_read_b64_tr_b16 v[46:47], v5 offset:8704
    v_mfma_f32_32x32x16_bf16 v[48:63], v[128:131], v[144:147], v[48:63]
    v_mul_f32 v88, v108, v88
    v_mul_f32 v81, v109, v81
    v_mul_f32 v89, v109, v89
    v_mul_f32 v82, v110, v82
    v_mfma_f32_32x32x16_bf16 v[64:79], v[132:135], v[144:147], v[64:79]
    v_mul_f32 v90, v110, v90
    v_mul_f32 v83, v111, v83
    v_mul_f32 v91, v111, v91
    s_waitcnt lgkmcnt(11)
    v_mul_f32 v84, v112, v84
    ds_read_b64_tr_b16 v[128:129], v4 offset:12288
    ds_read_b64_tr_b16 v[130:131], v4 offset:12800
    ds_read_b64_tr_b16 v[132:133], v5 offset:12288
    ds_read_b64_tr_b16 v[134:135], v5 offset:12800
    s_waitcnt lgkmcnt(10)
    v_mfma_f32_32x32x16_bf16 v[48:63], v[32:35], v[148:151], v[48:63]
    v_mul_f32 v92, v112, v92
    v_mul_f32 v85, v113, v85
    v_mul_f32 v93, v113, v93
    v_mul_f32 v86, v114, v86
    s_waitcnt lgkmcnt(8)
    v_mfma_f32_32x32x16_bf16 v[64:79], v[36:39], v[148:151], v[64:79]
    v_mul_f32 v94, v114, v94
    v_mul_f32 v87, v115, v87
    v_mul_f32 v95, v115, v95
    v_fma_f32 v118, v98, v80, v81
    v_fma_f32 v119, v98, v88, v89
    v_fma_f32 v118, -v99, v88, v118
    v_fma_f32 v119, v99, v80, v119
    v_fma_f32 v120, v98, v118, v82
    v_fma_f32 v121, v98, v119, v90
    v_fma_f32 v120, -v99, v119, v120
    v_fma_f32 v121, v99, v118, v121
    v_fma_f32 v118, v98, v120, v83
    v_fma_f32 v119, v98, v121, v91
    v_fma_f32 v118, -v99, v121, v118
    v_fma_f32 v119, v99, v120, v119
    v_fma_f32 v120, v98, v118, v84
    v_fma_f32 v121, v98, v119, v92
    v_fma_f32 v120, -v99, v119, v120
    v_fma_f32 v121, v99, v118, v121
    v_fma_f32 v118, v98, v120, v85
    v_fma_f32 v119, v98, v121, v93
    v_fma_f32 v118, -v99, v121, v118
    v_fma_f32 v119, v99, v120, v119
    v_fma_f32 v120, v98, v118, v86
    v_fma_f32 v121, v98, v119, v94
    v_fma_f32 v120, -v99, v119, v120
    v_fma_f32 v121, v99, v118, v121
    v_fma_f32 v118, v98, v120, v87
    v_fma_f32 v119, v98, v121, v95
    v_fma_f32 v118, -v99, v121, v118
    v_fma_f32 v119, v99, v120, v119
    v_mov_b32 v120, v118
    v_mov_b32 v122, v118
    v_mov_b32 v121, v119
    v_mov_b32 v123, v119
    v_bfe_u32 v12, v0, 4, 1
    v_cmp_eq_u32 vcc, 1, v12
    v_permlane16_swap_b32 v120, v122
    v_permlane16_swap_b32 v121, v123
    v_lshrrev_b32 v12, 4, v0
    v_and_b32 v10, 15, v0
    v_lshlrev_b32 v10, 5, v10
    v_fma_f32 v118, v102, v120, v122
    v_fma_f32 v119, v102, v121, v123
    v_fma_f32 v118, -v103, v121, v118
    v_fma_f32 v119, v103, v120, v119
    v_cndmask_b32 v116, 0, v120, vcc
    v_cndmask_b32 v117, 0, v121, vcc
    v_mov_b32 v124, v118
    v_mov_b32 v126, v118
    v_mov_b32 v125, v119
    v_mov_b32 v127, v119
    s_lshl_b32 s4, s93, 9
    s_lshl_b32 s5, s92, 3
    s_add_u32 s4, s4, s5
    s_add_u32 s4, s4, 0x25600
    v_permlane32_swap_b32 v124, v126
    v_permlane32_swap_b32 v125, v127
    v_add_u32 v10, s4, v10
    v_fma_f32 v126, v104, v124, v126
    v_fma_f32 v127, v104, v125, v127
    v_fma_f32 v126, -v105, v125, v126
    v_fma_f32 v127, v105, v124, v127
    ds_write_b64 v10, v[126:127]
    v_fma_f32 v120, v102, v124, v116
    v_fma_f32 v121, v102, v125, v117
    v_fma_f32 v120, -v103, v125, v120
    v_fma_f32 v121, v103, v124, v121
    v_add_f32 v122, v124, v116
    v_add_f32 v123, v125, v117
    v_cmp_eq_u32 vcc, 2, v12
    s_nop 1
    v_cndmask_b32 v116, v116, v122, vcc
    v_cndmask_b32 v117, v117, v123, vcc
    v_cmp_eq_u32 vcc, 3, v12
    s_nop 1
    v_cndmask_b32 v116, v116, v120, vcc
    v_cndmask_b32 v117, v117, v121, vcc
    s_waitcnt vmcnt(8)
    s_waitcnt lgkmcnt(0)
    s_barrier
    v_add_u32 v4, 0x10000, v2
    v_add_u32 v5, 0x10000, v3
    ds_read_b64_tr_b16 v[32:33], v4 offset:0
    ds_read_b64_tr_b16 v[34:35], v4 offset:512
    ds_read_b64_tr_b16 v[36:37], v5 offset:0
    ds_read_b64_tr_b16 v[38:39], v5 offset:512
    v_mfma_f32_32x32x16_bf16 v[48:63], v[40:43], v[152:155], v[48:63]
    s_mov_b32 s100, 0x20000
    s_add_u32 m0, s86, 0x8000
    s_nop 0
    buffer_load_dwordx4 v25, s[64:67], s100 offen lds
    v_mfma_f32_32x32x16_bf16 v[64:79], v[44:47], v[152:155], v[64:79]
    s_mov_b32 s100, 0x22000
    s_add_u32 m0, s86, 0x8400
    s_nop 0
    buffer_load_dwordx4 v25, s[64:67], s100 offen lds
    ds_read_b64_tr_b16 v[40:41], v4 offset:4096
    ds_read_b64_tr_b16 v[42:43], v4 offset:4608
    ds_read_b64_tr_b16 v[44:45], v5 offset:4096
    ds_read_b64_tr_b16 v[46:47], v5 offset:4608
    v_mfma_f32_32x32x16_bf16 v[48:63], v[128:131], v[156:159], v[48:63]
    s_mov_b32 s100, 0x24000
    s_add_u32 m0, s86, 0x8800
    s_nop 0
    buffer_load_dwordx4 v25, s[64:67], s100 offen lds
    v_mfma_f32_32x32x16_bf16 v[64:79], v[132:135], v[156:159], v[64:79]
    s_mov_b32 s100, 0x26000
    s_add_u32 m0, s86, 0x8c00
    s_nop 0
    buffer_load_dwordx4 v25, s[64:67], s100 offen lds
    v_and_b32 v10, 15, v0
    v_lshlrev_b32 v10, 5, v10
    s_lshl_b32 s4, s93, 9
    s_add_u32 s4, s4, 0x25600
    v_add_u32 v10, s4, v10
    ds_read_b128 v[108:111], v10
    ds_read_b64_tr_b16 v[128:129], v4 offset:8192
    ds_read_b64_tr_b16 v[130:131], v4 offset:8704
    ds_read_b64_tr_b16 v[132:133], v5 offset:8192
    ds_read_b64_tr_b16 v[134:135], v5 offset:8704
    s_waitcnt lgkmcnt(11)
    v_mfma_f32_32x32x16_bf16 v[48:63], v[32:35], v[160:163], v[48:63]
    ds_read_b128 v[112:115], v10 offset:16
    s_lshl_b32 s4, s89, 13
    s_lshl_b32 s5, s88, 9
    s_add_u32 s4, s4, s5
    s_lshl_b32 s5, s93, 8
    s_add_u32 s4, s4, s5
    s_add_u32 s4, s4, 0x10000
    s_cmp_eq_u32 s92, 0
    s_cselect_b32 s4, s4, 0x7ff00000
    s_waitcnt lgkmcnt(10)
    v_mfma_f32_32x32x16_bf16 v[64:79], v[36:39], v[160:163], v[64:79]
    v_lshlrev_b32 v11, 4, v0
    v_mov_b32 v12, 0x7ff00000
    v_cmp_gt_u32 vcc, 16, v0
    s_nop 1
    v_cndmask_b32 v11, v12, v11, vcc
    ds_read_b64_tr_b16 v[32:33], v4 offset:12288
    ds_read_b64_tr_b16 v[34:35], v4 offset:12800
    ds_read_b64_tr_b16 v[36:37], v5 offset:12288
    ds_read_b64_tr_b16 v[38:39], v5 offset:12800
    s_waitcnt lgkmcnt(12)
    v_mfma_f32_32x32x16_bf16 v[48:63], v[40:43], v[164:167], v[48:63]
    v_add_u32 v11, s4, v11
    v_mov_b32 v125, s26
    v_mov_b32 v127, s26
    s_waitcnt lgkmcnt(9)
    v_fma_f32 v110, v106, v108, v110
    v_mfma_f32_32x32x16_bf16 v[64:79], v[44:47], v[164:167], v[64:79]
    v_fma_f32 v111, v106, v109, v111
    v_fma_f32 v110, -v107, v109, v110
    v_fma_f32 v111, v107, v108, v111
    s_waitcnt lgkmcnt(4)
    v_fma_f32 v112, v106, v110, v112
    v_add_u32 v4, 0x14000, v2
    v_add_u32 v5, 0x14000, v3
    ds_read_b64_tr_b16 v[40:41], v4 offset:0
    ds_read_b64_tr_b16 v[42:43], v4 offset:512
    ds_read_b64_tr_b16 v[44:45], v5 offset:0
    ds_read_b64_tr_b16 v[46:47], v5 offset:512
    v_mfma_f32_32x32x16_bf16 v[48:63], v[128:131], v[168:171], v[48:63]
    v_fma_f32 v113, v106, v111, v113
    v_fma_f32 v112, -v107, v111, v112
    v_fma_f32 v113, v107, v110, v113
    v_fma_f32 v114, v106, v112, v114
    v_mfma_f32_32x32x16_bf16 v[64:79], v[132:135], v[168:171], v[64:79]
    v_fma_f32 v115, v106, v113, v115
    v_fma_f32 v114, -v107, v113, v114
    v_fma_f32 v115, v107, v112, v115
    v_mov_b32 v124, v114
    ds_read_b64_tr_b16 v[128:129], v4 offset:4096
    ds_read_b64_tr_b16 v[130:131], v4 offset:4608
    ds_read_b64_tr_b16 v[132:133], v5 offset:4096
    ds_read_b64_tr_b16 v[134:135], v5 offset:4608
    s_waitcnt lgkmcnt(10)
    v_mfma_f32_32x32x16_bf16 v[48:63], v[32:35], v[172:175], v[48:63]
    v_mov_b32 v126, v115
    buffer_store_dwordx4 v[124:127], v11, s[60:63], 0 offen sc0 sc1
    v_mov_b32 v118, 0
    v_mov_b32 v119, 0
    s_waitcnt lgkmcnt(8)
    v_mfma_f32_32x32x16_bf16 v[64:79], v[36:39], v[172:175], v[64:79]
    s_cmp_eq_u32 s92, 1
    s_cselect_b64 s[98:99], -1, 0
    v_cndmask_b32 v118, v118, v108, s[98:99]
    v_cndmask_b32 v119, v119, v109, s[98:99]
    s_cmp_eq_u32 s92, 2
    s_cselect_b64 s[98:99], -1, 0
    v_cndmask_b32 v118, v118, v110, s[98:99]
    ds_read_b64_tr_b16 v[32:33], v4 offset:8192
    ds_read_b64_tr_b16 v[34:35], v4 offset:8704
    ds_read_b64_tr_b16 v[36:37], v5 offset:8192
    ds_read_b64_tr_b16 v[38:39], v5 offset:8704
    s_waitcnt lgkmcnt(10)
    v_mfma_f32_32x32x16_bf16 v[48:63], v[40:43], v[176:179], v[48:63]
    v_cndmask_b32 v119, v119, v111, s[98:99]
    s_cmp_eq_u32 s92, 3
    s_cselect_b64 s[98:99], -1, 0
    v_cndmask_b32 v118, v118, v112, s[98:99]
    v_cndmask_b32 v119, v119, v113, s[98:99]
    s_waitcnt lgkmcnt(8)
    v_mfma_f32_32x32x16_bf16 v[64:79], v[44:47], v[176:179], v[64:79]
    v_lshrrev_b32 v11, 4, v0
    v_lshlrev_b32 v11, 3, v11
    v_cvt_f32_u32 v12, v11
    s_lshl_b32 s4, s92, 5
    v_add_u32 v11, s4, v11
    ds_read_b64_tr_b16 v[40:41], v4 offset:12288
    ds_read_b64_tr_b16 v[42:43], v4 offset:12800
    ds_read_b64_tr_b16 v[44:45], v5 offset:12288
    ds_read_b64_tr_b16 v[46:47], v5 offset:12800
    s_waitcnt lgkmcnt(10)
    v_mfma_f32_32x32x16_bf16 v[48:63], v[128:131], v[180:183], v[48:63]
    v_cvt_f32_u32 v13, v11
    v_mul_f32 v14, v12, v96
    v_mul_f32 v121, v12, v97
    v_exp_f32 v14, v14
    s_waitcnt lgkmcnt(8)
    v_mfma_f32_32x32x16_bf16 v[64:79], v[132:135], v[180:183], v[64:79]
    v_fract_f32 v121, v121
    v_cos_f32 v120, v121
    s_waitcnt lgkmcnt(0)
    s_barrier
    v_add_u32 v4, 0x18000, v2
    v_add_u32 v5, 0x18000, v3
    ds_read_b64_tr_b16 v[128:129], v4 offset:0
    ds_read_b64_tr_b16 v[130:131], v4 offset:512
    ds_read_b64_tr_b16 v[132:133], v5 offset:0
    ds_read_b64_tr_b16 v[134:135], v5 offset:512
    v_mfma_f32_32x32x16_bf16 v[48:63], v[32:35], v[184:187], v[48:63]
    s_mov_b32 s100, 0x40000
    s_add_u32 m0, s86, 0xc000
    s_nop 0
    buffer_load_dwordx4 v25, s[64:67], s100 offen lds
    v_mfma_f32_32x32x16_bf16 v[64:79], v[36:39], v[184:187], v[64:79]
    s_mov_b32 s100, 0x42000
    s_add_u32 m0, s86, 0xc400
    s_nop 0
    buffer_load_dwordx4 v25, s[64:67], s100 offen lds
    ds_read_b64_tr_b16 v[32:33], v4 offset:4096
    ds_read_b64_tr_b16 v[34:35], v4 offset:4608
    ds_read_b64_tr_b16 v[36:37], v5 offset:4096
    ds_read_b64_tr_b16 v[38:39], v5 offset:4608
    v_mfma_f32_32x32x16_bf16 v[48:63], v[40:43], v[188:191], v[48:63]
    s_mov_b32 s100, 0x44000
    s_add_u32 m0, s86, 0xc800
    s_nop 0
    buffer_load_dwordx4 v25, s[64:67], s100 offen lds
    v_mfma_f32_32x32x16_bf16 v[64:79], v[44:47], v[188:191], v[64:79]
    s_mov_b32 s100, 0x46000
    s_add_u32 m0, s86, 0xcc00
    s_nop 0
    buffer_load_dwordx4 v25, s[64:67], s100 offen lds
    v_sin_f32 v121, v121
    s_nop 0
    v_mul_f32 v120, v120, v14
    v_mul_f32 v121, v121, v14
    ds_read_b64_tr_b16 v[40:41], v4 offset:8192
    ds_read_b64_tr_b16 v[42:43], v4 offset:8704
    ds_read_b64_tr_b16 v[44:45], v5 offset:8192
    ds_read_b64_tr_b16 v[46:47], v5 offset:8704
    s_waitcnt lgkmcnt(10)
    v_mfma_f32_32x32x16_bf16 v[48:63], v[128:131], v[192:195], v[48:63]
    v_fma_f32 v116, v120, v118, v116
    v_fma_f32 v117, v120, v119, v117
    v_fma_f32 v116, -v121, v119, v116
    v_fma_f32 v117, v121, v118, v117
    s_waitcnt lgkmcnt(8)
    v_mfma_f32_32x32x16_bf16 v[64:79], v[132:135], v[192:195], v[64:79]
    v_mul_f32 v14, v13, v96
    v_mul_f32 v121, v13, v97
    v_exp_f32 v14, v14
    ds_read_b64_tr_b16 v[128:129], v4 offset:12288
    ds_read_b64_tr_b16 v[130:131], v4 offset:12800
    ds_read_b64_tr_b16 v[132:133], v5 offset:12288
    ds_read_b64_tr_b16 v[134:135], v5 offset:12800
    s_waitcnt lgkmcnt(10)
    v_mfma_f32_32x32x16_bf16 v[48:63], v[32:35], v[196:199], v[48:63]
    v_fract_f32 v121, v121
    v_cos_f32 v120, v121
    v_sin_f32 v121, v121
    s_waitcnt lgkmcnt(8)
    v_mfma_f32_32x32x16_bf16 v[64:79], v[36:39], v[196:199], v[64:79]
    s_nop 0
    v_mul_f32 v120, v120, v14
    v_mul_f32 v121, v121, v14
    v_add_u32 v4, 0x1c000, v2
    v_add_u32 v5, 0x1c000, v3
    ds_read_b64_tr_b16 v[32:33], v4 offset:0
    ds_read_b64_tr_b16 v[34:35], v4 offset:512
    ds_read_b64_tr_b16 v[36:37], v5 offset:0
    ds_read_b64_tr_b16 v[38:39], v5 offset:512
    s_waitcnt lgkmcnt(10)
    v_mfma_f32_32x32x16_bf16 v[48:63], v[40:43], v[200:203], v[48:63]
    v_mul_f32 v122, v120, v100
    v_mul_f32 v123, v120, v101
    v_fma_f32 v122, -v121, v101, v122
    v_fma_f32 v123, v121, v100, v123
    s_waitcnt lgkmcnt(8)
    v_mfma_f32_32x32x16_bf16 v[64:79], v[44:47], v[200:203], v[64:79]
    v_mul_f32 v120, v116, v100
    v_mul_f32 v121, v116, v101
    v_fma_f32 v120, -v117, v101, v120
    v_fma_f32 v121, v117, v100, v121
    ds_read_b64_tr_b16 v[40:41], v4 offset:4096
    ds_read_b64_tr_b16 v[42:43], v4 offset:4608
    ds_read_b64_tr_b16 v[44:45], v5 offset:4096
    ds_read_b64_tr_b16 v[46:47], v5 offset:4608
    s_waitcnt lgkmcnt(10)
    v_mfma_f32_32x32x16_bf16 v[48:63], v[128:131], v[204:207], v[48:63]
    v_mov_b32 v116, v120
    v_mov_b32 v117, v121
    v_mul_f32 v12, v100, v80
    v_mul_f32 v13, v101, v80
    s_waitcnt lgkmcnt(8)
    v_mfma_f32_32x32x16_bf16 v[64:79], v[132:135], v[204:207], v[64:79]
    v_fma_f32 v80, -v101, v88, v12
    v_fma_f32 v88, v100, v88, v13
    v_mul_f32 v10, v100, v81
    v_mul_f32 v11, v101, v81
    ds_read_b64_tr_b16 v[128:129], v4 offset:8192
    ds_read_b64_tr_b16 v[130:131], v4 offset:8704
    ds_read_b64_tr_b16 v[132:133], v5 offset:8192
    ds_read_b64_tr_b16 v[134:135], v5 offset:8704
    s_waitcnt lgkmcnt(10)
    v_mfma_f32_32x32x16_bf16 v[48:63], v[32:35], v[208:211], v[48:63]
    v_fma_f32 v81, -v101, v89, v10
    v_fma_f32 v89, v100, v89, v11
    v_mul_f32 v12, v100, v82
    v_mul_f32 v13, v101, v82
    s_waitcnt lgkmcnt(8)
    v_mfma_f32_32x32x16_bf16 v[64:79], v[36:39], v[208:211], v[64:79]
    v_fma_f32 v82, -v101, v90, v12
    v_fma_f32 v90, v100, v90, v13
    v_mul_f32 v10, v100, v83
    v_mul_f32 v11, v101, v83
    ds_read_b64_tr_b16 v[32:33], v4 offset:12288
    ds_read_b64_tr_b16 v[34:35], v4 offset:12800
    ds_read_b64_tr_b16 v[36:37], v5 offset:12288
    ds_read_b64_tr_b16 v[38:39], v5 offset:12800
    s_waitcnt lgkmcnt(10)
    v_mfma_f32_32x32x16_bf16 v[48:63], v[40:43], v[212:215], v[48:63]
    v_fma_f32 v83, -v101, v91, v10
    v_fma_f32 v91, v100, v91, v11
    v_mul_f32 v12, v100, v84
    v_mul_f32 v13, v101, v84
    s_waitcnt lgkmcnt(8)
    v_mfma_f32_32x32x16_bf16 v[64:79], v[44:47], v[212:215], v[64:79]
    v_fma_f32 v84, -v101, v92, v12
    v_fma_f32 v92, v100, v92, v13
    v_mul_f32 v10, v100, v85
    v_mul_f32 v11, v101, v85
    s_waitcnt vmcnt(13)
    s_waitcnt lgkmcnt(0)
    s_barrier
    v_add_u32 v4, 0x20000, v2
    v_add_u32 v5, 0x20000, v3
    ds_read_b64_tr_b16 v[40:41], v4 offset:0
    ds_read_b64_tr_b16 v[42:43], v4 offset:512
    ds_read_b64_tr_b16 v[44:45], v5 offset:0
    ds_read_b64_tr_b16 v[46:47], v5 offset:512
    v_mfma_f32_32x32x16_bf16 v[48:63], v[128:131], v[216:219], v[48:63]
    s_add_u32 s100, s83, 0x0
    s_add_u32 m0, s86, 0x10000
    s_nop 0
    buffer_load_dwordx4 v24, s[60:63], s100 offen offset:0 sc1 lds
    v_mfma_f32_32x32x16_bf16 v[64:79], v[132:135], v[216:219], v[64:79]
    buffer_load_dwordx4 v24, s[60:63], s100 offen offset:1024 sc1 lds
    ds_read_b64_tr_b16 v[128:129], v4 offset:4096
    ds_read_b64_tr_b16 v[130:131], v4 offset:4608
    ds_read_b64_tr_b16 v[132:133], v5 offset:4096
    ds_read_b64_tr_b16 v[134:135], v5 offset:4608
    v_mfma_f32_32x32x16_bf16 v[48:63], v[32:35], v[220:223], v[48:63]
    buffer_load_dwordx4 v24, s[60:63], s100 offen offset:2048 sc1 lds
    v_mfma_f32_32x32x16_bf16 v[64:79], v[36:39], v[220:223], v[64:79]
    buffer_load_dwordx4 v24, s[60:63], s100 offen offset:3072 sc1 lds
    v_fma_f32 v85, -v101, v93, v10
    v_fma_f32 v93, v100, v93, v11
    v_mul_f32 v12, v100, v86
    v_mul_f32 v13, v101, v86
    ds_read_b64_tr_b16 v[32:33], v4 offset:8192
    ds_read_b64_tr_b16 v[34:35], v4 offset:8704
    ds_read_b64_tr_b16 v[36:37], v5 offset:8192
    ds_read_b64_tr_b16 v[38:39], v5 offset:8704
    s_waitcnt lgkmcnt(10)
    v_mfma_f32_32x32x16_bf16 v[48:63], v[40:43], v[224:227], v[48:63]
    s_add_u32 s100, s83, 0x2000
    s_add_u32 m0, s86, 0x14000
    s_nop 0
    buffer_load_dwordx4 v24, s[60:63], s100 offen offset:0 sc1 lds
    v_fma_f32 v86, -v101, v94, v12
    v_fma_f32 v94, v100, v94, v13
    v_mul_f32 v10, v100, v87
    v_mul_f32 v11, v101, v87
    s_waitcnt lgkmcnt(8)
    v_mfma_f32_32x32x16_bf16 v[64:79], v[44:47], v[224:227], v[64:79]
    buffer_load_dwordx4 v24, s[60:63], s100 offen offset:1024 sc1 lds
    v_fma_f32 v87, -v101, v95, v10
    v_fma_f32 v95, v100, v95, v11
    s_lshl_b32 s4, s93, 2
    s_add_u32 s4, s4, s92
    s_lshl_b32 s4, s4, 10
    s_add_u32 s4, s4, 0x25b00
    v_and_b32 v10, 15, v0
    ds_read_b64_tr_b16 v[40:41], v4 offset:12288
    ds_read_b64_tr_b16 v[42:43], v4 offset:12800
    ds_read_b64_tr_b16 v[44:45], v5 offset:12288
    ds_read_b64_tr_b16 v[46:47], v5 offset:12800
    s_waitcnt lgkmcnt(10)
    v_mfma_f32_32x32x16_bf16 v[48:63], v[128:131], v[228:231], v[48:63]
    buffer_load_dwordx4 v24, s[60:63], s100 offen offset:2048 sc1 lds
    v_lshlrev_b32 v10, 6, v10
    v_lshrrev_b32 v11, 4, v0
    v_lshl_add_u32 v10, v11, 4, v10
    v_add_u32 v124, s4, v10
    s_waitcnt lgkmcnt(8)
    v_mfma_f32_32x32x16_bf16 v[64:79], v[132:135], v[228:231], v[64:79]
    buffer_load_dwordx4 v24, s[60:63], s100 offen offset:3072 sc1 lds
    v_lshrrev_b32 v11, 5, v0
    v_lshlrev_b32 v11, 9, v11
    v_bfe_u32 v12, v0, 2, 2
    v_lshl_add_u32 v11, v12, 6, v11
    v_add_u32 v4, 0x0, v2
    v_add_u32 v5, 0x0, v3
    ds_read_b64_tr_b16 v[128:129], v4 offset:0
    ds_read_b64_tr_b16 v[130:131], v4 offset:512
    ds_read_b64_tr_b16 v[132:133], v5 offset:0
    ds_read_b64_tr_b16 v[134:135], v5 offset:512
    s_waitcnt lgkmcnt(10)
    v_mfma_f32_32x32x16_bf16 v[48:63], v[32:35], v[232:235], v[48:63]
    s_add_u32 s100, s83, 0x4000
    s_add_u32 m0, s86, 0x18000
    s_nop 0
    buffer_load_dwordx4 v24, s[60:63], s100 offen offset:0 sc1 lds
    v_and_b32 v12, 1, v0
    v_lshl_add_u32 v11, v12, 5, v11
    v_bfe_u32 v12, v0, 4, 1
    v_lshl_add_u32 v11, v12, 4, v11
    s_waitcnt lgkmcnt(8)
    v_mfma_f32_32x32x16_bf16 v[64:79], v[36:39], v[232:235], v[64:79]
    buffer_load_dwordx4 v24, s[60:63], s100 offen offset:1024 sc1 lds
    v_bfe_u32 v12, v0, 1, 1
    v_lshl_add_u32 v11, v12, 3, v11
    v_add_u32 v125, s4, v11
    s_lshl_b32 s4, s89, 1
    s_add_u32 s4, s4, s93
    ds_read_b64_tr_b16 v[32:33], v4 offset:4096
    ds_read_b64_tr_b16 v[34:35], v4 offset:4608
    ds_read_b64_tr_b16 v[36:37], v5 offset:4096
    ds_read_b64_tr_b16 v[38:39], v5 offset:4608
    s_waitcnt lgkmcnt(10)
    v_mfma_f32_32x32x16_bf16 v[48:63], v[40:43], v[236:239], v[48:63]
    buffer_load_dwordx4 v24, s[60:63], s100 offen offset:2048 sc1 lds
    s_lshr_b32 s5, s4, 2
    s_lshl_b32 s5, s5, 3
    s_and_b32 s4, s4, 3
    s_add_u32 s4, s4, s5
    s_add_u32 s4, s4, 64
    s_lshl_b32 s4, s4, 10
    s_mul_i32 s5, s88, 0xb0000
    s_add_u32 s4, s4, s5
    s_add_u32 s27, s4, 0x200000
    s_add_u32 s8, s27, 4096
    s_waitcnt lgkmcnt(8)
    v_mfma_f32_32x32x16_bf16 v[64:79], v[44:47], v[236:239], v[64:79]
    buffer_load_dwordx4 v24, s[60:63], s100 offen offset:3072 sc1 lds
    v_and_b32 v10, 15, v0
    s_lshl_b32 s4, s93, 4
    v_add_u32 v10, s4, v10
    v_lshlrev_b32 v10, 3, v10
    v_add_u32 v126, 0x25a00, v10
    ds_read_b64_tr_b16 v[40:41], v4 offset:8192
    ds_read_b64_tr_b16 v[42:43], v4 offset:8704
    ds_read_b64_tr_b16 v[44:45], v5 offset:8192
    ds_read_b64_tr_b16 v[46:47], v5 offset:8704
    s_waitcnt lgkmcnt(10)
    v_mfma_f32_32x32x16_bf16 v[48:63], v[128:131], v[240:243], v[48:63]
    s_mov_b32 s100, 0x60000
    s_add_u32 m0, s86, 0x1c000
    s_nop 0
    buffer_load_dwordx4 v25, s[64:67], s100 offen lds
    s_waitcnt lgkmcnt(8)
    v_mfma_f32_32x32x16_bf16 v[64:79], v[132:135], v[240:243], v[64:79]
    s_mov_b32 s100, 0x62000
    s_add_u32 m0, s86, 0x1c400
    s_nop 0
    buffer_load_dwordx4 v25, s[64:67], s100 offen lds
    ds_read_b64_tr_b16 v[128:129], v4 offset:12288
    ds_read_b64_tr_b16 v[130:131], v4 offset:12800
    ds_read_b64_tr_b16 v[132:133], v5 offset:12288
    ds_read_b64_tr_b16 v[134:135], v5 offset:12800
    s_waitcnt lgkmcnt(10)
    v_mfma_f32_32x32x16_bf16 v[48:63], v[32:35], v[244:247], v[48:63]
    s_mov_b32 s100, 0x64000
    s_add_u32 m0, s86, 0x1c800
    s_nop 0
    buffer_load_dwordx4 v25, s[64:67], s100 offen lds
    s_waitcnt lgkmcnt(8)
    v_mfma_f32_32x32x16_bf16 v[64:79], v[36:39], v[244:247], v[64:79]
    s_mov_b32 s100, 0x66000
    s_add_u32 m0, s86, 0x1cc00
    s_nop 0
    buffer_load_dwordx4 v25, s[64:67], s100 offen lds
    s_waitcnt lgkmcnt(6)
    v_mfma_f32_32x32x16_bf16 v[48:63], v[40:43], v[248:251], v[48:63]
    s_waitcnt lgkmcnt(4)
    v_mfma_f32_32x32x16_bf16 v[64:79], v[44:47], v[248:251], v[64:79]
    s_waitcnt lgkmcnt(2)
    v_mfma_f32_32x32x16_bf16 v[48:63], v[128:131], v[252:255], v[48:63]
    s_waitcnt lgkmcnt(0)
    v_mfma_f32_32x32x16_bf16 v[64:79], v[132:135], v[252:255], v[64:79]
    s_lshl_b32 s6, s93, 9
    s_add_u32 s6, s6, 0x24400
    v_and_b32 v18, 31, v0
    v_lshlrev_b32 v18, 3, v18
    v_add_u32 v18, s6, v18
    ds_read_b64 v[136:137], v18
    v_mov_b32 v138, 0
    v_mov_b32 v139, 0
    s_lshl_b32 s6, s93, 9
    s_add_u32 s6, s6, 0x24500
    v_and_b32 v18, 31, v0
    v_lshlrev_b32 v18, 3, v18
    v_add_u32 v18, s6, v18
    ds_read_b64 v[140:141], v18
    v_mov_b32 v142, 0
    v_mov_b32 v143, 0
    s_waitcnt lgkmcnt(1)
    v_mfma_f32_32x32x16_bf16 v[48:63], v[136:139], v[20:23], v[48:63]
    s_waitcnt lgkmcnt(0)
    v_mfma_f32_32x32x16_bf16 v[64:79], v[140:143], v[20:23], v[64:79]
    s_barrier
    ds_read_b64 v[108:109], v126
    s_waitcnt lgkmcnt(0)
    v_fma_f32 v116, v122, v108, v116
    v_fma_f32 v117, v122, v109, v117
    v_fma_f32 v116, -v123, v109, v116
    v_fma_f32 v117, v123, v108, v117
    v_fma_f32 v80, v98, v116, v80
    v_fma_f32 v88, v98, v117, v88
    v_fma_f32 v80, -v99, v117, v80
    v_fma_f32 v88, v99, v116, v88
    v_fma_f32 v81, v98, v80, v81
    v_fma_f32 v89, v98, v88, v89
    v_fma_f32 v81, -v99, v88, v81
    v_fma_f32 v89, v99, v80, v89
    v_fma_f32 v82, v98, v81, v82
    v_fma_f32 v90, v98, v89, v90
    v_fma_f32 v82, -v99, v89, v82
    v_fma_f32 v90, v99, v81, v90
    v_fma_f32 v83, v98, v82, v83
    v_fma_f32 v91, v98, v90, v91
    v_fma_f32 v83, -v99, v90, v83
    v_fma_f32 v91, v99, v82, v91
    v_fma_f32 v84, v98, v83, v84
    v_fma_f32 v92, v98, v91, v92
    v_fma_f32 v84, -v99, v91, v84
    v_fma_f32 v92, v99, v83, v92
    v_fma_f32 v85, v98, v84, v85
    v_fma_f32 v93, v98, v92, v93
    v_fma_f32 v85, -v99, v92, v85
    v_fma_f32 v93, v99, v84, v93
    v_fma_f32 v86, v98, v85, v86
    v_fma_f32 v94, v98, v93, v94
    v_fma_f32 v86, -v99, v93, v86
    v_fma_f32 v94, v99, v85, v94
    v_fma_f32 v87, v98, v86, v87
    v_fma_f32 v95, v98, v94, v95
    v_fma_f32 v87, -v99, v94, v87
    v_fma_f32 v95, v99, v86, v95
    v_cvt_pk_bf16_f32 v108, v80, v81
    v_cvt_pk_bf16_f32 v109, v82, v83
    v_cvt_pk_bf16_f32 v110, v84, v85
    v_cvt_pk_bf16_f32 v111, v86, v87
    ds_write_b128 v124, v[108:111]
    ds_read_b64_tr_b16 v[96:97], v125 offset:0
    ds_read_b64_tr_b16 v[98:99], v125 offset:256
    v_cvt_pk_bf16_f32 v112, -v88, -v89
    v_cvt_pk_bf16_f32 v113, -v90, -v91
    v_cvt_pk_bf16_f32 v114, -v92, -v93
    v_cvt_pk_bf16_f32 v115, -v94, -v95
    ds_write_b128 v124, v[112:115]
    ds_read_b64_tr_b16 v[100:101], v125 offset:0
    ds_read_b64_tr_b16 v[102:103], v125 offset:256
    s_waitcnt lgkmcnt(3)
    buffer_store_dwordx4 v[96:99], v1, s[60:63], s27 offen sc1
    s_waitcnt lgkmcnt(0)
    buffer_store_dwordx4 v[100:103], v1, s[60:63], s8 offen sc1
    s_add_u32 s100, s83, 0x6000
    s_add_u32 m0, s86, 0x20000
    s_nop 0
    buffer_load_dwordx4 v24, s[60:63], s100 offen offset:0 sc1 lds
    buffer_load_dwordx4 v24, s[60:63], s100 offen offset:1024 sc1 lds
    buffer_load_dwordx4 v24, s[60:63], s100 offen offset:2048 sc1 lds
    buffer_load_dwordx4 v24, s[60:63], s100 offen offset:3072 sc1 lds
    s_mov_b32 s100, 0x80000
    s_add_u32 m0, s86, 0x0
    s_nop 0
    buffer_load_dwordx4 v25, s[64:67], s100 offen lds
    s_mov_b32 s100, 0x82000
    s_add_u32 m0, s86, 0x400
    s_nop 0
    buffer_load_dwordx4 v25, s[64:67], s100 offen lds
    s_mov_b32 s100, 0x84000
    s_add_u32 m0, s86, 0x800
    s_nop 0
    buffer_load_dwordx4 v25, s[64:67], s100 offen lds
    s_mov_b32 s100, 0x86000
    s_add_u32 m0, s86, 0xc00
    s_nop 0
    buffer_load_dwordx4 v25, s[64:67], s100 offen lds
    s_waitcnt vmcnt(35)
    s_waitcnt vmcnt(22)
    s_barrier
    s_mov_b32 s100, 0
    s_add_u32 m0, s84, 0x25b00
    s_nop 0
    buffer_load_dwordx4 v30, s[40:43], s100 offen lds
    s_mov_b32 s100, 8192
    s_add_u32 m0, s84, 0x25f00
    s_nop 0
    buffer_load_dwordx4 v30, s[40:43], s100 offen lds
    s_lshl_b32 s4, s89, 2
    s_lshl_b32 s5, s93, 1
    s_add_u32 s4, s4, s5
    s_add_u32 s4, s4, 128
    s_lshl_b32 s4, s4, 10
    s_mul_i32 s5, s88, 0xb0000
    s_add_u32 s4, s4, s5
    s_add_u32 s9, s4, 0x200000
    v_mul_f32 v10, v6, v48
    v_mul_f32 v11, v6, v49
    s_waitcnt vmcnt(10)
    s_barrier
    s_add_u32 s100, s83, 0x8000
    s_add_u32 m0, s86, 0x4000
    s_nop 0
    buffer_load_dwordx4 v24, s[60:63], s100 offen offset:0 sc1 lds
    buffer_load_dwordx4 v24, s[60:63], s100 offen offset:1024 sc1 lds
    buffer_load_dwordx4 v24, s[60:63], s100 offen offset:2048 sc1 lds
    buffer_load_dwordx4 v24, s[60:63], s100 offen offset:3072 sc1 lds
    v_mul_f32 v12, v6, v50
    v_mul_f32 v13, v6, v51
    v_exp_f32 v10, v10
    v_exp_f32 v11, v11
    s_mov_b32 s100, 0xa0000
    s_add_u32 m0, s86, 0x10000
    s_nop 0
    buffer_load_dwordx4 v25, s[64:67], s100 offen lds
    v_exp_f32 v12, v12
    v_exp_f32 v13, v13
    s_mov_b32 s100, 0xa2000
    s_add_u32 m0, s86, 0x10400
    s_nop 0
    buffer_load_dwordx4 v25, s[64:67], s100 offen lds
    v_mul_f32 v14, v48, v56
    v_mul_f32 v15, v49, v57
    v_mul_f32 v16, v50, v58
    v_mul_f32 v17, v51, v59
    v_fma_f32 v10, v10, v7, v7
    s_mov_b32 s100, 0xa4000
    s_add_u32 m0, s86, 0x10800
    s_nop 0
    buffer_load_dwordx4 v25, s[64:67], s100 offen lds
    v_fma_f32 v11, v11, v7, v7
    v_fma_f32 v12, v12, v7, v7
    v_fma_f32 v13, v13, v7, v7
    v_rcp_f32 v10, v10
    s_mov_b32 s100, 0xa6000
    s_add_u32 m0, s86, 0x10c00
    s_nop 0
    buffer_load_dwordx4 v25, s[64:67], s100 offen lds
    v_rcp_f32 v11, v11
    v_rcp_f32 v12, v12
    v_rcp_f32 v13, v13
    v_mul_f32 v14, v14, v10
    v_mul_f32 v15, v15, v11
    v_mul_f32 v16, v16, v12
    v_mul_f32 v17, v17, v13
    v_cvt_pk_bf16_f32 v48, v14, v15
    v_cvt_pk_bf16_f32 v49, v16, v17
    v_mul_f32 v10, v6, v52
    v_mul_f32 v11, v6, v53
    v_mul_f32 v12, v6, v54
    s_barrier
    s_add_u32 s100, s83, 0xa000
    s_add_u32 m0, s86, 0x8000
    s_nop 0
    buffer_load_dwordx4 v24, s[60:63], s100 offen offset:0 sc1 lds
    buffer_load_dwordx4 v24, s[60:63], s100 offen offset:1024 sc1 lds
    buffer_load_dwordx4 v24, s[60:63], s100 offen offset:2048 sc1 lds
    buffer_load_dwordx4 v24, s[60:63], s100 offen offset:3072 sc1 lds
    v_mul_f32 v13, v6, v55
    v_exp_f32 v10, v10
    v_exp_f32 v11, v11
    s_mov_b32 s100, 0xc0000
    s_add_u32 m0, s86, 0x14000
    s_nop 0
    buffer_load_dwordx4 v25, s[64:67], s100 offen lds
    v_exp_f32 v12, v12
    v_exp_f32 v13, v13
    v_mul_f32 v14, v52, v60
    s_mov_b32 s100, 0xc2000
    s_add_u32 m0, s86, 0x14400
    s_nop 0
    buffer_load_dwordx4 v25, s[64:67], s100 offen lds
    v_mul_f32 v15, v53, v61
    v_mul_f32 v16, v54, v62
    v_mul_f32 v17, v55, v63
    v_fma_f32 v10, v10, v7, v7
    v_fma_f32 v11, v11, v7, v7
    s_mov_b32 s100, 0xc4000
    s_add_u32 m0, s86, 0x14800
    s_nop 0
    buffer_load_dwordx4 v25, s[64:67], s100 offen lds
    v_fma_f32 v12, v12, v7, v7
    v_fma_f32 v13, v13, v7, v7
    v_rcp_f32 v10, v10
    v_rcp_f32 v11, v11
    s_mov_b32 s100, 0xc6000
    s_add_u32 m0, s86, 0x14c00
    s_nop 0
    buffer_load_dwordx4 v25, s[64:67], s100 offen lds
    v_rcp_f32 v12, v12
    v_rcp_f32 v13, v13
    v_mul_f32 v14, v14, v10
    v_mul_f32 v15, v15, v11
    v_mul_f32 v16, v16, v12
    v_mul_f32 v17, v17, v13
    v_cvt_pk_bf16_f32 v50, v14, v15
    v_cvt_pk_bf16_f32 v51, v16, v17
    buffer_store_dwordx4 v[48:51], v1, s[60:63], s9 offen offset:0 sc1
    v_mul_f32 v10, v6, v64
    v_mul_f32 v11, v6, v65
    v_mul_f32 v12, v6, v66
    s_waitcnt vmcnt(23)
    s_barrier
    s_add_u32 s100, s83, 0xc000
    s_add_u32 m0, s86, 0xc000
    s_nop 0
    buffer_load_dwordx4 v24, s[60:63], s100 offen offset:0 sc1 lds
    buffer_load_dwordx4 v24, s[60:63], s100 offen offset:1024 sc1 lds
    buffer_load_dwordx4 v24, s[60:63], s100 offen offset:2048 sc1 lds
    buffer_load_dwordx4 v24, s[60:63], s100 offen offset:3072 sc1 lds
    v_mul_f32 v13, v6, v67
    v_exp_f32 v10, v10
    v_exp_f32 v11, v11
    s_mov_b32 s100, 0xe0000
    s_add_u32 m0, s86, 0x18000
    s_nop 0
    buffer_load_dwordx4 v25, s[64:67], s100 offen lds
    v_exp_f32 v12, v12
    v_exp_f32 v13, v13
    v_mul_f32 v14, v64, v72
    s_mov_b32 s100, 0xe2000
    s_add_u32 m0, s86, 0x18400
    s_nop 0
    buffer_load_dwordx4 v25, s[64:67], s100 offen lds
    v_mul_f32 v15, v65, v73
    v_mul_f32 v16, v66, v74
    v_mul_f32 v17, v67, v75
    v_fma_f32 v10, v10, v7, v7
    v_fma_f32 v11, v11, v7, v7
    s_mov_b32 s100, 0xe4000
    s_add_u32 m0, s86, 0x18800
    s_nop 0
    buffer_load_dwordx4 v25, s[64:67], s100 offen lds
    v_fma_f32 v12, v12, v7, v7
    v_fma_f32 v13, v13, v7, v7
    v_rcp_f32 v10, v10
    v_rcp_f32 v11, v11
    s_mov_b32 s100, 0xe6000
    s_add_u32 m0, s86, 0x18c00
    s_nop 0
    buffer_load_dwordx4 v25, s[64:67], s100 offen lds
    v_rcp_f32 v12, v12
    v_rcp_f32 v13, v13
    v_mul_f32 v14, v14, v10
    v_mul_f32 v15, v15, v11
    v_mul_f32 v16, v16, v12
    v_mul_f32 v17, v17, v13
    v_cvt_pk_bf16_f32 v64, v14, v15
    v_cvt_pk_bf16_f32 v65, v16, v17
    v_mul_f32 v10, v6, v68
    v_mul_f32 v11, v6, v69
    v_mul_f32 v12, v6, v70
    v_mul_f32 v13, v6, v71
    s_waitcnt vmcnt(27)
    s_waitcnt vmcnt(21)
    s_barrier
    s_add_u32 s100, s83, 0xe000
    s_add_u32 m0, s86, 0x1c000
    s_nop 0
    buffer_load_dwordx4 v24, s[60:63], s100 offen offset:0 sc1 lds
    buffer_load_dwordx4 v24, s[60:63], s100 offen offset:1024 sc1 lds
    buffer_load_dwordx4 v24, s[60:63], s100 offen offset:2048 sc1 lds
    buffer_load_dwordx4 v24, s[60:63], s100 offen offset:3072 sc1 lds
    v_exp_f32 v10, v10
    v_exp_f32 v11, v11
    v_exp_f32 v12, v12
    s_mov_b32 s100, 0
    s_add_u32 m0, s84, 0x20000
    s_nop 0
    buffer_load_dwordx4 v26, s[68:71], s100 offen lds
    v_exp_f32 v13, v13
    v_mul_f32 v14, v68, v76
    v_mul_f32 v15, v69, v77
    s_add_u32 m0, s84, 0x22000
    s_nop 0
    buffer_load_dwordx4 v26, s[72:75], s100 offen lds
    v_mul_f32 v16, v70, v78
    v_mul_f32 v17, v71, v79
    v_fma_f32 v10, v10, v7, v7
    v_fma_f32 v11, v11, v7, v7
    v_fma_f32 v12, v12, v7, v7
    s_add_u32 m0, s84, 0x20400
    s_nop 0
    buffer_load_dwordx4 v27, s[68:71], s100 offen lds
    v_fma_f32 v13, v13, v7, v7
    v_rcp_f32 v10, v10
    v_rcp_f32 v11, v11
    s_add_u32 m0, s84, 0x22400
    s_nop 0
    buffer_load_dwordx4 v27, s[72:75], s100 offen lds
    v_rcp_f32 v12, v12
    v_rcp_f32 v13, v13
    v_mul_f32 v14, v14, v10
    v_mul_f32 v15, v15, v11
    v_mul_f32 v16, v16, v12
    v_mul_f32 v17, v17, v13
    v_cvt_pk_bf16_f32 v66, v14, v15
    v_cvt_pk_bf16_f32 v67, v16, v17
    buffer_store_dwordx4 v[64:67], v1, s[60:63], s9 offen offset:1024 sc1
    s_waitcnt vmcnt(26)
    s_waitcnt vmcnt(22)
    s_barrier
    s_add_u32 s100, s83, 0x10000
    s_add_u32 m0, s86, 0x0
    s_nop 0
    buffer_load_dwordx4 v24, s[60:63], s100 offen offset:0 sc1 lds
    buffer_load_dwordx4 v24, s[60:63], s100 offen offset:1024 sc1 lds
    buffer_load_dwordx4 v24, s[60:63], s100 offen offset:2048 sc1 lds
    buffer_load_dwordx4 v24, s[60:63], s100 offen offset:3072 sc1 lds
    s_mov_b32 s100, 128
    s_add_u32 m0, s84, 0x4000
    s_nop 0
    buffer_load_dwordx4 v26, s[68:71], s100 offen lds
    s_add_u32 m0, s84, 0x6000
    s_nop 0
    buffer_load_dwordx4 v26, s[72:75], s100 offen lds
    s_add_u32 m0, s84, 0x4400
    s_nop 0
    buffer_load_dwordx4 v27, s[68:71], s100 offen lds
    s_add_u32 m0, s84, 0x6400
    s_nop 0
    buffer_load_dwordx4 v27, s[72:75], s100 offen lds
    s_waitcnt vmcnt(26)
    s_waitcnt vmcnt(21)
    s_barrier
    s_add_u32 s100, s83, 0x12000
    s_add_u32 m0, s86, 0x10000
    s_nop 0
    buffer_load_dwordx4 v24, s[60:63], s100 offen offset:0 sc1 lds
    buffer_load_dwordx4 v24, s[60:63], s100 offen offset:1024 sc1 lds
    buffer_load_dwordx4 v24, s[60:63], s100 offen offset:2048 sc1 lds
    buffer_load_dwordx4 v24, s[60:63], s100 offen offset:3072 sc1 lds
    s_mov_b32 s100, 256
    s_add_u32 m0, s84, 0x8000
    s_nop 0
    buffer_load_dwordx4 v26, s[68:71], s100 offen lds
    s_add_u32 m0, s84, 0xa000
    s_nop 0
    buffer_load_dwordx4 v26, s[72:75], s100 offen lds
    s_add_u32 m0, s84, 0x8400
    s_nop 0
    buffer_load_dwordx4 v27, s[68:71], s100 offen lds
    s_add_u32 m0, s84, 0xa400
    s_nop 0
    buffer_load_dwordx4 v27, s[72:75], s100 offen lds
    s_waitcnt vmcnt(25)
    s_waitcnt vmcnt(21)
    s_barrier
    s_add_u32 s100, s83, 0x14000
    s_add_u32 m0, s86, 0x14000
    s_nop 0
    buffer_load_dwordx4 v24, s[60:63], s100 offen offset:0 sc1 lds
    buffer_load_dwordx4 v24, s[60:63], s100 offen offset:1024 sc1 lds
    buffer_load_dwordx4 v24, s[60:63], s100 offen offset:2048 sc1 lds
    buffer_load_dwordx4 v24, s[60:63], s100 offen offset:3072 sc1 lds
    s_mov_b32 s100, 384
    s_add_u32 m0, s84, 0xc000
    s_nop 0
    buffer_load_dwordx4 v26, s[68:71], s100 offen lds
    s_add_u32 m0, s84, 0xe000
    s_nop 0
    buffer_load_dwordx4 v26, s[72:75], s100 offen lds
    s_add_u32 m0, s84, 0xc400
    s_nop 0
    buffer_load_dwordx4 v27, s[68:71], s100 offen lds
    s_add_u32 m0, s84, 0xe400
    s_nop 0
    buffer_load_dwordx4 v27, s[72:75], s100 offen lds
    s_waitcnt vmcnt(24)
    s_waitcnt vmcnt(20)
    s_barrier
    s_add_u32 s100, s83, 0x16000
    s_add_u32 m0, s86, 0x18000
    s_nop 0
    buffer_load_dwordx4 v24, s[60:63], s100 offen offset:0 sc1 lds
    buffer_load_dwordx4 v24, s[60:63], s100 offen offset:1024 sc1 lds
    buffer_load_dwordx4 v24, s[60:63], s100 offen offset:2048 sc1 lds
    buffer_load_dwordx4 v24, s[60:63], s100 offen offset:3072 sc1 lds
    s_mov_b32 s100, 512
    s_add_u32 m0, s84, 0x1c000
    s_nop 0
    buffer_load_dwordx4 v26, s[68:71], s100 offen lds
    s_add_u32 m0, s84, 0x1e000
    s_nop 0
    buffer_load_dwordx4 v26, s[72:75], s100 offen lds
    s_add_u32 m0, s84, 0x1c400
    s_nop 0
    buffer_load_dwordx4 v27, s[68:71], s100 offen lds
    s_add_u32 m0, s84, 0x1e400
    s_nop 0
    buffer_load_dwordx4 v27, s[72:75], s100 offen lds
    s_waitcnt vmcnt(24)
    s_waitcnt vmcnt(20)
    s_barrier
    s_add_u32 s100, s83, 0x18000
    s_add_u32 m0, s86, 0x20000
    s_nop 0
    buffer_load_dwordx4 v24, s[60:63], s100 offen offset:0 sc1 lds
    buffer_load_dwordx4 v24, s[60:63], s100 offen offset:1024 sc1 lds
    buffer_load_dwordx4 v24, s[60:63], s100 offen offset:2048 sc1 lds
    buffer_load_dwordx4 v24, s[60:63], s100 offen offset:3072 sc1 lds
    s_mov_b32 s100, 640
    s_add_u32 m0, s84, 0x0
    s_nop 0
    buffer_load_dwordx4 v26, s[68:71], s100 offen lds
    s_add_u32 m0, s84, 0x2000
    s_nop 0
    buffer_load_dwordx4 v26, s[72:75], s100 offen lds
    s_add_u32 m0, s84, 0x400
    s_nop 0
    buffer_load_dwordx4 v27, s[68:71], s100 offen lds
    s_add_u32 m0, s84, 0x2400
    s_nop 0
    buffer_load_dwordx4 v27, s[72:75], s100 offen lds
    s_waitcnt vmcnt(24)
    s_waitcnt vmcnt(20)
    s_barrier
    s_add_u32 s100, s83, 0x1a000
    s_add_u32 m0, s86, 0x4000
    s_nop 0
    buffer_load_dwordx4 v24, s[60:63], s100 offen offset:0 sc1 lds
    buffer_load_dwordx4 v24, s[60:63], s100 offen offset:1024 sc1 lds
    buffer_load_dwordx4 v24, s[60:63], s100 offen offset:2048 sc1 lds
    buffer_load_dwordx4 v24, s[60:63], s100 offen offset:3072 sc1 lds
    s_mov_b32 s100, 768
    s_add_u32 m0, s84, 0x10000
    s_nop 0
    buffer_load_dwordx4 v26, s[68:71], s100 offen lds
    s_add_u32 m0, s84, 0x12000
    s_nop 0
    buffer_load_dwordx4 v26, s[72:75], s100 offen lds
    s_add_u32 m0, s84, 0x10400
    s_nop 0
    buffer_load_dwordx4 v27, s[68:71], s100 offen lds
    s_add_u32 m0, s84, 0x12400
    s_nop 0
    buffer_load_dwordx4 v27, s[72:75], s100 offen lds
    s_waitcnt vmcnt(24)
    s_waitcnt vmcnt(20)
    s_barrier
    s_add_u32 s100, s83, 0x1c000
    s_add_u32 m0, s86, 0x8000
    s_nop 0
    buffer_load_dwordx4 v24, s[60:63], s100 offen offset:0 sc1 lds
    buffer_load_dwordx4 v24, s[60:63], s100 offen offset:1024 sc1 lds
    buffer_load_dwordx4 v24, s[60:63], s100 offen offset:2048 sc1 lds
    buffer_load_dwordx4 v24, s[60:63], s100 offen offset:3072 sc1 lds
    s_mov_b32 s100, 896
    s_add_u32 m0, s84, 0x14000
    s_nop 0
    buffer_load_dwordx4 v26, s[68:71], s100 offen lds
    s_add_u32 m0, s84, 0x16000
    s_nop 0
    buffer_load_dwordx4 v26, s[72:75], s100 offen lds
    s_add_u32 m0, s84, 0x14400
    s_nop 0
    buffer_load_dwordx4 v27, s[68:71], s100 offen lds
    s_add_u32 m0, s84, 0x16400
    s_nop 0
    buffer_load_dwordx4 v27, s[72:75], s100 offen lds
    s_waitcnt vmcnt(24)
    s_waitcnt vmcnt(20)
    s_barrier
    s_add_u32 s100, s83, 0x1e000
    s_add_u32 m0, s86, 0xc000
    s_nop 0
    buffer_load_dwordx4 v24, s[60:63], s100 offen offset:0 sc1 lds
    buffer_load_dwordx4 v24, s[60:63], s100 offen offset:1024 sc1 lds
    buffer_load_dwordx4 v24, s[60:63], s100 offen offset:2048 sc1 lds
    buffer_load_dwordx4 v24, s[60:63], s100 offen offset:3072 sc1 lds
    s_mov_b32 s100, 0x100000
    s_add_u32 m0, s86, 0x18000
    s_nop 0
    buffer_load_dwordx4 v25, s[64:67], s100 offen lds
    s_mov_b32 s100, 0x102000
    s_add_u32 m0, s86, 0x18400
    s_nop 0
    buffer_load_dwordx4 v25, s[64:67], s100 offen lds
    s_mov_b32 s100, 0x104000
    s_add_u32 m0, s86, 0x18800
    s_nop 0
    buffer_load_dwordx4 v25, s[64:67], s100 offen lds
    s_mov_b32 s100, 0x106000
    s_add_u32 m0, s86, 0x18c00
    s_nop 0
    buffer_load_dwordx4 v25, s[64:67], s100 offen lds
    s_waitcnt vmcnt(24)
    s_waitcnt vmcnt(20)
    s_barrier
    s_add_u32 s100, s83, 0x20000
    s_add_u32 m0, s86, 0x1c000
    s_nop 0
    buffer_load_dwordx4 v24, s[60:63], s100 offen offset:0 sc1 lds
    buffer_load_dwordx4 v24, s[60:63], s100 offen offset:1024 sc1 lds
    buffer_load_dwordx4 v24, s[60:63], s100 offen offset:2048 sc1 lds
    buffer_load_dwordx4 v24, s[60:63], s100 offen offset:3072 sc1 lds
    s_mov_b32 s100, 0x120000
    s_add_u32 m0, s86, 0x20000
    s_nop 0
    buffer_load_dwordx4 v25, s[64:67], s100 offen lds
    s_mov_b32 s100, 0x122000
    s_add_u32 m0, s86, 0x20400
    s_nop 0
    buffer_load_dwordx4 v25, s[64:67], s100 offen lds
    s_mov_b32 s100, 0x124000
    s_add_u32 m0, s86, 0x20800
    s_nop 0
    buffer_load_dwordx4 v25, s[64:67], s100 offen lds
    s_mov_b32 s100, 0x126000
    s_add_u32 m0, s86, 0x20c00
    s_nop 0
    buffer_load_dwordx4 v25, s[64:67], s100 offen lds
    s_waitcnt vmcnt(24)
    s_waitcnt vmcnt(20)
    s_barrier
    s_add_u32 s100, s83, 0x22000
    s_add_u32 m0, s86, 0x0
    s_nop 0
    buffer_load_dwordx4 v24, s[60:63], s100 offen offset:0 sc1 lds
    buffer_load_dwordx4 v24, s[60:63], s100 offen offset:1024 sc1 lds
    buffer_load_dwordx4 v24, s[60:63], s100 offen offset:2048 sc1 lds
    buffer_load_dwordx4 v24, s[60:63], s100 offen offset:3072 sc1 lds
    s_mov_b32 s100, 0x140000
    s_add_u32 m0, s86, 0x4000
    s_nop 0
    buffer_load_dwordx4 v25, s[64:67], s100 offen lds
    s_mov_b32 s100, 0x142000
    s_add_u32 m0, s86, 0x4400
    s_nop 0
    buffer_load_dwordx4 v25, s[64:67], s100 offen lds
    s_mov_b32 s100, 0x144000
    s_add_u32 m0, s86, 0x4800
    s_nop 0
    buffer_load_dwordx4 v25, s[64:67], s100 offen lds
    s_mov_b32 s100, 0x146000
    s_add_u32 m0, s86, 0x4c00
    s_nop 0
    buffer_load_dwordx4 v25, s[64:67], s100 offen lds
    s_waitcnt vmcnt(24)
    s_waitcnt vmcnt(20)
    s_barrier
    s_add_u32 s100, s83, 0x24000
    s_add_u32 m0, s86, 0x10000
    s_nop 0
    buffer_load_dwordx4 v24, s[60:63], s100 offen offset:0 sc1 lds
    buffer_load_dwordx4 v24, s[60:63], s100 offen offset:1024 sc1 lds
    buffer_load_dwordx4 v24, s[60:63], s100 offen offset:2048 sc1 lds
    buffer_load_dwordx4 v24, s[60:63], s100 offen offset:3072 sc1 lds
    s_mov_b32 s100, 0x160000
    s_add_u32 m0, s86, 0x8000
    s_nop 0
    buffer_load_dwordx4 v25, s[64:67], s100 offen lds
    s_mov_b32 s100, 0x162000
    s_add_u32 m0, s86, 0x8400
    s_nop 0
    buffer_load_dwordx4 v25, s[64:67], s100 offen lds
    s_mov_b32 s100, 0x164000
    s_add_u32 m0, s86, 0x8800
    s_nop 0
    buffer_load_dwordx4 v25, s[64:67], s100 offen lds
    s_mov_b32 s100, 0x166000
    s_add_u32 m0, s86, 0x8c00
    s_nop 0
    buffer_load_dwordx4 v25, s[64:67], s100 offen lds
    s_waitcnt vmcnt(24)
    s_waitcnt vmcnt(20)
    s_barrier
    s_add_u32 s100, s83, 0x26000
    s_add_u32 m0, s86, 0x14000
    s_nop 0
    buffer_load_dwordx4 v24, s[60:63], s100 offen offset:0 sc1 lds
    buffer_load_dwordx4 v24, s[60:63], s100 offen offset:1024 sc1 lds
    buffer_load_dwordx4 v24, s[60:63], s100 offen offset:2048 sc1 lds
    buffer_load_dwordx4 v24, s[60:63], s100 offen offset:3072 sc1 lds
    s_mov_b32 s100, 0x180000
    s_add_u32 m0, s86, 0xc000
    s_nop 0
    buffer_load_dwordx4 v25, s[64:67], s100 offen lds
    s_mov_b32 s100, 0x182000
    s_add_u32 m0, s86, 0xc400
    s_nop 0
    buffer_load_dwordx4 v25, s[64:67], s100 offen lds
    s_mov_b32 s100, 0x184000
    s_add_u32 m0, s86, 0xc800
    s_nop 0
    buffer_load_dwordx4 v25, s[64:67], s100 offen lds
    s_mov_b32 s100, 0x186000
    s_add_u32 m0, s86, 0xcc00
    s_nop 0
    buffer_load_dwordx4 v25, s[64:67], s100 offen lds
    s_waitcnt vmcnt(24)
    s_waitcnt vmcnt(20)
    s_barrier
    s_add_u32 s100, s83, 0x28000
    s_add_u32 m0, s86, 0x18000
    s_nop 0
    buffer_load_dwordx4 v24, s[60:63], s100 offen offset:0 sc1 lds
    buffer_load_dwordx4 v24, s[60:63], s100 offen offset:1024 sc1 lds
    buffer_load_dwordx4 v24, s[60:63], s100 offen offset:2048 sc1 lds
    buffer_load_dwordx4 v24, s[60:63], s100 offen offset:3072 sc1 lds
    s_mov_b32 s100, 0x1a0000
    s_add_u32 m0, s86, 0x1c000
    s_nop 0
    buffer_load_dwordx4 v25, s[64:67], s100 offen lds
    s_mov_b32 s100, 0x1a2000
    s_add_u32 m0, s86, 0x1c400
    s_nop 0
    buffer_load_dwordx4 v25, s[64:67], s100 offen lds
    s_mov_b32 s100, 0x1a4000
    s_add_u32 m0, s86, 0x1c800
    s_nop 0
    buffer_load_dwordx4 v25, s[64:67], s100 offen lds
    s_mov_b32 s100, 0x1a6000
    s_add_u32 m0, s86, 0x1cc00
    s_nop 0
    buffer_load_dwordx4 v25, s[64:67], s100 offen lds
    s_waitcnt vmcnt(24)
    s_waitcnt vmcnt(20)
    s_barrier
    s_add_u32 s100, s83, 0x2a000
    s_add_u32 m0, s86, 0x20000
    s_nop 0
    buffer_load_dwordx4 v24, s[60:63], s100 offen offset:0 sc1 lds
    buffer_load_dwordx4 v24, s[60:63], s100 offen offset:1024 sc1 lds
    buffer_load_dwordx4 v24, s[60:63], s100 offen offset:2048 sc1 lds
    buffer_load_dwordx4 v24, s[60:63], s100 offen offset:3072 sc1 lds
    s_waitcnt vmcnt(20)
    s_waitcnt vmcnt(16)
    s_barrier
    s_waitcnt vmcnt(12)
    s_waitcnt vmcnt(8)
    s_barrier
    s_waitcnt vmcnt(4)
    s_waitcnt vmcnt(0)
    s_barrier
    s_branch L_end
L_heavy0:
    v_add_u32 v48, 0x0, v8
    v_add_u32 v4, 0x4000, v2
    v_add_u32 v5, 0x4000, v3
    v_xor_b32 v49, 32, v48
    v_xor_b32 v50, 64, v48
    v_xor_b32 v51, 96, v48
    s_waitcnt lgkmcnt(0)
    s_barrier
    ds_read_b128 v[128:131], v48
    ds_read_b64_tr_b16 v[32:33], v4 offset:0
    ds_read_b64_tr_b16 v[34:35], v4 offset:512
    ds_read_b64_tr_b16 v[36:37], v5 offset:0
    ds_read_b64_tr_b16 v[38:39], v5 offset:512
    ds_read_b128 v[132:135], v49
    ds_read_b128 v[136:139], v50
    ds_read_b128 v[140:143], v51
    ds_read_b64_tr_b16 v[40:41], v4 offset:4096
    ds_read_b64_tr_b16 v[42:43], v4 offset:4608
    ds_read_b64_tr_b16 v[44:45], v5 offset:4096
    ds_read_b64_tr_b16 v[46:47], v5 offset:4608
    ds_read_b64_tr_b16 v[80:81], v4 offset:8192
    ds_read_b64_tr_b16 v[82:83], v4 offset:8704
    ds_read_b64_tr_b16 v[84:85], v5 offset:8192
    ds_read_b64_tr_b16 v[86:87], v5 offset:8704
    s_waitcnt lgkmcnt(13)
    v_mfma_f32_32x32x16_bf16 v[96:111], v[32:35], v[128:131], 0
    s_waitcnt lgkmcnt(11)
    v_mfma_f32_32x32x16_bf16 v[112:127], v[36:39], v[128:131], 0
    ds_read_b64_tr_b16 v[32:33], v4 offset:12288
    ds_read_b64_tr_b16 v[34:35], v4 offset:12800
    ds_read_b64_tr_b16 v[36:37], v5 offset:12288
    ds_read_b64_tr_b16 v[38:39], v5 offset:12800
    s_waitcnt lgkmcnt(10)
    v_mfma_f32_32x32x16_bf16 v[96:111], v[40:43], v[132:135], v[96:111]
    s_waitcnt lgkmcnt(8)
    v_mfma_f32_32x32x16_bf16 v[112:127], v[44:47], v[132:135], v[112:127]
    v_add_u32 v72, 0x8000, v8
    v_add_u32 v76, 0xc000, v2
    v_add_u32 v77, 0xc000, v3
    v_xor_b32 v73, 32, v72
    v_xor_b32 v74, 64, v72
    v_xor_b32 v75, 96, v72
    s_waitcnt lgkmcnt(0)
    s_barrier
    ds_read_b128 v[144:147], v72
    ds_read_b64_tr_b16 v[40:41], v76 offset:0
    ds_read_b64_tr_b16 v[42:43], v76 offset:512
    ds_read_b64_tr_b16 v[44:45], v77 offset:0
    ds_read_b64_tr_b16 v[46:47], v77 offset:512
    ds_read_b128 v[148:151], v73
    ds_read_b128 v[152:155], v74
    ds_read_b128 v[156:159], v75
    v_mfma_f32_32x32x16_bf16 v[96:111], v[80:83], v[136:139], v[96:111]
    v_mfma_f32_32x32x16_bf16 v[112:127], v[84:87], v[136:139], v[112:127]
    ds_read_b64_tr_b16 v[80:81], v76 offset:4096
    ds_read_b64_tr_b16 v[82:83], v76 offset:4608
    ds_read_b64_tr_b16 v[84:85], v77 offset:4096
    ds_read_b64_tr_b16 v[86:87], v77 offset:4608
    v_mfma_f32_32x32x16_bf16 v[96:111], v[32:35], v[140:143], v[96:111]
    v_mfma_f32_32x32x16_bf16 v[112:127], v[36:39], v[140:143], v[112:127]
    v_add_u32 v48, 0x10000, v8
    v_add_u32 v4, 0x14000, v2
    v_add_u32 v5, 0x14000, v3
    v_xor_b32 v49, 32, v48
    ds_read_b64_tr_b16 v[32:33], v76 offset:8192
    ds_read_b64_tr_b16 v[34:35], v76 offset:8704
    ds_read_b64_tr_b16 v[36:37], v77 offset:8192
    ds_read_b64_tr_b16 v[38:39], v77 offset:8704
    s_waitcnt lgkmcnt(13)
    v_mfma_f32_32x32x16_bf16 v[96:111], v[40:43], v[144:147], v[96:111]
    v_xor_b32 v50, 64, v48
    v_xor_b32 v51, 96, v48
    s_lshl_b32 s4, s88, 2
    s_add_u32 s4, s4, s92
    s_bitcmp1_b32 s4, 4
    s_cselect_b32 s76, s16, s14
    s_cselect_b32 s77, s17, s15
    s_waitcnt lgkmcnt(11)
    v_mfma_f32_32x32x16_bf16 v[112:127], v[44:47], v[144:147], v[112:127]
    s_mov_b32 s78, 0x80000
    s_mov_b32 s79, 0x20000
    s_lshr_b32 s5, s4, 5
    s_lshl_b32 s5, s5, 4
    s_and_b32 s4, s4, 15
    s_add_u32 s4, s4, s5
    s_lshl_b32 s5, s89, 5
    s_add_u32 s4, s4, s5
    s_lshl_b32 s96, s4, 10
    v_lshlrev_b32 v11, 4, v0
    ds_read_b64_tr_b16 v[40:41], v76 offset:12288
    ds_read_b64_tr_b16 v[42:43], v76 offset:12800
    ds_read_b64_tr_b16 v[44:45], v77 offset:12288
    ds_read_b64_tr_b16 v[46:47], v77 offset:12800
    s_waitcnt lgkmcnt(10)
    v_mfma_f32_32x32x16_bf16 v[96:111], v[80:83], v[148:151], v[96:111]
    s_waitcnt lgkmcnt(8)
    v_mfma_f32_32x32x16_bf16 v[112:127], v[84:87], v[148:151], v[112:127]
    buffer_load_dwordx4 v[88:91], v11, s[76:79], s96 offen
    v_and_b32 v12, 31, v0
    s_lshl_b32 s4, s89, 5
    v_add_u32 v12, s4, v12
    v_lshlrev_b32 v12, 1, v12
    global_load_ushort v52, v12, s[10:11]
    global_load_ushort v53, v12, s[12:13]
    global_load_ushort v54, v12, s[22:23]
    s_waitcnt lgkmcnt(0)
    s_barrier
    ds_read_b128 v[160:163], v48
    ds_read_b64_tr_b16 v[80:81], v4 offset:0
    ds_read_b64_tr_b16 v[82:83], v4 offset:512
    ds_read_b64_tr_b16 v[84:85], v5 offset:0
    ds_read_b64_tr_b16 v[86:87], v5 offset:512
    ds_read_b128 v[164:167], v49
    ds_read_b128 v[168:171], v50
    ds_read_b128 v[172:175], v51
    v_mfma_f32_32x32x16_bf16 v[96:111], v[32:35], v[152:155], v[96:111]
    v_mfma_f32_32x32x16_bf16 v[112:127], v[36:39], v[152:155], v[112:127]
    ds_read_b64_tr_b16 v[32:33], v4 offset:4096
    ds_read_b64_tr_b16 v[34:35], v4 offset:4608
    ds_read_b64_tr_b16 v[36:37], v5 offset:4096
    ds_read_b64_tr_b16 v[38:39], v5 offset:4608
    v_mfma_f32_32x32x16_bf16 v[96:111], v[40:43], v[156:159], v[96:111]
    v_mfma_f32_32x32x16_bf16 v[112:127], v[44:47], v[156:159], v[112:127]
    v_add_u32 v72, 0x18000, v8
    v_add_u32 v76, 0x1c000, v2
    v_add_u32 v77, 0x1c000, v3
    v_xor_b32 v73, 32, v72
    ds_read_b64_tr_b16 v[40:41], v4 offset:8192
    ds_read_b64_tr_b16 v[42:43], v4 offset:8704
    ds_read_b64_tr_b16 v[44:45], v5 offset:8192
    ds_read_b64_tr_b16 v[46:47], v5 offset:8704
    s_waitcnt lgkmcnt(13)
    v_mfma_f32_32x32x16_bf16 v[96:111], v[80:83], v[160:163], v[96:111]
    v_xor_b32 v74, 64, v72
    v_xor_b32 v75, 96, v72
    s_lshl_b32 s4, s89, 16
    s_add_u32 s9, s4, 0x100000
    s_lshl_b32 s5, s92, 9
    s_add_u32 s27, s9, s5
    v_and_b32 v60, 31, v0
    s_waitcnt lgkmcnt(11)
    v_mfma_f32_32x32x16_bf16 v[112:127], v[84:87], v[160:163], v[112:127]
    v_lshlrev_b32 v60, 4, v60
    v_lshrrev_b32 v12, 5, v0
    v_lshl_add_u32 v60, v12, 12, v60
    v_and_b32 v63, 31, v0
    ds_read_b64_tr_b16 v[80:81], v4 offset:12288
    ds_read_b64_tr_b16 v[82:83], v4 offset:12800
    ds_read_b64_tr_b16 v[84:85], v5 offset:12288
    ds_read_b64_tr_b16 v[86:87], v5 offset:12800
    s_waitcnt lgkmcnt(10)
    v_mfma_f32_32x32x16_bf16 v[96:111], v[32:35], v[164:167], v[96:111]
    s_lshl_b32 s4, s92, 5
    v_add_u32 v63, s4, v63
    s_lshl_b32 s4, s88, 11
    s_add_u32 s4, s4, 0x8000
    v_lshl_add_u32 v62, v63, 4, s4
    s_waitcnt lgkmcnt(8)
    v_mfma_f32_32x32x16_bf16 v[112:127], v[36:39], v[164:167], v[112:127]
    buffer_load_dwordx4 v[56:59], v62, s[60:63], 0 offen sc0 sc1
    s_add_u32 s8, s27, 0
    buffer_load_dwordx4 v[224:227], v60, s[60:63], s8 offen sc0 sc1
    s_add_u32 s8, s27, 8192
    buffer_load_dwordx4 v[228:231], v60, s[60:63], s8 offen sc0 sc1
    s_add_u32 s8, s27, 16384
    buffer_load_dwordx4 v[232:235], v60, s[60:63], s8 offen sc0 sc1
    s_add_u32 s8, s27, 24576
    buffer_load_dwordx4 v[236:239], v60, s[60:63], s8 offen sc0 sc1
    s_waitcnt lgkmcnt(0)
    s_barrier
    ds_read_b128 v[176:179], v72
    ds_read_b64_tr_b16 v[32:33], v76 offset:0
    ds_read_b64_tr_b16 v[34:35], v76 offset:512
    ds_read_b64_tr_b16 v[36:37], v77 offset:0
    ds_read_b64_tr_b16 v[38:39], v77 offset:512
    ds_read_b128 v[180:183], v73
    ds_read_b128 v[184:187], v74
    ds_read_b128 v[188:191], v75
    v_mfma_f32_32x32x16_bf16 v[96:111], v[40:43], v[168:171], v[96:111]
    v_mfma_f32_32x32x16_bf16 v[112:127], v[44:47], v[168:171], v[112:127]
    ds_read_b64_tr_b16 v[40:41], v76 offset:4096
    ds_read_b64_tr_b16 v[42:43], v76 offset:4608
    ds_read_b64_tr_b16 v[44:45], v77 offset:4096
    ds_read_b64_tr_b16 v[46:47], v77 offset:4608
    v_mfma_f32_32x32x16_bf16 v[96:111], v[80:83], v[172:175], v[96:111]
    v_mfma_f32_32x32x16_bf16 v[112:127], v[84:87], v[172:175], v[112:127]
    v_add_u32 v48, 0x20000, v8
    v_add_u32 v4, 0x0, v2
    v_add_u32 v5, 0x0, v3
    v_xor_b32 v49, 32, v48
    ds_read_b64_tr_b16 v[80:81], v76 offset:8192
    ds_read_b64_tr_b16 v[82:83], v76 offset:8704
    ds_read_b64_tr_b16 v[84:85], v77 offset:8192
    ds_read_b64_tr_b16 v[86:87], v77 offset:8704
    s_waitcnt lgkmcnt(13)
    v_mfma_f32_32x32x16_bf16 v[96:111], v[32:35], v[176:179], v[96:111]
    v_xor_b32 v50, 64, v48
    v_xor_b32 v51, 96, v48
    s_waitcnt lgkmcnt(11)
    v_mfma_f32_32x32x16_bf16 v[112:127], v[36:39], v[176:179], v[112:127]
    ds_read_b64_tr_b16 v[32:33], v76 offset:12288
    ds_read_b64_tr_b16 v[34:35], v76 offset:12800
    ds_read_b64_tr_b16 v[36:37], v77 offset:12288
    ds_read_b64_tr_b16 v[38:39], v77 offset:12800
    s_waitcnt lgkmcnt(10)
    v_mfma_f32_32x32x16_bf16 v[96:111], v[40:43], v[180:183], v[96:111]
    s_waitcnt lgkmcnt(8)
    v_mfma_f32_32x32x16_bf16 v[112:127], v[44:47], v[180:183], v[112:127]
    s_add_u32 s8, s27, 32768
    buffer_load_dwordx4 v[240:243], v60, s[60:63], s8 offen sc0 sc1
    s_add_u32 s8, s27, 40960
    buffer_load_dwordx4 v[244:247], v60, s[60:63], s8 offen sc0 sc1
    s_add_u32 s8, s27, 49152
    buffer_load_dwordx4 v[248:251], v60, s[60:63], s8 offen sc0 sc1
    s_add_u32 s8, s27, 57344
    buffer_load_dwordx4 v[252:255], v60, s[60:63], s8 offen sc0 sc1
    s_lshr_b32 s6, s92, 1
    s_and_b32 s7, s92, 1
    s_lshl_b32 s4, s6, 13
    v_lshlrev_b32 v26, 4, v0
    v_add_u32 v26, s4, v26
    v_lshrrev_b32 v10, 5, v0
    v_lshlrev_b32 v10, 10, v10
    v_bfe_u32 v11, v0, 2, 2
    v_lshl_add_u32 v10, v11, 7, v10
    v_bfe_u32 v11, v0, 3, 1
    v_xor_b32 v11, s7, v11
    v_lshl_add_u32 v10, v11, 6, v10
    v_bfe_u32 v11, v0, 4, 1
    v_lshl_add_u32 v10, v11, 5, v10
    v_and_b32 v11, 3, v0
    v_lshl_add_u32 v29, v11, 3, v10
    v_and_b32 v10, 31, v0
    s_lshl_b32 s4, s7, 5
    v_add_u32 v10, s4, v10
    v_lshlrev_b32 v10, 7, v10
    v_bfe_u32 v11, v0, 1, 3
    v_lshrrev_b32 v12, 5, v0
    v_xor_b32 v11, v11, v12
    v_lshl_add_u32 v30, v11, 4, v10
    s_waitcnt lgkmcnt(0)
    s_barrier
    ds_read_b128 v[192:195], v48
    ds_read_b64_tr_b16 v[40:41], v4 offset:0
    ds_read_b64_tr_b16 v[42:43], v4 offset:512
    ds_read_b64_tr_b16 v[44:45], v5 offset:0
    ds_read_b64_tr_b16 v[46:47], v5 offset:512
    ds_read_b128 v[196:199], v49
    ds_read_b128 v[200:203], v50
    ds_read_b128 v[204:207], v51
    v_mfma_f32_32x32x16_bf16 v[96:111], v[80:83], v[184:187], v[96:111]
    v_mfma_f32_32x32x16_bf16 v[112:127], v[84:87], v[184:187], v[112:127]
    ds_read_b64_tr_b16 v[80:81], v4 offset:4096
    ds_read_b64_tr_b16 v[82:83], v4 offset:4608
    ds_read_b64_tr_b16 v[84:85], v5 offset:4096
    ds_read_b64_tr_b16 v[86:87], v5 offset:4608
    v_mfma_f32_32x32x16_bf16 v[96:111], v[32:35], v[188:191], v[96:111]
    v_mfma_f32_32x32x16_bf16 v[112:127], v[36:39], v[188:191], v[112:127]
    v_add_u32 v72, 0x4000, v8
    v_add_u32 v76, 0x8000, v2
    v_add_u32 v77, 0x8000, v3
    v_xor_b32 v73, 32, v72
    ds_read_b64_tr_b16 v[32:33], v4 offset:8192
    ds_read_b64_tr_b16 v[34:35], v4 offset:8704
    ds_read_b64_tr_b16 v[36:37], v5 offset:8192
    ds_read_b64_tr_b16 v[38:39], v5 offset:8704
    s_waitcnt lgkmcnt(13)
    v_mfma_f32_32x32x16_bf16 v[96:111], v[40:43], v[192:195], v[96:111]
    v_xor_b32 v74, 64, v72
    v_xor_b32 v75, 96, v72
    s_waitcnt vmcnt(12)
    v_lshlrev_b32 v92, 16, v88
    v_and_b32 v88, 0xffff0000, v88
    s_waitcnt lgkmcnt(11)
    v_mfma_f32_32x32x16_bf16 v[112:127], v[44:47], v[192:195], v[112:127]
    v_add_f32 v88, v88, v92
    v_lshlrev_b32 v92, 16, v89
    v_and_b32 v89, 0xffff0000, v89
    v_add_f32 v89, v89, v92
    ds_read_b64_tr_b16 v[40:41], v4 offset:12288
    ds_read_b64_tr_b16 v[42:43], v4 offset:12800
    ds_read_b64_tr_b16 v[44:45], v5 offset:12288
    ds_read_b64_tr_b16 v[46:47], v5 offset:12800
    s_waitcnt lgkmcnt(10)
    v_mfma_f32_32x32x16_bf16 v[96:111], v[80:83], v[196:199], v[96:111]
    v_lshlrev_b32 v92, 16, v90
    v_and_b32 v90, 0xffff0000, v90
    v_add_f32 v90, v90, v92
    v_lshlrev_b32 v92, 16, v91
    s_waitcnt lgkmcnt(8)
    v_mfma_f32_32x32x16_bf16 v[112:127], v[84:87], v[196:199], v[112:127]
    v_and_b32 v91, 0xffff0000, v91
    v_add_f32 v91, v91, v92
    v_add_f32 v88, v88, v89
    v_add_f32 v90, v90, v91
    s_waitcnt lgkmcnt(0)
    s_barrier
    ds_read_b128 v[208:211], v72
    ds_read_b64_tr_b16 v[80:81], v76 offset:0
    ds_read_b64_tr_b16 v[82:83], v76 offset:512
    ds_read_b64_tr_b16 v[84:85], v77 offset:0
    ds_read_b64_tr_b16 v[86:87], v77 offset:512
    ds_read_b128 v[212:215], v73
    ds_read_b128 v[216:219], v74
    ds_read_b128 v[220:223], v75
    v_mfma_f32_32x32x16_bf16 v[96:111], v[32:35], v[200:203], v[96:111]
    v_mfma_f32_32x32x16_bf16 v[112:127], v[36:39], v[200:203], v[112:127]
    ds_read_b64_tr_b16 v[32:33], v76 offset:4096
    ds_read_b64_tr_b16 v[34:35], v76 offset:4608
    ds_read_b64_tr_b16 v[36:37], v77 offset:4096
    ds_read_b64_tr_b16 v[38:39], v77 offset:4608
    v_mfma_f32_32x32x16_bf16 v[96:111], v[40:43], v[204:207], v[96:111]
    v_mfma_f32_32x32x16_bf16 v[112:127], v[44:47], v[204:207], v[112:127]
    v_add_u32 v48, 0xc000, v8
    v_add_u32 v4, 0x10000, v2
    v_add_u32 v5, 0x10000, v3
    v_xor_b32 v49, 32, v48
    ds_read_b64_tr_b16 v[40:41], v76 offset:8192
    ds_read_b64_tr_b16 v[42:43], v76 offset:8704
    ds_read_b64_tr_b16 v[44:45], v77 offset:8192
    ds_read_b64_tr_b16 v[46:47], v77 offset:8704
    s_waitcnt lgkmcnt(13)
    v_mfma_f32_32x32x16_bf16 v[96:111], v[80:83], v[208:211], v[96:111]
    v_xor_b32 v50, 64, v48
    v_xor_b32 v51, 96, v48
    v_add_f32 v92, v88, v90
    s_nop 1
    v_add_f32_dpp v92, v92, v92 row_ror:8 row_mask:0xf bank_mask:0xf
    s_waitcnt lgkmcnt(11)
    v_mfma_f32_32x32x16_bf16 v[112:127], v[84:87], v[208:211], v[112:127]
    v_add_f32_dpp v92, v92, v92 row_ror:4 row_mask:0xf bank_mask:0xf
    s_nop 1
    v_add_f32_dpp v92, v92, v92 row_ror:2 row_mask:0xf bank_mask:0xf
    s_nop 1
    v_add_f32_dpp v92, v92, v92 row_ror:1 row_mask:0xf bank_mask:0xf
    v_mov_b32 v93, v92
    ds_read_b64_tr_b16 v[80:81], v76 offset:12288
    ds_read_b64_tr_b16 v[82:83], v76 offset:12800
    ds_read_b64_tr_b16 v[84:85], v77 offset:12288
    ds_read_b64_tr_b16 v[86:87], v77 offset:12800
    s_waitcnt lgkmcnt(10)
    v_mfma_f32_32x32x16_bf16 v[96:111], v[32:35], v[212:215], v[96:111]
    v_permlane16_swap_b32 v92, v93
    v_add_f32 v92, v92, v93
    v_mov_b32 v93, v92
    s_nop 1
    v_permlane32_swap_b32 v92, v93
    s_waitcnt lgkmcnt(8)
    v_mfma_f32_32x32x16_bf16 v[112:127], v[36:39], v[212:215], v[112:127]
    v_add_f32 v92, v92, v93
    s_lshl_b32 s4, s89, 16
    s_lshl_b32 s5, s88, 12
    s_add_u32 s4, s4, s5
    s_add_u32 s6, s4, 0x100000
    v_mov_b32 v10, 0
    v_mov_b32 v11, 0x7ff00000
    v_cmp_eq_u32 vcc, 0, v0
    s_nop 1
    v_cndmask_b32 v10, v11, v10, vcc
    s_lshl_b32 s5, s92, 3
    s_add_u32 s95, s6, s5
    s_add_u32 s95, s95, 2048
    v_mov_b32 v93, s26
    buffer_store_dwordx2 v[92:93], v10, s[60:63], s95 offen sc0 sc1
    s_mov_b32 s97, 400000
    s_waitcnt vmcnt(1)
    v_mov_b32 v64, v255
    v_xor_b32 v64, s26, v225
    v_xor_b32 v65, s26, v227
    v_or_b32 v64, v64, v65
    v_xor_b32 v65, s26, v229
    v_or_b32 v64, v64, v65
    v_xor_b32 v65, s26, v231
    v_or_b32 v64, v64, v65
    v_xor_b32 v65, s26, v233
    v_or_b32 v64, v64, v65
    v_xor_b32 v65, s26, v235
    v_or_b32 v64, v64, v65
    v_xor_b32 v65, s26, v237
    v_or_b32 v64, v64, v65
    v_xor_b32 v65, s26, v239
    v_or_b32 v64, v64, v65
    v_xor_b32 v65, s26, v241
    v_or_b32 v64, v64, v65
    v_xor_b32 v65, s26, v243
    v_or_b32 v64, v64, v65
    v_xor_b32 v65, s26, v245
    v_or_b32 v64, v64, v65
    v_xor_b32 v65, s26, v247
    v_or_b32 v64, v64, v65
    v_xor_b32 v65, s26, v249
    v_or_b32 v64, v64, v65
    v_xor_b32 v65, s26, v251
    v_or_b32 v64, v64, v65
    v_xor_b32 v65, s26, v253
    v_or_b32 v64, v64, v65
    v_xor_b32 v65, s26, v255
    v_or_b32 v64, v64, v65
    v_xor_b32 v65, s26, v57
    v_or_b32 v64, v64, v65
    v_xor_b32 v65, s26, v59
    v_or_b32 v64, v64, v65
    v_cmp_eq_u32 vcc, 0, v64
    s_nop 4
    s_cmp_eq_u64 vcc, exec
    s_cbranch_scc1 L_tabd5
L_tab4:
    s_sub_u32 s97, s97, 1
    s_sleep 1
    s_add_u32 s8, s27, 0
    buffer_load_dwordx4 v[224:227], v60, s[60:63], s8 offen sc0 sc1
    s_add_u32 s8, s27, 8192
    buffer_load_dwordx4 v[228:231], v60, s[60:63], s8 offen sc0 sc1
    s_add_u32 s8, s27, 16384
    buffer_load_dwordx4 v[232:235], v60, s[60:63], s8 offen sc0 sc1
    s_add_u32 s8, s27, 24576
    buffer_load_dwordx4 v[236:239], v60, s[60:63], s8 offen sc0 sc1
    s_add_u32 s8, s27, 32768
    buffer_load_dwordx4 v[240:243], v60, s[60:63], s8 offen sc0 sc1
    s_add_u32 s8, s27, 40960
    buffer_load_dwordx4 v[244:247], v60, s[60:63], s8 offen sc0 sc1
    s_add_u32 s8, s27, 49152
    buffer_load_dwordx4 v[248:251], v60, s[60:63], s8 offen sc0 sc1
    s_add_u32 s8, s27, 57344
    buffer_load_dwordx4 v[252:255], v60, s[60:63], s8 offen sc0 sc1
    buffer_load_dwordx4 v[56:59], v62, s[60:63], 0 offen sc0 sc1
    s_waitcnt vmcnt(0)
    v_xor_b32 v64, s26, v225
    v_xor_b32 v65, s26, v227
    v_or_b32 v64, v64, v65
    v_xor_b32 v65, s26, v229
    v_or_b32 v64, v64, v65
    v_xor_b32 v65, s26, v231
    v_or_b32 v64, v64, v65
    v_xor_b32 v65, s26, v233
    v_or_b32 v64, v64, v65
    v_xor_b32 v65, s26, v235
    v_or_b32 v64, v64, v65
    v_xor_b32 v65, s26, v237
    v_or_b32 v64, v64, v65
    v_xor_b32 v65, s26, v239
    v_or_b32 v64, v64, v65
    v_xor_b32 v65, s26, v241
    v_or_b32 v64, v64, v65
    v_xor_b32 v65, s26, v243
    v_or_b32 v64, v64, v65
    v_xor_b32 v65, s26, v245
    v_or_b32 v64, v64, v65
    v_xor_b32 v65, s26, v247
    v_or_b32 v64, v64, v65
    v_xor_b32 v65, s26, v249
    v_or_b32 v64, v64, v65
    v_xor_b32 v65, s26, v251
    v_or_b32 v64, v64, v65
    v_xor_b32 v65, s26, v253
    v_or_b32 v64, v64, v65
    v_xor_b32 v65, s26, v255
    v_or_b32 v64, v64, v65
    v_xor_b32 v65, s26, v57
    v_or_b32 v64, v64, v65
    v_xor_b32 v65, s26, v59
    v_or_b32 v64, v64, v65
    v_cmp_eq_u32 vcc, 0, v64
    s_nop 4
    s_cmp_eq_u64 vcc, exec
    s_cbranch_scc1 L_tabd5
    s_cmp_lg_u32 s97, 0
    s_cbranch_scc1 L_tab4
L_tabd5:
    s_nop 4
    v_add_f32 v224, v224, v228
    v_add_f32 v232, v232, v236
    v_add_f32 v240, v240, v244
    v_add_f32 v248, v248, v252
    v_add_f32 v224, v224, v232
    v_add_f32 v240, v240, v248
    v_add_f32 v64, v224, v240
    v_add_f32 v226, v226, v230
    v_add_f32 v234, v234, v238
    v_add_f32 v242, v242, v246
    v_add_f32 v250, v250, v254
    v_add_f32 v226, v226, v234
    v_add_f32 v242, v242, v250
    v_add_f32 v65, v226, v242
    s_nop 1
    v_permlane32_swap_b32 v64, v65
    v_add_f32 v64, v64, v65
    v_and_b32 v12, 31, v0
    v_lshlrev_b32 v12, 1, v12
    v_lshrrev_b32 v13, 5, v0
    v_add_u32 v12, v12, v13
    v_and_b32 v10, 3, v12
    v_bfe_u32 v11, v12, 3, 1
    v_lshl_add_u32 v10, v11, 2, v10
    v_bfe_u32 v11, v12, 2, 1
    v_lshl_add_u32 v10, v11, 3, v10
    v_lshlrev_b32 v10, 3, v10
    v_lshrrev_b32 v11, 4, v12
    v_lshl_add_u32 v10, v11, 8, v10
    s_lshr_b32 s4, s92, 1
    s_lshl_b32 s4, s4, 10
    s_and_b32 s5, s92, 1
    s_lshl_b32 s5, s5, 7
    s_add_u32 s4, s4, s5
    s_add_u32 s4, s4, 0x24000
    v_add_u32 v10, s4, v10
    v_cvt_pk_bf16_f32 v67, v64, 0
    v_lshlrev_b32 v68, 16, v67
    v_sub_f32 v68, v64, v68
    v_cvt_pk_bf16_f32 v68, v68, 0
    v_lshl_or_b32 v66, v68, 16, v67
    ds_write_b64 v10, v[66:67]
    v_lshlrev_b32 v63, 2, v63
    v_add_u32 v63, 0x24a00, v63
    ds_write_b32 v63, v56
    ds_write_b32 v63, v58 offset:512
    s_waitcnt lgkmcnt(0)
    s_barrier
    ds_read_b128 v[224:227], v48
    ds_read_b64_tr_b16 v[32:33], v4 offset:0
    ds_read_b64_tr_b16 v[34:35], v4 offset:512
    ds_read_b64_tr_b16 v[36:37], v5 offset:0
    ds_read_b64_tr_b16 v[38:39], v5 offset:512
    ds_read_b128 v[228:231], v49
    ds_read_b128 v[232:235], v50
    ds_read_b128 v[236:239], v51
    v_mfma_f32_32x32x16_bf16 v[96:111], v[40:43], v[216:219], v[96:111]
    v_mfma_f32_32x32x16_bf16 v[112:127], v[44:47], v[216:219], v[112:127]
    ds_read_b64_tr_b16 v[40:41], v4 offset:4096
    ds_read_b64_tr_b16 v[42:43], v4 offset:4608
    ds_read_b64_tr_b16 v[44:45], v5 offset:4096
    ds_read_b64_tr_b16 v[46:47], v5 offset:4608
    v_mfma_f32_32x32x16_bf16 v[96:111], v[80:83], v[220:223], v[96:111]
    v_mfma_f32_32x32x16_bf16 v[112:127], v[84:87], v[220:223], v[112:127]
    v_add_u32 v72, 0x14000, v8
    v_add_u32 v76, 0x18000, v2
    v_add_u32 v77, 0x18000, v3
    v_xor_b32 v73, 32, v72
    ds_read_b64_tr_b16 v[80:81], v4 offset:8192
    ds_read_b64_tr_b16 v[82:83], v4 offset:8704
    ds_read_b64_tr_b16 v[84:85], v5 offset:8192
    ds_read_b64_tr_b16 v[86:87], v5 offset:8704
    s_waitcnt lgkmcnt(13)
    v_mfma_f32_32x32x16_bf16 v[96:111], v[32:35], v[224:227], v[96:111]
    v_xor_b32 v74, 64, v72
    v_xor_b32 v75, 96, v72
    v_mov_b32 v11, 0x7ff00000
    s_lshl_b32 s7, s88, 4
    s_add_u32 s7, s7, s89
    s_mul_i32 s5, s7, 56
    s_waitcnt lgkmcnt(11)
    v_mfma_f32_32x32x16_bf16 v[112:127], v[36:39], v[224:227], v[112:127]
    s_mul_i32 s6, s92, 14
    s_add_u32 s5, s5, s6
    v_add_u32 v10, s5, v0
    v_lshlrev_b32 v10, 7, v10
    v_cmp_gt_u32 vcc, 14, v0
    ds_read_b64_tr_b16 v[32:33], v4 offset:12288
    ds_read_b64_tr_b16 v[34:35], v4 offset:12800
    ds_read_b64_tr_b16 v[36:37], v5 offset:12288
    ds_read_b64_tr_b16 v[38:39], v5 offset:12800
    s_waitcnt lgkmcnt(10)
    v_mfma_f32_32x32x16_bf16 v[96:111], v[40:43], v[228:231], v[96:111]
    v_cndmask_b32 v10, v11, v10, vcc
    s_mov_b32 s84, s32
    s_mov_b32 s85, s33
    s_mov_b32 s86, 0x1c0000
    s_mov_b32 s87, 0x20000
    s_waitcnt lgkmcnt(8)
    v_mfma_f32_32x32x16_bf16 v[112:127], v[44:47], v[228:231], v[112:127]
    buffer_load_dword v92, v10, s[84:87], 0 offen
    s_lshl_b32 s5, s7, 4
    s_and_b32 s6, s92, 1
    s_lshl_b32 s6, s6, 3
    s_add_u32 s5, s5, s6
    v_add_u32 v10, s5, v0
    v_lshlrev_b32 v10, 7, v10
    v_cmp_gt_u32 vcc, 8, v0
    s_nop 1
    v_cndmask_b32 v10, v11, v10, vcc
    s_and_b32 s4, s92, 2
    s_cmp_eq_u32 s4, 0
    s_cselect_b32 s84, s18, s20
    s_cselect_b32 s85, s19, s21
    s_mov_b32 s86, 0x80000
    s_mov_b32 s87, 0x20000
    buffer_load_dword v93, v10, s[84:87], 0 offen
    s_and_b32 s6, s92, 1
    s_lshl_b32 s4, s89, 13
    s_lshl_b32 s5, s6, 8
    s_add_u32 s4, s4, s5
    s_add_u32 s4, s4, 0x10000
    v_lshrrev_b32 v12, 4, v0
    v_and_b32 v13, 15, v0
    v_lshlrev_b32 v13, 4, v13
    v_lshl_add_u32 v13, v12, 9, v13
    v_add_u32 v28, s4, v13
    v_lshlrev_b32 v52, 16, v52
    v_lshlrev_b32 v53, 16, v53
    v_lshlrev_b32 v54, 16, v54
    v_mul_f32 v54, 0x3fb8aa3b, v54
    v_exp_f32 v54, v54
    v_and_b32 v12, 31, v0
    v_lshlrev_b32 v12, 6, v12
    v_cvt_pk_bf16_f32 v54, v54, v54
    v_and_b32 v54, 0xffff0000, v54
    v_mul_f32 v56, v54, v52
    v_mul_f32 v57, v54, v53
    v_mul_f32 v56, 0x3fb8aa3b, v56
    v_mul_f32 v57, 0x3e22f983, v57
    v_exp_f32 v68, v56
    v_cos_f32 v58, v57
    v_sin_f32 v59, v57
    v_add_u32 v12, 0x24e00, v12
    v_mul_f32 v58, v58, v68
    v_mul_f32 v59, v59, v68
    v_add_f32 v68, -1.0, v58
    v_mul_f32 v60, v68, v52
    v_fmac_f32 v60, v59, v53
    v_mul_f32 v61, v59, v52
    v_fma_f32 v61, -v68, v53, v61
    v_mul_f32 v68, v52, v52
    v_fmac_f32 v68, v53, v53
    v_rcp_f32 v68, v68
    ds_write_b128 v12, v[56:59]
    v_add_f32 v68, v68, v68
    v_mul_f32 v60, v60, v68
    v_mul_f32 v61, v61, v68
    v_mul_f32 v68, 0x41000000, v56
    v_mul_f32 v63, 0x41000000, v57
    v_exp_f32 v68, v68
    v_fract_f32 v63, v63
    v_cos_f32 v62, v63
    v_sin_f32 v63, v63
    v_mov_b32 v69, v68
    v_mul_f32 v62, v62, v69
    v_mul_f32 v63, v63, v69
    v_mul_f32 v68, 0x41800000, v56
    v_mul_f32 v65, 0x41800000, v57
    v_exp_f32 v68, v68
    v_fract_f32 v65, v65
    v_cos_f32 v64, v65
    v_sin_f32 v65, v65
    v_mov_b32 v69, v68
    v_mul_f32 v64, v64, v69
    v_mul_f32 v65, v65, v69
    v_mul_f32 v68, 0x42000000, v56
    v_mul_f32 v67, 0x42000000, v57
    v_exp_f32 v68, v68
    v_fract_f32 v67, v67
    v_cos_f32 v66, v67
    v_sin_f32 v67, v67
    v_mov_b32 v69, v68
    v_mul_f32 v66, v66, v69
    v_mul_f32 v67, v67, v69
    ds_write_b128 v12, v[60:63] offset:16
    ds_write_b128 v12, v[64:67] offset:32
    s_waitcnt lgkmcnt(0)
    s_barrier
    ds_read_b128 v[240:243], v72
    ds_read_b64_tr_b16 v[40:41], v76 offset:0
    ds_read_b64_tr_b16 v[42:43], v76 offset:512
    ds_read_b64_tr_b16 v[44:45], v77 offset:0
    ds_read_b64_tr_b16 v[46:47], v77 offset:512
    ds_read_b128 v[244:247], v73
    ds_read_b128 v[248:251], v74
    ds_read_b128 v[252:255], v75
    v_mfma_f32_32x32x16_bf16 v[96:111], v[80:83], v[232:235], v[96:111]
    v_mfma_f32_32x32x16_bf16 v[112:127], v[84:87], v[232:235], v[112:127]
    ds_read_b64_tr_b16 v[80:81], v76 offset:4096
    ds_read_b64_tr_b16 v[82:83], v76 offset:4608
    ds_read_b64_tr_b16 v[84:85], v77 offset:4096
    ds_read_b64_tr_b16 v[86:87], v77 offset:4608
    v_mfma_f32_32x32x16_bf16 v[96:111], v[32:35], v[236:239], v[96:111]
    v_mfma_f32_32x32x16_bf16 v[112:127], v[36:39], v[236:239], v[112:127]
    s_lshl_b32 s4, s89, 16
    s_add_u32 s4, s4, 0x100800
    v_lshrrev_b32 v70, 2, v0
    v_lshlrev_b32 v70, 12, v70
    v_and_b32 v12, 3, v0
    v_lshl_add_u32 v70, v12, 3, v70
    ds_read_b64_tr_b16 v[32:33], v76 offset:8192
    ds_read_b64_tr_b16 v[34:35], v76 offset:8704
    ds_read_b64_tr_b16 v[36:37], v77 offset:8192
    ds_read_b64_tr_b16 v[38:39], v77 offset:8704
    s_waitcnt lgkmcnt(13)
    v_mfma_f32_32x32x16_bf16 v[96:111], v[40:43], v[240:243], v[96:111]
    v_add_u32 v70, s4, v70
    s_waitcnt lgkmcnt(11)
    v_mfma_f32_32x32x16_bf16 v[112:127], v[44:47], v[240:243], v[112:127]
    ds_read_b64_tr_b16 v[40:41], v76 offset:12288
    ds_read_b64_tr_b16 v[42:43], v76 offset:12800
    ds_read_b64_tr_b16 v[44:45], v77 offset:12288
    ds_read_b64_tr_b16 v[46:47], v77 offset:12800
    s_waitcnt lgkmcnt(10)
    v_mfma_f32_32x32x16_bf16 v[96:111], v[80:83], v[244:247], v[96:111]
    s_waitcnt lgkmcnt(8)
    v_mfma_f32_32x32x16_bf16 v[112:127], v[84:87], v[244:247], v[112:127]
    s_waitcnt lgkmcnt(6)
    v_mfma_f32_32x32x16_bf16 v[96:111], v[32:35], v[248:251], v[96:111]
    s_waitcnt lgkmcnt(4)
    v_mfma_f32_32x32x16_bf16 v[112:127], v[36:39], v[248:251], v[112:127]
    s_waitcnt lgkmcnt(2)
    v_mfma_f32_32x32x16_bf16 v[96:111], v[40:43], v[252:255], v[96:111]
    s_waitcnt lgkmcnt(0)
    v_mfma_f32_32x32x16_bf16 v[112:127], v[44:47], v[252:255], v[112:127]
    buffer_load_dwordx2 v[78:79], v70, s[60:63], 0 offen sc0 sc1
    s_barrier
    s_mov_b32 s7, 0x1c000
    v_and_b32 v49, 31, v0
    v_lshrrev_b32 v50, 5, v0
    v_and_b32 v51, 15, v0
    v_xor_b32 v50, v50, v51
    v_lshlrev_b32 v50, 4, v50
    v_lshl_add_u32 v8, v49, 9, v50
    v_add_u32 v48, s7, v8
    v_xor_b32 v49, 0, v48
    ds_read_b128 v[32:35], v49
    v_xor_b32 v50, 32, v48
    ds_read_b128 v[36:39], v50
    v_xor_b32 v49, 64, v48
    ds_read_b128 v[40:43], v49
    v_xor_b32 v50, 96, v48
    ds_read_b128 v[44:47], v50
    s_waitcnt vmcnt(1) lgkmcnt(3)
    v_mfma_f32_32x32x16_bf16 v[80:95], v[128:131], v[32:35], 0
    v_xor_b32 v49, 128, v48
    ds_read_b128 v[32:35], v49
    s_waitcnt lgkmcnt(3)
    v_mfma_f32_32x32x16_bf16 v[80:95], v[132:135], v[36:39], v[80:95]
    v_xor_b32 v50, 160, v48
    ds_read_b128 v[36:39], v50
    s_waitcnt lgkmcnt(3)
    v_mfma_f32_32x32x16_bf16 v[80:95], v[136:139], v[40:43], v[80:95]
    v_xor_b32 v49, 192, v48
    ds_read_b128 v[40:43], v49
    s_waitcnt lgkmcnt(3)
    v_mfma_f32_32x32x16_bf16 v[80:95], v[140:143], v[44:47], v[80:95]
    s_lshl_b32 s6, s93, 9
    s_add_u32 s6, s6, 0x24000
    v_and_b32 v18, 31, v0
    v_lshlrev_b32 v18, 3, v18
    v_add_u32 v18, s6, v18
    ds_read_b64 v[56:57], v18
    v_mov_b32 v58, 0
    v_mov_b32 v59, 0
    v_xor_b32 v50, 224, v48
    ds_read_b128 v[44:47], v50
    s_waitcnt lgkmcnt(4)
    v_mfma_f32_32x32x16_bf16 v[80:95], v[144:147], v[32:35], v[80:95]
    s_lshl_b32 s6, s93, 9
    s_add_u32 s6, s6, 0x24100
    v_and_b32 v18, 31, v0
    v_lshlrev_b32 v18, 3, v18
    v_add_u32 v18, s6, v18
    ds_read_b64 v[60:61], v18
    v_mov_b32 v62, 0
    v_mov_b32 v63, 0
    v_xor_b32 v49, 256, v48
    ds_read_b128 v[32:35], v49
    s_waitcnt lgkmcnt(5)
    v_mfma_f32_32x32x16_bf16 v[80:95], v[148:151], v[36:39], v[80:95]
    v_bfe_u32 v10, v0, 2, 1
    v_lshlrev_b32 v10, 4, v10
    v_bfe_u32 v11, v0, 3, 2
    v_xor_b32 v50, 288, v48
    ds_read_b128 v[36:39], v50
    s_waitcnt lgkmcnt(5)
    v_mfma_f32_32x32x16_bf16 v[80:95], v[152:155], v[40:43], v[80:95]
    v_lshl_add_u32 v10, v11, 2, v10
    v_and_b32 v11, 3, v0
    v_add_u32 v10, v10, v11
    s_lshl_b32 s4, s92, 5
    v_add_u32 v10, s4, v10
    v_xor_b32 v49, 320, v48
    ds_read_b128 v[40:43], v49
    s_waitcnt lgkmcnt(4)
    v_mfma_f32_32x32x16_bf16 v[80:95], v[156:159], v[44:47], v[80:95]
    v_lshlrev_b32 v10, 2, v10
    v_add_u32 v10, 0x24a00, v10
    ds_read_b32 v11, v10
    ds_read_b32 v12, v10 offset:512
    v_cmp_gt_u32 vcc, 32, v0
    v_mov_b32 v22, 0
    v_xor_b32 v50, 352, v48
    ds_read_b128 v[44:47], v50
    s_waitcnt lgkmcnt(5)
    v_mfma_f32_32x32x16_bf16 v[80:95], v[160:163], v[32:35], v[80:95]
    v_mov_b32 v23, 0
    s_waitcnt lgkmcnt(2)
    v_sub_f32 v11, 0, v11
    v_cvt_pk_bf16_f32 v20, v11, v11
    s_waitcnt lgkmcnt(1)
    v_mul_f32 v6, 0xbfb8aa3b, v12
    v_mul_f32 v7, v12, v12
    v_xor_b32 v49, 384, v48
    ds_read_b128 v[32:35], v49
    v_mfma_f32_32x32x16_bf16 v[80:95], v[164:167], v[36:39], v[80:95]
    v_and_b32 v13, 0xffff0000, v20
    v_sub_f32 v13, v11, v13
    v_rcp_f32 v7, v7
    v_cvt_pk_bf16_f32 v21, v13, 0
    v_xor_b32 v50, 416, v48
    ds_read_b128 v[36:39], v50
    v_mfma_f32_32x32x16_bf16 v[80:95], v[168:171], v[40:43], v[80:95]
    v_cndmask_b32 v20, 0, v20, vcc
    v_cndmask_b32 v21, 0, v21, vcc
    s_nop 1
    v_mfma_f32_32x32x16_bf16 v[96:111], v[56:59], v[20:23], v[96:111]
    v_mfma_f32_32x32x16_bf16 v[112:127], v[60:63], v[20:23], v[112:127]
    v_xor_b32 v49, 448, v48
    ds_read_b128 v[40:43], v49
    s_waitcnt lgkmcnt(3)
    v_mfma_f32_32x32x16_bf16 v[80:95], v[172:175], v[44:47], v[80:95]
    s_lshl_b32 s4, s89, 2
    s_lshl_b32 s5, s93, 1
    s_add_u32 s4, s4, s5
    s_add_u32 s4, s4, 0
    s_lshl_b32 s4, s4, 10
    s_mul_i32 s5, s88, 0xb0000
    s_add_u32 s4, s4, s5
    s_add_u32 s9, s4, 0x200000
    v_mul_f32 v10, v6, v96
    v_xor_b32 v50, 480, v48
    ds_read_b128 v[44:47], v50
    s_waitcnt lgkmcnt(3)
    v_mfma_f32_32x32x16_bf16 v[80:95], v[176:179], v[32:35], v[80:95]
    v_mul_f32 v11, v6, v97
    v_mul_f32 v12, v6, v98
    v_mul_f32 v13, v6, v99
    v_exp_f32 v10, v10
    s_waitcnt vmcnt(0)
    v_cmp_eq_u32 vcc, s26, v79
    s_nop 3
    s_cmp_eq_u64 vcc, exec
    s_cbranch_scc1 L_ssd7
    s_mov_b32 s97, 400000
L_ss6:
    s_sleep 1
    buffer_load_dwordx2 v[78:79], v70, s[60:63], 0 offen sc0 sc1
    s_waitcnt vmcnt(0)
    v_cmp_eq_u32 vcc, s26, v79
    s_nop 4
    s_cmp_eq_u64 vcc, exec
    s_cbranch_scc1 L_ssd7
    s_sub_u32 s97, s97, 1
    s_cmp_lg_u32 s97, 0
    s_cbranch_scc1 L_ss6
L_ssd7:
    s_nop 4
    v_cvt_pk_bf16_f32 v71, v78, 0
    v_lshlrev_b32 v69, 16, v71
    v_sub_f32 v69, v78, v69
    v_cvt_pk_bf16_f32 v69, v69, 0
    v_lshl_or_b32 v70, v69, 16, v71
    v_lshlrev_b32 v69, 3, v0
    v_add_u32 v69, 0x24800, v69
    ds_write_b64 v69, v[70:71]
    s_waitcnt lgkmcnt(0)
    s_barrier
    s_mov_b32 s7, 0x0
    v_add_u32 v48, s7, v8
    v_xor_b32 v49, 0, v48
    ds_read_b128 v[32:35], v49
    v_mfma_f32_32x32x16_bf16 v[80:95], v[180:183], v[36:39], v[80:95]
    v_xor_b32 v50, 32, v48
    ds_read_b128 v[36:39], v50
    v_mfma_f32_32x32x16_bf16 v[80:95], v[184:187], v[40:43], v[80:95]
    v_xor_b32 v49, 64, v48
    ds_read_b128 v[40:43], v49
    v_mfma_f32_32x32x16_bf16 v[80:95], v[188:191], v[44:47], v[80:95]
    v_xor_b32 v50, 96, v48
    ds_read_b128 v[44:47], v50
    s_waitcnt lgkmcnt(3)
    v_mfma_f32_32x32x16_bf16 v[80:95], v[192:195], v[32:35], v[80:95]
    s_lshl_b32 s6, s93, 8
    s_add_u32 s6, s6, 0x24800
    v_and_b32 v18, 31, v0
    v_lshlrev_b32 v18, 3, v18
    v_add_u32 v18, s6, v18
    ds_read_b64 v[64:65], v18
    v_mov_b32 v66, 0
    v_mov_b32 v67, 0
    v_xor_b32 v49, 128, v48
    ds_read_b128 v[32:35], v49
    s_waitcnt lgkmcnt(4)
    v_mfma_f32_32x32x16_bf16 v[80:95], v[196:199], v[36:39], v[80:95]
    v_exp_f32 v11, v11
    v_exp_f32 v12, v12
    v_xor_b32 v50, 160, v48
    ds_read_b128 v[36:39], v50
    s_waitcnt lgkmcnt(4)
    v_mfma_f32_32x32x16_bf16 v[80:95], v[200:203], v[40:43], v[80:95]
    v_exp_f32 v13, v13
    v_mul_f32 v14, v96, v104
    v_mul_f32 v15, v97, v105
    v_mul_f32 v16, v98, v106
    v_xor_b32 v49, 192, v48
    ds_read_b128 v[40:43], v49
    s_waitcnt lgkmcnt(4)
    v_mfma_f32_32x32x16_bf16 v[80:95], v[204:207], v[44:47], v[80:95]
    v_mul_f32 v17, v99, v107
    v_fma_f32 v10, v10, v7, v7
    v_fma_f32 v11, v11, v7, v7
    v_fma_f32 v12, v12, v7, v7
    v_fma_f32 v13, v13, v7, v7
    v_xor_b32 v50, 224, v48
    ds_read_b128 v[44:47], v50
    s_waitcnt lgkmcnt(3)
    v_mfma_f32_32x32x16_bf16 v[80:95], v[208:211], v[32:35], v[80:95]
    v_rcp_f32 v10, v10
    v_rcp_f32 v11, v11
    v_rcp_f32 v12, v12
    v_xor_b32 v49, 256, v48
    ds_read_b128 v[32:35], v49
    s_waitcnt lgkmcnt(3)
    v_mfma_f32_32x32x16_bf16 v[80:95], v[212:215], v[36:39], v[80:95]
    v_rcp_f32 v13, v13
    v_mul_f32 v14, v14, v10
    v_mul_f32 v15, v15, v11
    v_xor_b32 v50, 288, v48
    ds_read_b128 v[36:39], v50
    s_waitcnt lgkmcnt(3)
    v_mfma_f32_32x32x16_bf16 v[80:95], v[216:219], v[40:43], v[80:95]
    v_mul_f32 v16, v16, v12
    v_mul_f32 v17, v17, v13
    v_cvt_pk_bf16_f32 v96, v14, v15
    v_cvt_pk_bf16_f32 v97, v16, v17
    v_mul_f32 v10, v6, v100
    v_xor_b32 v49, 320, v48
    ds_read_b128 v[40:43], v49
    s_waitcnt lgkmcnt(3)
    v_mfma_f32_32x32x16_bf16 v[80:95], v[220:223], v[44:47], v[80:95]
    v_mul_f32 v11, v6, v101
    v_mul_f32 v12, v6, v102
    v_mul_f32 v13, v6, v103
    v_exp_f32 v10, v10
    v_xor_b32 v50, 352, v48
    ds_read_b128 v[44:47], v50
    s_waitcnt lgkmcnt(3)
    v_mfma_f32_32x32x16_bf16 v[80:95], v[224:227], v[32:35], v[80:95]
    v_exp_f32 v11, v11
    v_exp_f32 v12, v12
    v_exp_f32 v13, v13
    v_xor_b32 v49, 384, v48
    ds_read_b128 v[32:35], v49
    s_waitcnt lgkmcnt(3)
    v_mfma_f32_32x32x16_bf16 v[80:95], v[228:231], v[36:39], v[80:95]
    v_mul_f32 v14, v100, v108
    v_mul_f32 v15, v101, v109
    v_mul_f32 v16, v102, v110
    v_mul_f32 v17, v103, v111
    v_xor_b32 v50, 416, v48
    ds_read_b128 v[36:39], v50
    s_waitcnt lgkmcnt(3)
    v_mfma_f32_32x32x16_bf16 v[80:95], v[232:235], v[40:43], v[80:95]
    v_fma_f32 v10, v10, v7, v7
    v_fma_f32 v11, v11, v7, v7
    v_fma_f32 v12, v12, v7, v7
    v_fma_f32 v13, v13, v7, v7
    v_rcp_f32 v10, v10
    v_xor_b32 v49, 448, v48
    ds_read_b128 v[40:43], v49
    s_waitcnt lgkmcnt(3)
    v_mfma_f32_32x32x16_bf16 v[80:95], v[236:239], v[44:47], v[80:95]
    v_rcp_f32 v11, v11
    v_rcp_f32 v12, v12
    v_xor_b32 v50, 480, v48
    ds_read_b128 v[44:47], v50
    s_waitcnt lgkmcnt(3)
    v_mfma_f32_32x32x16_bf16 v[80:95], v[240:243], v[32:35], v[80:95]
    v_rcp_f32 v13, v13
    v_mul_f32 v14, v14, v10
    v_mul_f32 v15, v15, v11
    v_mul_f32 v16, v16, v12
    s_waitcnt lgkmcnt(2)
    v_mfma_f32_32x32x16_bf16 v[80:95], v[244:247], v[36:39], v[80:95]
    v_mul_f32 v17, v17, v13
    v_cvt_pk_bf16_f32 v98, v14, v15
    v_cvt_pk_bf16_f32 v99, v16, v17
    buffer_store_dwordx4 v[96:99], v1, s[60:63], s9 offen offset:0 sc1
    v_mul_f32 v10, v6, v112
    s_waitcnt lgkmcnt(1)
    v_mfma_f32_32x32x16_bf16 v[80:95], v[248:251], v[40:43], v[80:95]
    v_mul_f32 v11, v6, v113
    v_mul_f32 v12, v6, v114
    v_mul_f32 v13, v6, v115
    v_exp_f32 v10, v10
    s_waitcnt lgkmcnt(0)
    v_mfma_f32_32x32x16_bf16 v[80:95], v[252:255], v[44:47], v[80:95]
    v_exp_f32 v11, v11
    v_exp_f32 v12, v12
    v_exp_f32 v13, v13
    v_mul_f32 v14, v112, v120
    v_mul_f32 v15, v113, v121
    v_mul_f32 v16, v114, v122
    v_mul_f32 v17, v115, v123
    v_fma_f32 v10, v10, v7, v7
    v_fma_f32 v11, v11, v7, v7
    v_fma_f32 v12, v12, v7, v7
    v_fma_f32 v13, v13, v7, v7
    v_rcp_f32 v10, v10
    v_rcp_f32 v11, v11
    v_rcp_f32 v12, v12
    v_rcp_f32 v13, v13
    v_mul_f32 v14, v14, v10
    v_mul_f32 v15, v15, v11
    v_mul_f32 v16, v16, v12
    v_mul_f32 v17, v17, v13
    v_cvt_pk_bf16_f32 v112, v14, v15
    v_cvt_pk_bf16_f32 v113, v16, v17
    v_mul_f32 v10, v6, v116
    v_mul_f32 v11, v6, v117
    v_mul_f32 v12, v6, v118
    v_mul_f32 v13, v6, v119
    v_exp_f32 v10, v10
    v_exp_f32 v11, v11
    v_exp_f32 v12, v12
    v_exp_f32 v13, v13
    v_mul_f32 v14, v116, v124
    v_mul_f32 v15, v117, v125
    v_mul_f32 v16, v118, v126
    v_mul_f32 v17, v119, v127
    v_fma_f32 v10, v10, v7, v7
    v_fma_f32 v11, v11, v7, v7
    v_fma_f32 v12, v12, v7, v7
    v_fma_f32 v13, v13, v7, v7
    v_rcp_f32 v10, v10
    v_rcp_f32 v11, v11
    v_rcp_f32 v12, v12
    v_rcp_f32 v13, v13
    v_mul_f32 v14, v14, v10
    v_mul_f32 v15, v15, v11
    v_mul_f32 v16, v16, v12
    v_mul_f32 v17, v17, v13
    v_cvt_pk_bf16_f32 v114, v14, v15
    v_cvt_pk_bf16_f32 v115, v16, v17
    buffer_store_dwordx4 v[112:115], v1, s[60:63], s9 offen offset:1024 sc1
    v_mfma_f32_32x32x16_bf16 v[80:95], v[20:23], v[64:67], v[80:95]
    s_barrier
    v_add_u32 v4, 0x8000, v2
    v_add_u32 v5, 0x8000, v3
    ds_read_b64_tr_b16 v[32:33], v4 offset:0
    ds_read_b64_tr_b16 v[34:35], v4 offset:512
    ds_read_b64_tr_b16 v[36:37], v5 offset:0
    ds_read_b64_tr_b16 v[38:39], v5 offset:512
    ds_read_b64_tr_b16 v[40:41], v4 offset:4096
    ds_read_b64_tr_b16 v[42:43], v4 offset:4608
    ds_read_b64_tr_b16 v[44:45], v5 offset:4096
    ds_read_b64_tr_b16 v[46:47], v5 offset:4608
    s_waitcnt lgkmcnt(6)
    v_mfma_f32_32x32x16_bf16 v[48:63], v[32:35], v[128:131], 0
    s_waitcnt lgkmcnt(4)
    v_mfma_f32_32x32x16_bf16 v[64:79], v[36:39], v[128:131], 0
    ds_read_b64_tr_b16 v[32:33], v4 offset:8192
    ds_read_b64_tr_b16 v[34:35], v4 offset:8704
    ds_read_b64_tr_b16 v[36:37], v5 offset:8192
    ds_read_b64_tr_b16 v[38:39], v5 offset:8704
    s_waitcnt lgkmcnt(6)
    v_mfma_f32_32x32x16_bf16 v[48:63], v[40:43], v[132:135], v[48:63]
    s_waitcnt lgkmcnt(4)
    v_mfma_f32_32x32x16_bf16 v[64:79], v[44:47], v[132:135], v[64:79]
    v_and_b32 v10, 15, v0
    s_lshl_b32 s4, s93, 4
    v_add_u32 v10, s4, v10
    v_lshlrev_b32 v10, 6, v10
    v_add_u32 v10, 0x24e00, v10
    ds_read_b64_tr_b16 v[40:41], v4 offset:12288
    ds_read_b64_tr_b16 v[42:43], v4 offset:12800
    ds_read_b64_tr_b16 v[44:45], v5 offset:12288
    ds_read_b64_tr_b16 v[46:47], v5 offset:12800
    v_add_u32 v4, 0xc000, v2
    v_add_u32 v5, 0xc000, v3
    ds_read_b64_tr_b16 v[128:129], v4 offset:0
    ds_read_b64_tr_b16 v[130:131], v4 offset:512
    ds_read_b64_tr_b16 v[132:133], v5 offset:0
    ds_read_b64_tr_b16 v[134:135], v5 offset:512
    s_waitcnt lgkmcnt(10)
    v_mfma_f32_32x32x16_bf16 v[48:63], v[32:35], v[136:139], v[48:63]
    v_lshrrev_b32 v11, 4, v0
    v_lshlrev_b32 v11, 5, v11
    s_lshl_b32 s4, s92, 7
    s_add_u32 s4, s4, 0x24c00
    v_add_u32 v11, s4, v11
    s_waitcnt lgkmcnt(8)
    v_mfma_f32_32x32x16_bf16 v[64:79], v[36:39], v[136:139], v[64:79]
    ds_read_b128 v[108:111], v11
    ds_read_b128 v[112:115], v11 offset:16
    ds_read_b128 v[96:99], v10
    ds_read_b128 v[100:103], v10 offset:16
    ds_read_b128 v[104:107], v10 offset:32
    v_permlane16_swap_b32 v80, v88
    ds_read_b64_tr_b16 v[32:33], v4 offset:4096
    ds_read_b64_tr_b16 v[34:35], v4 offset:4608
    ds_read_b64_tr_b16 v[36:37], v5 offset:4096
    ds_read_b64_tr_b16 v[38:39], v5 offset:4608
    s_waitcnt lgkmcnt(15)
    v_mfma_f32_32x32x16_bf16 v[48:63], v[40:43], v[140:143], v[48:63]
    v_permlane16_swap_b32 v81, v89
    v_permlane16_swap_b32 v82, v90
    v_permlane16_swap_b32 v83, v91
    v_permlane16_swap_b32 v84, v92
    s_waitcnt lgkmcnt(13)
    v_mfma_f32_32x32x16_bf16 v[64:79], v[44:47], v[140:143], v[64:79]
    v_permlane16_swap_b32 v85, v93
    v_permlane16_swap_b32 v86, v94
    v_permlane16_swap_b32 v87, v95
    s_waitcnt lgkmcnt(8)
    v_mul_f32 v80, v108, v80
    ds_read_b64_tr_b16 v[40:41], v4 offset:8192
    ds_read_b64_tr_b16 v[42:43], v4 offset:8704
    ds_read_b64_tr_b16 v[44:45], v5 offset:8192
    ds_read_b64_tr_b16 v[46:47], v5 offset:8704
    v_mfma_f32_32x32x16_bf16 v[48:63], v[128:131], v[144:147], v[48:63]
    v_mul_f32 v88, v108, v88
    v_mul_f32 v81, v109, v81
    v_mul_f32 v89, v109, v89
    v_mul_f32 v82, v110, v82
    v_mfma_f32_32x32x16_bf16 v[64:79], v[132:135], v[144:147], v[64:79]
    v_mul_f32 v90, v110, v90
    v_mul_f32 v83, v111, v83
    v_mul_f32 v91, v111, v91
    s_waitcnt lgkmcnt(11)
    v_mul_f32 v84, v112, v84
    ds_read_b64_tr_b16 v[128:129], v4 offset:12288
    ds_read_b64_tr_b16 v[130:131], v4 offset:12800
    ds_read_b64_tr_b16 v[132:133], v5 offset:12288
    ds_read_b64_tr_b16 v[134:135], v5 offset:12800
    s_waitcnt lgkmcnt(10)
    v_mfma_f32_32x32x16_bf16 v[48:63], v[32:35], v[148:151], v[48:63]
    v_mul_f32 v92, v112, v92
    v_mul_f32 v85, v113, v85
    v_mul_f32 v93, v113, v93
    v_mul_f32 v86, v114, v86
    s_waitcnt lgkmcnt(8)
    v_mfma_f32_32x32x16_bf16 v[64:79], v[36:39], v[148:151], v[64:79]
    v_mul_f32 v94, v114, v94
    v_mul_f32 v87, v115, v87
    v_mul_f32 v95, v115, v95
    v_fma_f32 v118, v98, v80, v81
    v_fma_f32 v119, v98, v88, v89
    v_fma_f32 v118, -v99, v88, v118
    v_fma_f32 v119, v99, v80, v119
    v_fma_f32 v120, v98, v118, v82
    v_fma_f32 v121, v98, v119, v90
    v_fma_f32 v120, -v99, v119, v120
    v_fma_f32 v121, v99, v118, v121
    v_fma_f32 v118, v98, v120, v83
    v_fma_f32 v119, v98, v121, v91
    v_fma_f32 v118, -v99, v121, v118
    v_fma_f32 v119, v99, v120, v119
    v_fma_f32 v120, v98, v118, v84
    v_fma_f32 v121, v98, v119, v92
    v_fma_f32 v120, -v99, v119, v120
    v_fma_f32 v121, v99, v118, v121
    v_fma_f32 v118, v98, v120, v85
    v_fma_f32 v119, v98, v121, v93
    v_fma_f32 v118, -v99, v121, v118
    v_fma_f32 v119, v99, v120, v119
    v_fma_f32 v120, v98, v118, v86
    v_fma_f32 v121, v98, v119, v94
    v_fma_f32 v120, -v99, v119, v120
    v_fma_f32 v121, v99, v118, v121
    v_fma_f32 v118, v98, v120, v87
    v_fma_f32 v119, v98, v121, v95
    v_fma_f32 v118, -v99, v121, v118
    v_fma_f32 v119, v99, v120, v119
    v_mov_b32 v120, v118
    v_mov_b32 v122, v118
    v_mov_b32 v121, v119
    v_mov_b32 v123, v119
    v_bfe_u32 v12, v0, 4, 1
    v_cmp_eq_u32 vcc, 1, v12
    v_permlane16_swap_b32 v120, v122
    v_permlane16_swap_b32 v121, v123
    v_lshrrev_b32 v12, 4, v0
    v_and_b32 v10, 15, v0
    v_lshlrev_b32 v10, 5, v10
    v_fma_f32 v118, v102, v120, v122
    v_fma_f32 v119, v102, v121, v123
    v_fma_f32 v118, -v103, v121, v118
    v_fma_f32 v119, v103, v120, v119
    v_cndmask_b32 v116, 0, v120, vcc
    v_cndmask_b32 v117, 0, v121, vcc
    v_mov_b32 v124, v118
    v_mov_b32 v126, v118
    v_mov_b32 v125, v119
    v_mov_b32 v127, v119
    s_lshl_b32 s4, s93, 9
    s_lshl_b32 s5, s92, 3
    s_add_u32 s4, s4, s5
    s_add_u32 s4, s4, 0x25600
    v_permlane32_swap_b32 v124, v126
    v_permlane32_swap_b32 v125, v127
    v_add_u32 v10, s4, v10
    v_fma_f32 v126, v104, v124, v126
    v_fma_f32 v127, v104, v125, v127
    v_fma_f32 v126, -v105, v125, v126
    v_fma_f32 v127, v105, v124, v127
    ds_write_b64 v10, v[126:127]
    v_fma_f32 v120, v102, v124, v116
    v_fma_f32 v121, v102, v125, v117
    v_fma_f32 v120, -v103, v125, v120
    v_fma_f32 v121, v103, v124, v121
    v_add_f32 v122, v124, v116
    v_add_f32 v123, v125, v117
    v_cmp_eq_u32 vcc, 2, v12
    s_nop 1
    v_cndmask_b32 v116, v116, v122, vcc
    v_cndmask_b32 v117, v117, v123, vcc
    v_cmp_eq_u32 vcc, 3, v12
    s_nop 1
    v_cndmask_b32 v116, v116, v120, vcc
    v_cndmask_b32 v117, v117, v121, vcc
    s_waitcnt vmcnt(0)
    s_waitcnt lgkmcnt(0)
    s_barrier
    s_add_u32 s101, s26, 2
    v_mov_b32 v19, s101
    buffer_store_dword v19, v24, s[60:63], 0 offen offset:0 sc0 sc1
    v_add_u32 v4, 0x10000, v2
    v_add_u32 v5, 0x10000, v3
    ds_read_b64_tr_b16 v[32:33], v4 offset:0
    ds_read_b64_tr_b16 v[34:35], v4 offset:512
    ds_read_b64_tr_b16 v[36:37], v5 offset:0
    ds_read_b64_tr_b16 v[38:39], v5 offset:512
    v_mfma_f32_32x32x16_bf16 v[48:63], v[40:43], v[152:155], v[48:63]
    v_mfma_f32_32x32x16_bf16 v[64:79], v[44:47], v[152:155], v[64:79]
    ds_read_b64_tr_b16 v[40:41], v4 offset:4096
    ds_read_b64_tr_b16 v[42:43], v4 offset:4608
    ds_read_b64_tr_b16 v[44:45], v5 offset:4096
    ds_read_b64_tr_b16 v[46:47], v5 offset:4608
    v_mfma_f32_32x32x16_bf16 v[48:63], v[128:131], v[156:159], v[48:63]
    v_mfma_f32_32x32x16_bf16 v[64:79], v[132:135], v[156:159], v[64:79]
    v_and_b32 v10, 15, v0
    v_lshlrev_b32 v10, 5, v10
    s_lshl_b32 s4, s93, 9
    s_add_u32 s4, s4, 0x25600
    v_add_u32 v10, s4, v10
    ds_read_b128 v[108:111], v10
    ds_read_b64_tr_b16 v[128:129], v4 offset:8192
    ds_read_b64_tr_b16 v[130:131], v4 offset:8704
    ds_read_b64_tr_b16 v[132:133], v5 offset:8192
    ds_read_b64_tr_b16 v[134:135], v5 offset:8704
    s_waitcnt lgkmcnt(11)
    v_mfma_f32_32x32x16_bf16 v[48:63], v[32:35], v[160:163], v[48:63]
    ds_read_b128 v[112:115], v10 offset:16
    s_lshl_b32 s4, s89, 13
    s_lshl_b32 s5, s88, 9
    s_add_u32 s4, s4, s5
    s_lshl_b32 s5, s93, 8
    s_add_u32 s4, s4, s5
    s_add_u32 s4, s4, 0x10000
    s_cmp_eq_u32 s92, 0
    s_cselect_b32 s4, s4, 0x7ff00000
    s_waitcnt lgkmcnt(10)
    v_mfma_f32_32x32x16_bf16 v[64:79], v[36:39], v[160:163], v[64:79]
    v_lshlrev_b32 v11, 4, v0
    v_mov_b32 v12, 0x7ff00000
    v_cmp_gt_u32 vcc, 16, v0
    s_nop 1
    v_cndmask_b32 v11, v12, v11, vcc
    ds_read_b64_tr_b16 v[32:33], v4 offset:12288
    ds_read_b64_tr_b16 v[34:35], v4 offset:12800
    ds_read_b64_tr_b16 v[36:37], v5 offset:12288
    ds_read_b64_tr_b16 v[38:39], v5 offset:12800
    s_waitcnt lgkmcnt(12)
    v_mfma_f32_32x32x16_bf16 v[48:63], v[40:43], v[164:167], v[48:63]
    v_add_u32 v11, s4, v11
    v_mov_b32 v125, s26
    v_mov_b32 v127, s26
    s_waitcnt lgkmcnt(9)
    v_fma_f32 v110, v106, v108, v110
    v_mfma_f32_32x32x16_bf16 v[64:79], v[44:47], v[164:167], v[64:79]
    v_fma_f32 v111, v106, v109, v111
    v_fma_f32 v110, -v107, v109, v110
    v_fma_f32 v111, v107, v108, v111
    s_waitcnt lgkmcnt(4)
    v_fma_f32 v112, v106, v110, v112
    v_add_u32 v4, 0x14000, v2
    v_add_u32 v5, 0x14000, v3
    ds_read_b64_tr_b16 v[40:41], v4 offset:0
    ds_read_b64_tr_b16 v[42:43], v4 offset:512
    ds_read_b64_tr_b16 v[44:45], v5 offset:0
    ds_read_b64_tr_b16 v[46:47], v5 offset:512
    v_mfma_f32_32x32x16_bf16 v[48:63], v[128:131], v[168:171], v[48:63]
    v_fma_f32 v113, v106, v111, v113
    v_fma_f32 v112, -v107, v111, v112
    v_fma_f32 v113, v107, v110, v113
    v_fma_f32 v114, v106, v112, v114
    v_mfma_f32_32x32x16_bf16 v[64:79], v[132:135], v[168:171], v[64:79]
    v_fma_f32 v115, v106, v113, v115
    v_fma_f32 v114, -v107, v113, v114
    v_fma_f32 v115, v107, v112, v115
    v_mov_b32 v124, v114
    ds_read_b64_tr_b16 v[128:129], v4 offset:4096
    ds_read_b64_tr_b16 v[130:131], v4 offset:4608
    ds_read_b64_tr_b16 v[132:133], v5 offset:4096
    ds_read_b64_tr_b16 v[134:135], v5 offset:4608
    s_waitcnt lgkmcnt(10)
    v_mfma_f32_32x32x16_bf16 v[48:63], v[32:35], v[172:175], v[48:63]
    v_mov_b32 v126, v115
    buffer_store_dwordx4 v[124:127], v11, s[60:63], 0 offen sc0 sc1
    v_mov_b32 v118, 0
    v_mov_b32 v119, 0
    s_waitcnt lgkmcnt(8)
    v_mfma_f32_32x32x16_bf16 v[64:79], v[36:39], v[172:175], v[64:79]
    s_cmp_eq_u32 s92, 1
    s_cselect_b64 s[98:99], -1, 0
    v_cndmask_b32 v118, v118, v108, s[98:99]
    v_cndmask_b32 v119, v119, v109, s[98:99]
    s_cmp_eq_u32 s92, 2
    s_cselect_b64 s[98:99], -1, 0
    v_cndmask_b32 v118, v118, v110, s[98:99]
    ds_read_b64_tr_b16 v[32:33], v4 offset:8192
    ds_read_b64_tr_b16 v[34:35], v4 offset:8704
    ds_read_b64_tr_b16 v[36:37], v5 offset:8192
    ds_read_b64_tr_b16 v[38:39], v5 offset:8704
    s_waitcnt lgkmcnt(10)
    v_mfma_f32_32x32x16_bf16 v[48:63], v[40:43], v[176:179], v[48:63]
    v_cndmask_b32 v119, v119, v111, s[98:99]
    s_cmp_eq_u32 s92, 3
    s_cselect_b64 s[98:99], -1, 0
    v_cndmask_b32 v118, v118, v112, s[98:99]
    v_cndmask_b32 v119, v119, v113, s[98:99]
    s_waitcnt lgkmcnt(8)
    v_mfma_f32_32x32x16_bf16 v[64:79], v[44:47], v[176:179], v[64:79]
    v_lshrrev_b32 v11, 4, v0
    v_lshlrev_b32 v11, 3, v11
    v_cvt_f32_u32 v12, v11
    s_lshl_b32 s4, s92, 5
    v_add_u32 v11, s4, v11
    ds_read_b64_tr_b16 v[40:41], v4 offset:12288
    ds_read_b64_tr_b16 v[42:43], v4 offset:12800
    ds_read_b64_tr_b16 v[44:45], v5 offset:12288
    ds_read_b64_tr_b16 v[46:47], v5 offset:12800
    s_waitcnt lgkmcnt(10)
    v_mfma_f32_32x32x16_bf16 v[48:63], v[128:131], v[180:183], v[48:63]
    v_cvt_f32_u32 v13, v11
    v_mul_f32 v14, v12, v96
    v_mul_f32 v121, v12, v97
    v_exp_f32 v14, v14
    s_waitcnt lgkmcnt(8)
    v_mfma_f32_32x32x16_bf16 v[64:79], v[132:135], v[180:183], v[64:79]
    v_fract_f32 v121, v121
    v_cos_f32 v120, v121
    s_waitcnt lgkmcnt(0)
    s_barrier
    v_add_u32 v4, 0x18000, v2
    v_add_u32 v5, 0x18000, v3
    ds_read_b64_tr_b16 v[128:129], v4 offset:0
    ds_read_b64_tr_b16 v[130:131], v4 offset:512
    ds_read_b64_tr_b16 v[132:133], v5 offset:0
    ds_read_b64_tr_b16 v[134:135], v5 offset:512
    v_mfma_f32_32x32x16_bf16 v[48:63], v[32:35], v[184:187], v[48:63]
    v_mfma_f32_32x32x16_bf16 v[64:79], v[36:39], v[184:187], v[64:79]
    ds_read_b64_tr_b16 v[32:33], v4 offset:4096
    ds_read_b64_tr_b16 v[34:35], v4 offset:4608
    ds_read_b64_tr_b16 v[36:37], v5 offset:4096
    ds_read_b64_tr_b16 v[38:39], v5 offset:4608
    v_mfma_f32_32x32x16_bf16 v[48:63], v[40:43], v[188:191], v[48:63]
    v_mfma_f32_32x32x16_bf16 v[64:79], v[44:47], v[188:191], v[64:79]
    v_sin_f32 v121, v121
    s_nop 0
    v_mul_f32 v120, v120, v14
    v_mul_f32 v121, v121, v14
    ds_read_b64_tr_b16 v[40:41], v4 offset:8192
    ds_read_b64_tr_b16 v[42:43], v4 offset:8704
    ds_read_b64_tr_b16 v[44:45], v5 offset:8192
    ds_read_b64_tr_b16 v[46:47], v5 offset:8704
    s_waitcnt lgkmcnt(10)
    v_mfma_f32_32x32x16_bf16 v[48:63], v[128:131], v[192:195], v[48:63]
    v_fma_f32 v116, v120, v118, v116
    v_fma_f32 v117, v120, v119, v117
    v_fma_f32 v116, -v121, v119, v116
    v_fma_f32 v117, v121, v118, v117
    s_waitcnt lgkmcnt(8)
    v_mfma_f32_32x32x16_bf16 v[64:79], v[132:135], v[192:195], v[64:79]
    v_mul_f32 v14, v13, v96
    v_mul_f32 v121, v13, v97
    v_exp_f32 v14, v14
    ds_read_b64_tr_b16 v[128:129], v4 offset:12288
    ds_read_b64_tr_b16 v[130:131], v4 offset:12800
    ds_read_b64_tr_b16 v[132:133], v5 offset:12288
    ds_read_b64_tr_b16 v[134:135], v5 offset:12800
    s_waitcnt lgkmcnt(10)
    v_mfma_f32_32x32x16_bf16 v[48:63], v[32:35], v[196:199], v[48:63]
    v_fract_f32 v121, v121
    v_cos_f32 v120, v121
    v_sin_f32 v121, v121
    s_waitcnt lgkmcnt(8)
    v_mfma_f32_32x32x16_bf16 v[64:79], v[36:39], v[196:199], v[64:79]
    s_nop 0
    v_mul_f32 v120, v120, v14
    v_mul_f32 v121, v121, v14
    v_add_u32 v4, 0x1c000, v2
    v_add_u32 v5, 0x1c000, v3
    ds_read_b64_tr_b16 v[32:33], v4 offset:0
    ds_read_b64_tr_b16 v[34:35], v4 offset:512
    ds_read_b64_tr_b16 v[36:37], v5 offset:0
    ds_read_b64_tr_b16 v[38:39], v5 offset:512
    s_waitcnt lgkmcnt(10)
    v_mfma_f32_32x32x16_bf16 v[48:63], v[40:43], v[200:203], v[48:63]
    v_mul_f32 v122, v120, v100
    v_mul_f32 v123, v120, v101
    v_fma_f32 v122, -v121, v101, v122
    v_fma_f32 v123, v121, v100, v123
    s_waitcnt lgkmcnt(8)
    v_mfma_f32_32x32x16_bf16 v[64:79], v[44:47], v[200:203], v[64:79]
    v_mul_f32 v120, v116, v100
    v_mul_f32 v121, v116, v101
    v_fma_f32 v120, -v117, v101, v120
    v_fma_f32 v121, v117, v100, v121
    ds_read_b64_tr_b16 v[40:41], v4 offset:4096
    ds_read_b64_tr_b16 v[42:43], v4 offset:4608
    ds_read_b64_tr_b16 v[44:45], v5 offset:4096
    ds_read_b64_tr_b16 v[46:47], v5 offset:4608
    s_waitcnt lgkmcnt(10)
    v_mfma_f32_32x32x16_bf16 v[48:63], v[128:131], v[204:207], v[48:63]
    v_mov_b32 v116, v120
    v_mov_b32 v117, v121
    v_mul_f32 v12, v100, v80
    v_mul_f32 v13, v101, v80
    s_waitcnt lgkmcnt(8)
    v_mfma_f32_32x32x16_bf16 v[64:79], v[132:135], v[204:207], v[64:79]
    v_fma_f32 v80, -v101, v88, v12
    v_fma_f32 v88, v100, v88, v13
    v_mul_f32 v10, v100, v81
    v_mul_f32 v11, v101, v81
    ds_read_b64_tr_b16 v[128:129], v4 offset:8192
    ds_read_b64_tr_b16 v[130:131], v4 offset:8704
    ds_read_b64_tr_b16 v[132:133], v5 offset:8192
    ds_read_b64_tr_b16 v[134:135], v5 offset:8704
    s_waitcnt lgkmcnt(10)
    v_mfma_f32_32x32x16_bf16 v[48:63], v[32:35], v[208:211], v[48:63]
    v_fma_f32 v81, -v101, v89, v10
    v_fma_f32 v89, v100, v89, v11
    v_mul_f32 v12, v100, v82
    v_mul_f32 v13, v101, v82
    s_waitcnt lgkmcnt(8)
    v_mfma_f32_32x32x16_bf16 v[64:79], v[36:39], v[208:211], v[64:79]
    v_fma_f32 v82, -v101, v90, v12
    v_fma_f32 v90, v100, v90, v13
    v_mul_f32 v10, v100, v83
    v_mul_f32 v11, v101, v83
    ds_read_b64_tr_b16 v[32:33], v4 offset:12288
    ds_read_b64_tr_b16 v[34:35], v4 offset:12800
    ds_read_b64_tr_b16 v[36:37], v5 offset:12288
    ds_read_b64_tr_b16 v[38:39], v5 offset:12800
    s_waitcnt lgkmcnt(10)
    v_mfma_f32_32x32x16_bf16 v[48:63], v[40:43], v[212:215], v[48:63]
    v_fma_f32 v83, -v101, v91, v10
    v_fma_f32 v91, v100, v91, v11
    v_mul_f32 v12, v100, v84
    v_mul_f32 v13, v101, v84
    s_waitcnt lgkmcnt(8)
    v_mfma_f32_32x32x16_bf16 v[64:79], v[44:47], v[212:215], v[64:79]
    v_fma_f32 v84, -v101, v92, v12
    v_fma_f32 v92, v100, v92, v13
    v_mul_f32 v10, v100, v85
    v_mul_f32 v11, v101, v85
    v_fma_f32 v85, -v101, v93, v10
    v_fma_f32 v93, v100, v93, v11
    v_mul_f32 v12, v100, v86
    v_mul_f32 v13, v101, v86
    v_fma_f32 v86, -v101, v94, v12
    v_fma_f32 v94, v100, v94, v13
    v_mul_f32 v10, v100, v87
    v_mul_f32 v11, v101, v87
    v_fma_f32 v87, -v101, v95, v10
    v_fma_f32 v95, v100, v95, v11
    s_lshl_b32 s4, s93, 2
    s_add_u32 s4, s4, s92
    s_lshl_b32 s4, s4, 10
    s_add_u32 s4, s4, 0x25b00
    v_and_b32 v10, 15, v0
    v_lshlrev_b32 v10, 6, v10
    v_lshrrev_b32 v11, 4, v0
    v_lshl_add_u32 v10, v11, 4, v10
    v_add_u32 v124, s4, v10
    v_lshrrev_b32 v11, 5, v0
    v_lshlrev_b32 v11, 9, v11
    v_bfe_u32 v12, v0, 2, 2
    v_lshl_add_u32 v11, v12, 6, v11
    v_and_b32 v12, 1, v0
    v_lshl_add_u32 v11, v12, 5, v11
    v_bfe_u32 v12, v0, 4, 1
    v_lshl_add_u32 v11, v12, 4, v11
    v_bfe_u32 v12, v0, 1, 1
    v_lshl_add_u32 v11, v12, 3, v11
    v_add_u32 v125, s4, v11
    s_lshl_b32 s4, s89, 1
    s_add_u32 s4, s4, s93
    s_lshr_b32 s5, s4, 2
    s_lshl_b32 s5, s5, 3
    s_and_b32 s4, s4, 3
    s_add_u32 s4, s4, s5
    s_add_u32 s4, s4, 64
    s_lshl_b32 s4, s4, 10
    s_mul_i32 s5, s88, 0xb0000
    s_add_u32 s4, s4, s5
    s_add_u32 s27, s4, 0x200000
    s_add_u32 s8, s27, 4096
    v_and_b32 v10, 15, v0
    s_lshl_b32 s4, s93, 4
    v_add_u32 v10, s4, v10
    v_lshlrev_b32 v10, 3, v10
    v_add_u32 v126, 0x25a00, v10
    buffer_load_dword v27, v25, s[60:63], 0 offen sc0 sc1
    s_and_b32 s6, s92, 1
    v_and_b32 v113, 15, v0
    s_lshl_b32 s4, s6, 4
    v_add_u32 v113, s4, v113
    v_lshlrev_b32 v103, 6, v113
    v_add_u32 v103, 0x24e00, v103
    ds_read_b64 v[100:101], v103
    v_lshrrev_b32 v112, 4, v0
    v_lshlrev_b32 v113, 3, v113
    v_add_u32 v113, 0x25a00, v113
    s_sub_u32 s4, s88, 1
    v_sub_u32 v102, s4, v112
    v_cmp_le_i32 vcc, 0, v102
    v_max_i32 v102, 0, v102
    v_cvt_f32_i32 v102, v102
    v_mul_f32 v102, 0x43000000, v102
    s_waitcnt lgkmcnt(0)
    v_mul_f32 v103, v102, v100
    v_mul_f32 v105, v102, v101
    v_exp_f32 v103, v103
    v_fract_f32 v105, v105
    v_cos_f32 v104, v105
    v_sin_f32 v105, v105
    s_nop 0
    v_mul_f32 v104, v104, v103
    v_mul_f32 v105, v105, v103
    v_cndmask_b32 v104, 0, v104, vcc
    v_cndmask_b32 v105, 0, v105, vcc
    s_sub_u32 s4, s88, 5
    v_sub_u32 v102, s4, v112
    v_cmp_le_i32 vcc, 0, v102
    v_max_i32 v102, 0, v102
    v_cvt_f32_i32 v102, v102
    v_mul_f32 v102, 0x43000000, v102
    v_mul_f32 v103, v102, v100
    v_mul_f32 v107, v102, v101
    v_exp_f32 v103, v103
    v_fract_f32 v107, v107
    v_cos_f32 v106, v107
    v_sin_f32 v107, v107
    s_nop 0
    v_mul_f32 v106, v106, v103
    v_mul_f32 v107, v107, v103
    v_cndmask_b32 v106, 0, v106, vcc
    v_cndmask_b32 v107, 0, v107, vcc
    s_sub_u32 s4, s88, 9
    v_sub_u32 v102, s4, v112
    v_cmp_le_i32 vcc, 0, v102
    v_max_i32 v102, 0, v102
    v_cvt_f32_i32 v102, v102
    v_mul_f32 v102, 0x43000000, v102
    v_mul_f32 v103, v102, v100
    v_mul_f32 v109, v102, v101
    v_exp_f32 v103, v103
    v_fract_f32 v109, v109
    v_cos_f32 v108, v109
    v_sin_f32 v109, v109
    s_nop 0
    v_mul_f32 v108, v108, v103
    v_mul_f32 v109, v109, v103
    v_cndmask_b32 v108, 0, v108, vcc
    v_cndmask_b32 v109, 0, v109, vcc
    s_sub_u32 s4, s88, 13
    v_sub_u32 v102, s4, v112
    v_cmp_le_i32 vcc, 0, v102
    v_max_i32 v102, 0, v102
    v_cvt_f32_i32 v102, v102
    v_mul_f32 v102, 0x43000000, v102
    v_mul_f32 v103, v102, v100
    v_mul_f32 v111, v102, v101
    v_exp_f32 v103, v103
    v_fract_f32 v111, v111
    v_cos_f32 v110, v111
    v_sin_f32 v111, v111
    s_nop 0
    v_mul_f32 v110, v110, v103
    v_mul_f32 v111, v111, v103
    v_cndmask_b32 v110, 0, v110, vcc
    v_cndmask_b32 v111, 0, v111, vcc
    s_add_u32 s101, s26, 2
    s_waitcnt vmcnt(0)
    v_subrev_u32 v27, s101, v27
    v_cmp_ge_u32 vcc, 5, v27
    s_nop 3
    s_cmp_eq_u64 vcc, exec
    s_cbranch_scc1 L_polld9
    s_mov_b32 s97, 400000
L_poll8:
    s_sleep 1
    buffer_load_dword v27, v25, s[60:63], 0 offen sc0 sc1
    s_waitcnt vmcnt(0)
    v_subrev_u32 v27, s101, v27
    v_cmp_ge_u32 vcc, 5, v27
    s_nop 4
    s_cmp_eq_u64 vcc, exec
    s_cbranch_scc1 L_polld9
    s_sub_u32 s97, s97, 1
    s_cmp_lg_u32 s97, 0
    s_cbranch_scc1 L_poll8
L_polld9:
    s_nop 4
    s_barrier
    v_add_u32 v4, 0x20000, v2
    v_add_u32 v5, 0x20000, v3
    ds_read_b64_tr_b16 v[40:41], v4 offset:0
    ds_read_b64_tr_b16 v[42:43], v4 offset:512
    ds_read_b64_tr_b16 v[44:45], v5 offset:0
    ds_read_b64_tr_b16 v[46:47], v5 offset:512
    v_mfma_f32_32x32x16_bf16 v[48:63], v[128:131], v[216:219], v[48:63]
    v_mfma_f32_32x32x16_bf16 v[64:79], v[132:135], v[216:219], v[64:79]
    ds_read_b64_tr_b16 v[128:129], v4 offset:4096
    ds_read_b64_tr_b16 v[130:131], v4 offset:4608
    ds_read_b64_tr_b16 v[132:133], v5 offset:4096
    ds_read_b64_tr_b16 v[134:135], v5 offset:4608
    v_mfma_f32_32x32x16_bf16 v[48:63], v[32:35], v[220:223], v[48:63]
    v_mfma_f32_32x32x16_bf16 v[64:79], v[36:39], v[220:223], v[64:79]
    s_mov_b32 s96, 0
    s_mov_b32 s95, 4096
    buffer_load_dwordx4 v[144:147], v28, s[60:63], s96 offen offset:0 sc0 sc1
    buffer_load_dwordx4 v[148:151], v28, s[60:63], s96 offen offset:2048 sc0 sc1
    buffer_load_dwordx4 v[152:155], v28, s[60:63], s95 offen offset:0 sc0 sc1
    buffer_load_dwordx4 v[156:159], v28, s[60:63], s95 offen offset:2048 sc0 sc1
    ds_read_b64_tr_b16 v[32:33], v4 offset:8192
    ds_read_b64_tr_b16 v[34:35], v4 offset:8704
    ds_read_b64_tr_b16 v[36:37], v5 offset:8192
    ds_read_b64_tr_b16 v[38:39], v5 offset:8704
    s_waitcnt lgkmcnt(10)
    v_mfma_f32_32x32x16_bf16 v[48:63], v[40:43], v[224:227], v[48:63]
    s_waitcnt lgkmcnt(8)
    v_mfma_f32_32x32x16_bf16 v[64:79], v[44:47], v[224:227], v[64:79]
    ds_read_b64_tr_b16 v[40:41], v4 offset:12288
    ds_read_b64_tr_b16 v[42:43], v4 offset:12800
    ds_read_b64_tr_b16 v[44:45], v5 offset:12288
    ds_read_b64_tr_b16 v[46:47], v5 offset:12800
    s_waitcnt lgkmcnt(10)
    v_mfma_f32_32x32x16_bf16 v[48:63], v[128:131], v[228:231], v[48:63]
    s_waitcnt lgkmcnt(8)
    v_mfma_f32_32x32x16_bf16 v[64:79], v[132:135], v[228:231], v[64:79]
    v_add_u32 v4, 0x0, v2
    v_add_u32 v5, 0x0, v3
    ds_read_b64_tr_b16 v[128:129], v4 offset:0
    ds_read_b64_tr_b16 v[130:131], v4 offset:512
    ds_read_b64_tr_b16 v[132:133], v5 offset:0
    ds_read_b64_tr_b16 v[134:135], v5 offset:512
    s_waitcnt lgkmcnt(10)
    v_mfma_f32_32x32x16_bf16 v[48:63], v[32:35], v[232:235], v[48:63]
    s_waitcnt lgkmcnt(8)
    v_mfma_f32_32x32x16_bf16 v[64:79], v[36:39], v[232:235], v[64:79]
    ds_read_b64_tr_b16 v[32:33], v4 offset:4096
    ds_read_b64_tr_b16 v[34:35], v4 offset:4608
    ds_read_b64_tr_b16 v[36:37], v5 offset:4096
    ds_read_b64_tr_b16 v[38:39], v5 offset:4608
    s_waitcnt lgkmcnt(10)
    v_mfma_f32_32x32x16_bf16 v[48:63], v[40:43], v[236:239], v[48:63]
    s_waitcnt lgkmcnt(8)
    v_mfma_f32_32x32x16_bf16 v[64:79], v[44:47], v[236:239], v[64:79]
    ds_read_b64_tr_b16 v[40:41], v4 offset:8192
    ds_read_b64_tr_b16 v[42:43], v4 offset:8704
    ds_read_b64_tr_b16 v[44:45], v5 offset:8192
    ds_read_b64_tr_b16 v[46:47], v5 offset:8704
    s_waitcnt lgkmcnt(10)
    v_mfma_f32_32x32x16_bf16 v[48:63], v[128:131], v[240:243], v[48:63]
    s_waitcnt lgkmcnt(8)
    v_mfma_f32_32x32x16_bf16 v[64:79], v[132:135], v[240:243], v[64:79]
    ds_read_b64_tr_b16 v[128:129], v4 offset:12288
    ds_read_b64_tr_b16 v[130:131], v4 offset:12800
    ds_read_b64_tr_b16 v[132:133], v5 offset:12288
    ds_read_b64_tr_b16 v[134:135], v5 offset:12800
    s_waitcnt lgkmcnt(10)
    v_mfma_f32_32x32x16_bf16 v[48:63], v[32:35], v[244:247], v[48:63]
    s_waitcnt lgkmcnt(8)
    v_mfma_f32_32x32x16_bf16 v[64:79], v[36:39], v[244:247], v[64:79]
    s_waitcnt lgkmcnt(6)
    v_mfma_f32_32x32x16_bf16 v[48:63], v[40:43], v[248:251], v[48:63]
    s_waitcnt lgkmcnt(4)
    v_mfma_f32_32x32x16_bf16 v[64:79], v[44:47], v[248:251], v[64:79]
    s_waitcnt lgkmcnt(2)
    v_mfma_f32_32x32x16_bf16 v[48:63], v[128:131], v[252:255], v[48:63]
    s_waitcnt lgkmcnt(0)
    v_mfma_f32_32x32x16_bf16 v[64:79], v[132:135], v[252:255], v[64:79]
    s_lshl_b32 s6, s93, 9
    s_add_u32 s6, s6, 0x24400
    v_and_b32 v18, 31, v0
    v_lshlrev_b32 v18, 3, v18
    v_add_u32 v18, s6, v18
    ds_read_b64 v[136:137], v18
    v_mov_b32 v138, 0
    v_mov_b32 v139, 0
    s_lshl_b32 s6, s93, 9
    s_add_u32 s6, s6, 0x24500
    v_and_b32 v18, 31, v0
    v_lshlrev_b32 v18, 3, v18
    v_add_u32 v18, s6, v18
    ds_read_b64 v[140:141], v18
    v_mov_b32 v142, 0
    v_mov_b32 v143, 0
    s_waitcnt lgkmcnt(1)
    v_mfma_f32_32x32x16_bf16 v[48:63], v[136:139], v[20:23], v[48:63]
    s_waitcnt lgkmcnt(0)
    v_mfma_f32_32x32x16_bf16 v[64:79], v[140:143], v[20:23], v[64:79]
    s_mov_b32 s96, 0
    s_mov_b32 s95, 4096
    v_mov_b32 v161, 0
    s_waitcnt vmcnt(0)
    v_mov_b32 v160, v156
    v_xor_b32 v160, s26, v145
    v_xor_b32 v163, s26, v147
    v_or_b32 v160, v160, v163
    v_lshrrev_b32 v163, 4, v0
    v_add_u32 v163, 0, v163
    v_cmp_le_u32 vcc, s88, v163
    s_nop 1
    v_cndmask_b32 v160, v160, v161, vcc
    v_mov_b32 v162, v160
    v_xor_b32 v160, s26, v149
    v_xor_b32 v163, s26, v151
    v_or_b32 v160, v160, v163
    v_lshrrev_b32 v163, 4, v0
    v_add_u32 v163, 4, v163
    v_cmp_le_u32 vcc, s88, v163
    s_nop 1
    v_cndmask_b32 v160, v160, v161, vcc
    v_or_b32 v162, v162, v160
    v_xor_b32 v160, s26, v153
    v_xor_b32 v163, s26, v155
    v_or_b32 v160, v160, v163
    v_lshrrev_b32 v163, 4, v0
    v_add_u32 v163, 8, v163
    v_cmp_le_u32 vcc, s88, v163
    s_nop 1
    v_cndmask_b32 v160, v160, v161, vcc
    v_or_b32 v162, v162, v160
    v_xor_b32 v160, s26, v157
    v_xor_b32 v163, s26, v159
    v_or_b32 v160, v160, v163
    v_lshrrev_b32 v163, 4, v0
    v_add_u32 v163, 12, v163
    v_cmp_le_u32 vcc, s88, v163
    s_nop 1
    v_cndmask_b32 v160, v160, v161, vcc
    v_or_b32 v162, v162, v160
    v_cmp_eq_u32 vcc, 0, v162
    s_nop 4
    s_cmp_eq_u64 vcc, exec
    s_cbranch_scc1 L_aggd11
    s_mov_b32 s97, 400000
L_agg10:
    s_sleep 1
    buffer_load_dwordx4 v[144:147], v28, s[60:63], s96 offen offset:0 sc0 sc1
    buffer_load_dwordx4 v[148:151], v28, s[60:63], s96 offen offset:2048 sc0 sc1
    buffer_load_dwordx4 v[152:155], v28, s[60:63], s95 offen offset:0 sc0 sc1
    buffer_load_dwordx4 v[156:159], v28, s[60:63], s95 offen offset:2048 sc0 sc1
    s_waitcnt vmcnt(0)
    v_xor_b32 v160, s26, v145
    v_xor_b32 v163, s26, v147
    v_or_b32 v160, v160, v163
    v_lshrrev_b32 v163, 4, v0
    v_add_u32 v163, 0, v163
    v_cmp_le_u32 vcc, s88, v163
    s_nop 1
    v_cndmask_b32 v160, v160, v161, vcc
    v_mov_b32 v162, v160
    v_xor_b32 v160, s26, v149
    v_xor_b32 v163, s26, v151
    v_or_b32 v160, v160, v163
    v_lshrrev_b32 v163, 4, v0
    v_add_u32 v163, 4, v163
    v_cmp_le_u32 vcc, s88, v163
    s_nop 1
    v_cndmask_b32 v160, v160, v161, vcc
    v_or_b32 v162, v162, v160
    v_xor_b32 v160, s26, v153
    v_xor_b32 v163, s26, v155
    v_or_b32 v160, v160, v163
    v_lshrrev_b32 v163, 4, v0
    v_add_u32 v163, 8, v163
    v_cmp_le_u32 vcc, s88, v163
    s_nop 1
    v_cndmask_b32 v160, v160, v161, vcc
    v_or_b32 v162, v162, v160
    v_xor_b32 v160, s26, v157
    v_xor_b32 v163, s26, v159
    v_or_b32 v160, v160, v163
    v_lshrrev_b32 v163, 4, v0
    v_add_u32 v163, 12, v163
    v_cmp_le_u32 vcc, s88, v163
    s_nop 1
    v_cndmask_b32 v160, v160, v161, vcc
    v_or_b32 v162, v162, v160
    v_cmp_eq_u32 vcc, 0, v162
    s_nop 4
    s_cmp_eq_u64 vcc, exec
    s_cbranch_scc1 L_aggd11
    s_sub_u32 s97, s97, 1
    s_cmp_lg_u32 s97, 0
    s_cbranch_scc1 L_agg10
L_aggd11:
    s_nop 4
    v_add_u32 v162, 0, v112
    v_cmp_gt_u32 vcc, s88, v162
    s_nop 1
    v_cndmask_b32 v144, 0, v144, vcc
    v_cndmask_b32 v146, 0, v146, vcc
    v_add_u32 v162, 4, v112
    v_cmp_gt_u32 vcc, s88, v162
    s_nop 1
    v_cndmask_b32 v148, 0, v148, vcc
    v_cndmask_b32 v150, 0, v150, vcc
    v_add_u32 v162, 8, v112
    v_cmp_gt_u32 vcc, s88, v162
    s_nop 1
    v_cndmask_b32 v152, 0, v152, vcc
    v_cndmask_b32 v154, 0, v154, vcc
    v_add_u32 v162, 12, v112
    v_cmp_gt_u32 vcc, s88, v162
    s_nop 1
    v_cndmask_b32 v156, 0, v156, vcc
    v_cndmask_b32 v158, 0, v158, vcc
    v_mov_b32 v160, 0
    v_mov_b32 v161, 0
    v_fma_f32 v160, v104, v144, v160
    v_fma_f32 v161, v104, v146, v161
    v_fma_f32 v160, -v105, v146, v160
    v_fma_f32 v161, v105, v144, v161
    v_fma_f32 v160, v106, v148, v160
    v_fma_f32 v161, v106, v150, v161
    v_fma_f32 v160, -v107, v150, v160
    v_fma_f32 v161, v107, v148, v161
    v_fma_f32 v160, v108, v152, v160
    v_fma_f32 v161, v108, v154, v161
    v_fma_f32 v160, -v109, v154, v160
    v_fma_f32 v161, v109, v152, v161
    v_fma_f32 v160, v110, v156, v160
    v_fma_f32 v161, v110, v158, v161
    v_fma_f32 v160, -v111, v158, v160
    v_fma_f32 v161, v111, v156, v161
    v_mov_b32 v162, v160
    v_mov_b32 v163, v161
    s_nop 0
    v_permlane16_swap_b32 v160, v162
    v_permlane16_swap_b32 v161, v163
    v_add_f32 v160, v160, v162
    v_add_f32 v161, v161, v163
    v_mov_b32 v162, v160
    v_mov_b32 v163, v161
    s_nop 0
    v_permlane32_swap_b32 v160, v162
    v_permlane32_swap_b32 v161, v163
    v_add_f32 v160, v160, v162
    v_add_f32 v161, v161, v163
    ds_write_b64 v113, v[160:161]
    s_waitcnt lgkmcnt(0)
    s_barrier
    ds_read_b64 v[108:109], v126
    s_waitcnt lgkmcnt(0)
    v_fma_f32 v116, v122, v108, v116
    v_fma_f32 v117, v122, v109, v117
    v_fma_f32 v116, -v123, v109, v116
    v_fma_f32 v117, v123, v108, v117
    v_fma_f32 v80, v98, v116, v80
    v_fma_f32 v88, v98, v117, v88
    v_fma_f32 v80, -v99, v117, v80
    v_fma_f32 v88, v99, v116, v88
    v_fma_f32 v81, v98, v80, v81
    v_fma_f32 v89, v98, v88, v89
    v_fma_f32 v81, -v99, v88, v81
    v_fma_f32 v89, v99, v80, v89
    v_fma_f32 v82, v98, v81, v82
    v_fma_f32 v90, v98, v89, v90
    v_fma_f32 v82, -v99, v89, v82
    v_fma_f32 v90, v99, v81, v90
    v_fma_f32 v83, v98, v82, v83
    v_fma_f32 v91, v98, v90, v91
    v_fma_f32 v83, -v99, v90, v83
    v_fma_f32 v91, v99, v82, v91
    v_fma_f32 v84, v98, v83, v84
    v_fma_f32 v92, v98, v91, v92
    v_fma_f32 v84, -v99, v91, v84
    v_fma_f32 v92, v99, v83, v92
    v_fma_f32 v85, v98, v84, v85
    v_fma_f32 v93, v98, v92, v93
    v_fma_f32 v85, -v99, v92, v85
    v_fma_f32 v93, v99, v84, v93
    v_fma_f32 v86, v98, v85, v86
    v_fma_f32 v94, v98, v93, v94
    v_fma_f32 v86, -v99, v93, v86
    v_fma_f32 v94, v99, v85, v94
    v_fma_f32 v87, v98, v86, v87
    v_fma_f32 v95, v98, v94, v95
    v_fma_f32 v87, -v99, v94, v87
    v_fma_f32 v95, v99, v86, v95
    v_cvt_pk_bf16_f32 v108, v80, v81
    v_cvt_pk_bf16_f32 v109, v82, v83
    v_cvt_pk_bf16_f32 v110, v84, v85
    v_cvt_pk_bf16_f32 v111, v86, v87
    ds_write_b128 v124, v[108:111]
    ds_read_b64_tr_b16 v[96:97], v125 offset:0
    ds_read_b64_tr_b16 v[98:99], v125 offset:256
    v_cvt_pk_bf16_f32 v112, -v88, -v89
    v_cvt_pk_bf16_f32 v113, -v90, -v91
    v_cvt_pk_bf16_f32 v114, -v92, -v93
    v_cvt_pk_bf16_f32 v115, -v94, -v95
    ds_write_b128 v124, v[112:115]
    ds_read_b64_tr_b16 v[100:101], v125 offset:0
    ds_read_b64_tr_b16 v[102:103], v125 offset:256
    s_waitcnt lgkmcnt(3)
    buffer_store_dwordx4 v[96:99], v1, s[60:63], s27 offen sc1
    s_waitcnt lgkmcnt(0)
    buffer_store_dwordx4 v[100:103], v1, s[60:63], s8 offen sc1
    s_barrier
    v_add_u32 v5, 0x10000, v26
    v_add_u32 v8, 0x4000, v29
    ds_read_b128 v[128:131], v5 offset:0
    ds_read_b64_tr_b16 v[192:193], v8 offset:0
    ds_read_b64_tr_b16 v[194:195], v8 offset:512
    ds_read_b128 v[132:135], v5 offset:1024
    ds_read_b64_tr_b16 v[196:197], v8 offset:2048
    ds_read_b64_tr_b16 v[198:199], v8 offset:2560
    ds_read_b128 v[136:139], v5 offset:2048
    ds_read_b64_tr_b16 v[200:201], v8 offset:4096
    ds_read_b64_tr_b16 v[202:203], v8 offset:4608
    ds_read_b128 v[140:143], v5 offset:3072
    ds_read_b64_tr_b16 v[204:205], v8 offset:6144
    ds_read_b64_tr_b16 v[206:207], v8 offset:6656
    s_waitcnt lgkmcnt(9)
    v_mfma_f32_32x32x16_bf16 v[160:175], v[128:131], v[192:195], 0
    ds_read_b128 v[128:131], v5 offset:4096
    ds_read_b64_tr_b16 v[192:193], v8 offset:8192
    ds_read_b64_tr_b16 v[194:195], v8 offset:8704
    s_waitcnt lgkmcnt(9)
    v_mfma_f32_32x32x16_bf16 v[160:175], v[132:135], v[196:199], v[160:175]
    ds_read_b128 v[132:135], v5 offset:5120
    ds_read_b64_tr_b16 v[196:197], v8 offset:10240
    ds_read_b64_tr_b16 v[198:199], v8 offset:10752
    s_waitcnt lgkmcnt(9)
    v_mfma_f32_32x32x16_bf16 v[160:175], v[136:139], v[200:203], v[160:175]
    ds_read_b128 v[136:139], v5 offset:6144
    ds_read_b64_tr_b16 v[200:201], v8 offset:12288
    ds_read_b64_tr_b16 v[202:203], v8 offset:12800
    s_waitcnt lgkmcnt(9)
    v_mfma_f32_32x32x16_bf16 v[160:175], v[140:143], v[204:207], v[160:175]
    s_and_b32 s7, s92, 1
    s_mov_b32 s76, s34
    s_mov_b32 s77, s35
    s_mov_b32 s78, 0x400000
    s_mov_b32 s79, 0x20000
    s_lshl_b32 s4, s91, 6
    s_lshl_b32 s5, s7, 5
    s_add_u32 s4, s4, s5
    v_and_b32 v217, 31, v0
    v_add_u32 v217, s4, v217
    ds_read_b128 v[140:143], v5 offset:7168
    ds_read_b64_tr_b16 v[204:205], v8 offset:14336
    ds_read_b64_tr_b16 v[206:207], v8 offset:14848
    s_waitcnt lgkmcnt(9)
    v_mfma_f32_32x32x16_bf16 v[160:175], v[128:131], v[192:195], v[160:175]
    v_lshlrev_b32 v217, 1, v217
    global_load_ushort v23, v217, s[24:25]
    s_and_b32 s4, s90, 1
    s_lshl_b32 s4, s4, 6
    v_add_u32 v10, s4, v0
    v_lshlrev_b32 v10, 4, v10
    s_waitcnt vmcnt(1)
    s_waitcnt lgkmcnt(0)
    s_barrier
    s_add_u32 s101, s26, 1
    v_mov_b32 v19, s101
    buffer_store_dword v19, v24, s[60:63], 0 offen offset:4 sc0 sc1
    v_add_u32 v5, 0x14000, v26
    v_add_u32 v8, 0x8000, v29
    ds_read_b128 v[128:131], v5 offset:0
    ds_read_b64_tr_b16 v[192:193], v8 offset:0
    ds_read_b64_tr_b16 v[194:195], v8 offset:512
    v_mfma_f32_32x32x16_bf16 v[160:175], v[132:135], v[196:199], v[160:175]
    ds_read_b128 v[132:135], v5 offset:1024
    ds_read_b64_tr_b16 v[196:197], v8 offset:2048
    ds_read_b64_tr_b16 v[198:199], v8 offset:2560
    v_mfma_f32_32x32x16_bf16 v[160:175], v[136:139], v[200:203], v[160:175]
    ds_read_b128 v[136:139], v5 offset:2048
    ds_read_b64_tr_b16 v[200:201], v8 offset:4096
    ds_read_b64_tr_b16 v[202:203], v8 offset:4608
    v_mfma_f32_32x32x16_bf16 v[160:175], v[140:143], v[204:207], v[160:175]
    ds_read_b128 v[140:143], v5 offset:3072
    ds_read_b64_tr_b16 v[204:205], v8 offset:6144
    ds_read_b64_tr_b16 v[206:207], v8 offset:6656
    s_waitcnt lgkmcnt(9)
    v_mfma_f32_32x32x16_bf16 v[160:175], v[128:131], v[192:195], v[160:175]
    s_lshl_b32 s4, s94, 11
    s_add_u32 s95, s4, 0x8000
    buffer_load_dwordx4 v[240:243], v10, s[60:63], s95 offen sc0 sc1
    s_lshl_b32 s4, s89, 2
    s_lshl_b32 s5, s93, 1
    s_add_u32 s4, s4, s5
    s_add_u32 s4, s4, 128
    s_lshl_b32 s4, s4, 10
    s_mul_i32 s5, s88, 0xb0000
    s_add_u32 s4, s4, s5
    s_add_u32 s9, s4, 0x200000
    ds_read_b128 v[128:131], v5 offset:4096
    ds_read_b64_tr_b16 v[192:193], v8 offset:8192
    ds_read_b64_tr_b16 v[194:195], v8 offset:8704
    s_waitcnt lgkmcnt(9)
    v_mfma_f32_32x32x16_bf16 v[160:175], v[132:135], v[196:199], v[160:175]
    v_mul_f32 v10, v6, v48
    v_mul_f32 v11, v6, v49
    v_mul_f32 v12, v6, v50
    v_mul_f32 v13, v6, v51
    v_exp_f32 v10, v10
    ds_read_b128 v[132:135], v5 offset:5120
    ds_read_b64_tr_b16 v[196:197], v8 offset:10240
    ds_read_b64_tr_b16 v[198:199], v8 offset:10752
    s_waitcnt lgkmcnt(9)
    v_mfma_f32_32x32x16_bf16 v[160:175], v[136:139], v[200:203], v[160:175]
    v_exp_f32 v11, v11
    v_exp_f32 v12, v12
    ds_read_b128 v[136:139], v5 offset:6144
    ds_read_b64_tr_b16 v[200:201], v8 offset:12288
    ds_read_b64_tr_b16 v[202:203], v8 offset:12800
    s_waitcnt lgkmcnt(9)
    v_mfma_f32_32x32x16_bf16 v[160:175], v[140:143], v[204:207], v[160:175]
    v_exp_f32 v13, v13
    v_mul_f32 v14, v48, v56
    v_mul_f32 v15, v49, v57
    v_mul_f32 v16, v50, v58
    ds_read_b128 v[140:143], v5 offset:7168
    ds_read_b64_tr_b16 v[204:205], v8 offset:14336
    ds_read_b64_tr_b16 v[206:207], v8 offset:14848
    s_waitcnt lgkmcnt(9)
    v_mfma_f32_32x32x16_bf16 v[160:175], v[128:131], v[192:195], v[160:175]
    v_mul_f32 v17, v51, v59
    v_fma_f32 v10, v10, v7, v7
    v_fma_f32 v11, v11, v7, v7
    v_fma_f32 v12, v12, v7, v7
    v_fma_f32 v13, v13, v7, v7
    s_waitcnt lgkmcnt(0)
    s_barrier
    v_add_u32 v5, 0x18000, v26
    v_add_u32 v8, 0xc000, v29
    ds_read_b128 v[128:131], v5 offset:0
    ds_read_b64_tr_b16 v[192:193], v8 offset:0
    ds_read_b64_tr_b16 v[194:195], v8 offset:512
    v_mfma_f32_32x32x16_bf16 v[160:175], v[132:135], v[196:199], v[160:175]
    ds_read_b128 v[132:135], v5 offset:1024
    ds_read_b64_tr_b16 v[196:197], v8 offset:2048
    ds_read_b64_tr_b16 v[198:199], v8 offset:2560
    v_mfma_f32_32x32x16_bf16 v[160:175], v[136:139], v[200:203], v[160:175]
    ds_read_b128 v[136:139], v5 offset:2048
    ds_read_b64_tr_b16 v[200:201], v8 offset:4096
    ds_read_b64_tr_b16 v[202:203], v8 offset:4608
    v_mfma_f32_32x32x16_bf16 v[160:175], v[140:143], v[204:207], v[160:175]
    ds_read_b128 v[140:143], v5 offset:3072
    ds_read_b64_tr_b16 v[204:205], v8 offset:6144
    ds_read_b64_tr_b16 v[206:207], v8 offset:6656
    s_waitcnt lgkmcnt(9)
    v_mfma_f32_32x32x16_bf16 v[160:175], v[128:131], v[192:195], v[160:175]
    v_rcp_f32 v10, v10
    v_rcp_f32 v11, v11
    v_rcp_f32 v12, v12
    ds_read_b128 v[128:131], v5 offset:4096
    ds_read_b64_tr_b16 v[192:193], v8 offset:8192
    ds_read_b64_tr_b16 v[194:195], v8 offset:8704
    s_waitcnt lgkmcnt(9)
    v_mfma_f32_32x32x16_bf16 v[160:175], v[132:135], v[196:199], v[160:175]
    v_rcp_f32 v13, v13
    v_mul_f32 v14, v14, v10
    v_mul_f32 v15, v15, v11
    ds_read_b128 v[132:135], v5 offset:5120
    ds_read_b64_tr_b16 v[196:197], v8 offset:10240
    ds_read_b64_tr_b16 v[198:199], v8 offset:10752
    s_waitcnt lgkmcnt(9)
    v_mfma_f32_32x32x16_bf16 v[160:175], v[136:139], v[200:203], v[160:175]
    v_mul_f32 v16, v16, v12
    v_mul_f32 v17, v17, v13
    v_cvt_pk_bf16_f32 v48, v14, v15
    v_cvt_pk_bf16_f32 v49, v16, v17
    v_mul_f32 v10, v6, v52
    ds_read_b128 v[136:139], v5 offset:6144
    ds_read_b64_tr_b16 v[200:201], v8 offset:12288
    ds_read_b64_tr_b16 v[202:203], v8 offset:12800
    s_waitcnt lgkmcnt(9)
    v_mfma_f32_32x32x16_bf16 v[160:175], v[140:143], v[204:207], v[160:175]
    v_mul_f32 v11, v6, v53
    v_mul_f32 v12, v6, v54
    v_mul_f32 v13, v6, v55
    v_exp_f32 v10, v10
    ds_read_b128 v[140:143], v5 offset:7168
    ds_read_b64_tr_b16 v[204:205], v8 offset:14336
    ds_read_b64_tr_b16 v[206:207], v8 offset:14848
    s_waitcnt lgkmcnt(9)
    v_mfma_f32_32x32x16_bf16 v[160:175], v[128:131], v[192:195], v[160:175]
    v_exp_f32 v11, v11
    v_exp_f32 v12, v12
    v_exp_f32 v13, v13
    s_waitcnt lgkmcnt(0)
    s_barrier
    v_add_u32 v5, 0x20000, v26
    v_add_u32 v8, 0x1c000, v29
    ds_read_b128 v[128:131], v5 offset:0
    ds_read_b64_tr_b16 v[192:193], v8 offset:0
    ds_read_b64_tr_b16 v[194:195], v8 offset:512
    v_mfma_f32_32x32x16_bf16 v[160:175], v[132:135], v[196:199], v[160:175]
    ds_read_b128 v[132:135], v5 offset:1024
    ds_read_b64_tr_b16 v[196:197], v8 offset:2048
    ds_read_b64_tr_b16 v[198:199], v8 offset:2560
    v_mfma_f32_32x32x16_bf16 v[160:175], v[136:139], v[200:203], v[160:175]
    ds_read_b128 v[136:139], v5 offset:2048
    ds_read_b64_tr_b16 v[200:201], v8 offset:4096
    ds_read_b64_tr_b16 v[202:203], v8 offset:4608
    v_mfma_f32_32x32x16_bf16 v[160:175], v[140:143], v[204:207], v[160:175]
    ds_read_b128 v[140:143], v5 offset:3072
    ds_read_b64_tr_b16 v[204:205], v8 offset:6144
    ds_read_b64_tr_b16 v[206:207], v8 offset:6656
    s_waitcnt lgkmcnt(9)
    v_mfma_f32_32x32x16_bf16 v[160:175], v[128:131], v[192:195], v[160:175]
    v_mul_f32 v14, v52, v60
    v_mul_f32 v15, v53, v61
    v_mul_f32 v16, v54, v62
    v_mul_f32 v17, v55, v63
    v_fma_f32 v10, v10, v7, v7
    ds_read_b128 v[128:131], v5 offset:4096
    ds_read_b64_tr_b16 v[192:193], v8 offset:8192
    ds_read_b64_tr_b16 v[194:195], v8 offset:8704
    s_waitcnt lgkmcnt(9)
    v_mfma_f32_32x32x16_bf16 v[160:175], v[132:135], v[196:199], v[160:175]
    v_fma_f32 v11, v11, v7, v7
    v_fma_f32 v12, v12, v7, v7
    v_fma_f32 v13, v13, v7, v7
    v_rcp_f32 v10, v10
    ds_read_b128 v[132:135], v5 offset:5120
    ds_read_b64_tr_b16 v[196:197], v8 offset:10240
    ds_read_b64_tr_b16 v[198:199], v8 offset:10752
    s_waitcnt lgkmcnt(9)
    v_mfma_f32_32x32x16_bf16 v[160:175], v[136:139], v[200:203], v[160:175]
    v_rcp_f32 v11, v11
    v_rcp_f32 v12, v12
    v_rcp_f32 v13, v13
    ds_read_b128 v[136:139], v5 offset:6144
    ds_read_b64_tr_b16 v[200:201], v8 offset:12288
    ds_read_b64_tr_b16 v[202:203], v8 offset:12800
    s_waitcnt lgkmcnt(9)
    v_mfma_f32_32x32x16_bf16 v[160:175], v[140:143], v[204:207], v[160:175]
    v_mul_f32 v14, v14, v10
    v_mul_f32 v15, v15, v11
    v_mul_f32 v16, v16, v12
    v_mul_f32 v17, v17, v13
    ds_read_b128 v[140:143], v5 offset:7168
    ds_read_b64_tr_b16 v[204:205], v8 offset:14336
    ds_read_b64_tr_b16 v[206:207], v8 offset:14848
    s_waitcnt lgkmcnt(9)
    v_mfma_f32_32x32x16_bf16 v[160:175], v[128:131], v[192:195], v[160:175]
    v_cvt_pk_bf16_f32 v50, v14, v15
    v_cvt_pk_bf16_f32 v51, v16, v17
    buffer_store_dwordx4 v[48:51], v1, s[60:63], s9 offen offset:0 sc1
    v_mul_f32 v10, v6, v64
    v_mul_f32 v11, v6, v65
    s_waitcnt lgkmcnt(0)
    s_barrier
    buffer_load_dword v27, v25, s[60:63], 0 offen offset:4 sc0 sc1
    v_add_u32 v5, 0x4000, v26
    v_add_u32 v8, 0x0, v29
    ds_read_b128 v[128:131], v5 offset:0
    ds_read_b64_tr_b16 v[192:193], v8 offset:0
    ds_read_b64_tr_b16 v[194:195], v8 offset:512
    v_mfma_f32_32x32x16_bf16 v[160:175], v[132:135], v[196:199], v[160:175]
    ds_read_b128 v[132:135], v5 offset:1024
    ds_read_b64_tr_b16 v[196:197], v8 offset:2048
    ds_read_b64_tr_b16 v[198:199], v8 offset:2560
    v_mfma_f32_32x32x16_bf16 v[160:175], v[136:139], v[200:203], v[160:175]
    ds_read_b128 v[136:139], v5 offset:2048
    ds_read_b64_tr_b16 v[200:201], v8 offset:4096
    ds_read_b64_tr_b16 v[202:203], v8 offset:4608
    v_mfma_f32_32x32x16_bf16 v[160:175], v[140:143], v[204:207], v[160:175]
    ds_read_b128 v[140:143], v5 offset:3072
    ds_read_b64_tr_b16 v[204:205], v8 offset:6144
    ds_read_b64_tr_b16 v[206:207], v8 offset:6656
    s_waitcnt lgkmcnt(9)
    v_mfma_f32_32x32x16_bf16 v[160:175], v[128:131], v[192:195], v[160:175]
    v_mul_f32 v12, v6, v66
    v_mul_f32 v13, v6, v67
    v_exp_f32 v10, v10
    v_exp_f32 v11, v11
    ds_read_b128 v[128:131], v5 offset:4096
    ds_read_b64_tr_b16 v[192:193], v8 offset:8192
    ds_read_b64_tr_b16 v[194:195], v8 offset:8704
    s_waitcnt lgkmcnt(9)
    v_mfma_f32_32x32x16_bf16 v[160:175], v[132:135], v[196:199], v[160:175]
    v_exp_f32 v12, v12
    v_exp_f32 v13, v13
    ds_read_b128 v[132:135], v5 offset:5120
    ds_read_b64_tr_b16 v[196:197], v8 offset:10240
    ds_read_b64_tr_b16 v[198:199], v8 offset:10752
    s_waitcnt lgkmcnt(9)
    v_mfma_f32_32x32x16_bf16 v[160:175], v[136:139], v[200:203], v[160:175]
    v_mul_f32 v14, v64, v72
    v_mul_f32 v15, v65, v73
    v_mul_f32 v16, v66, v74
    v_mul_f32 v17, v67, v75
    v_fma_f32 v10, v10, v7, v7
    ds_read_b128 v[136:139], v5 offset:6144
    ds_read_b64_tr_b16 v[200:201], v8 offset:12288
    ds_read_b64_tr_b16 v[202:203], v8 offset:12800
    s_waitcnt lgkmcnt(9)
    v_mfma_f32_32x32x16_bf16 v[160:175], v[140:143], v[204:207], v[160:175]
    v_fma_f32 v11, v11, v7, v7
    v_fma_f32 v12, v12, v7, v7
    v_fma_f32 v13, v13, v7, v7
    v_rcp_f32 v10, v10
    ds_read_b128 v[140:143], v5 offset:7168
    ds_read_b64_tr_b16 v[204:205], v8 offset:14336
    ds_read_b64_tr_b16 v[206:207], v8 offset:14848
    s_waitcnt lgkmcnt(9)
    v_mfma_f32_32x32x16_bf16 v[160:175], v[128:131], v[192:195], v[160:175]
    v_rcp_f32 v11, v11
    v_rcp_f32 v12, v12
    v_rcp_f32 v13, v13
    s_add_u32 s101, s26, 1
    s_waitcnt vmcnt(0)
    v_subrev_u32 v27, s101, v27
    v_cmp_ge_u32 vcc, 6, v27
    s_nop 3
    s_cmp_eq_u64 vcc, exec
    s_cbranch_scc1 L_polld13
    s_mov_b32 s97, 400000
L_poll12:
    s_sleep 1
    buffer_load_dword v27, v25, s[60:63], 0 offen offset:4 sc0 sc1
    s_waitcnt vmcnt(0)
    v_subrev_u32 v27, s101, v27
    v_cmp_ge_u32 vcc, 6, v27
    s_nop 4
    s_cmp_eq_u64 vcc, exec
    s_cbranch_scc1 L_polld13
    s_sub_u32 s97, s97, 1
    s_cmp_lg_u32 s97, 0
    s_cbranch_scc1 L_poll12
L_polld13:
    s_nop 4
    s_waitcnt lgkmcnt(0)
    s_barrier
    v_add_u32 v5, 0x8000, v26
    v_add_u32 v8, 0x10000, v29
    ds_read_b128 v[128:131], v5 offset:0
    ds_read_b64_tr_b16 v[192:193], v8 offset:0
    ds_read_b64_tr_b16 v[194:195], v8 offset:512
    v_mfma_f32_32x32x16_bf16 v[160:175], v[132:135], v[196:199], v[160:175]
    ds_read_b128 v[132:135], v5 offset:1024
    ds_read_b64_tr_b16 v[196:197], v8 offset:2048
    ds_read_b64_tr_b16 v[198:199], v8 offset:2560
    v_mfma_f32_32x32x16_bf16 v[160:175], v[136:139], v[200:203], v[160:175]
    ds_read_b128 v[136:139], v5 offset:2048
    ds_read_b64_tr_b16 v[200:201], v8 offset:4096
    ds_read_b64_tr_b16 v[202:203], v8 offset:4608
    v_mfma_f32_32x32x16_bf16 v[160:175], v[140:143], v[204:207], v[160:175]
    ds_read_b128 v[140:143], v5 offset:3072
    ds_read_b64_tr_b16 v[204:205], v8 offset:6144
    ds_read_b64_tr_b16 v[206:207], v8 offset:6656
    s_waitcnt lgkmcnt(9)
    v_mfma_f32_32x32x16_bf16 v[160:175], v[128:131], v[192:195], v[160:175]
    v_mul_f32 v14, v14, v10
    v_mul_f32 v15, v15, v11
    v_mul_f32 v16, v16, v12
    v_mul_f32 v17, v17, v13
    v_cvt_pk_bf16_f32 v64, v14, v15
    ds_read_b128 v[128:131], v5 offset:4096
    ds_read_b64_tr_b16 v[192:193], v8 offset:8192
    ds_read_b64_tr_b16 v[194:195], v8 offset:8704
    s_waitcnt lgkmcnt(9)
    v_mfma_f32_32x32x16_bf16 v[160:175], v[132:135], v[196:199], v[160:175]
    v_cvt_pk_bf16_f32 v65, v16, v17
    v_mul_f32 v10, v6, v68
    v_mul_f32 v11, v6, v69
    v_mul_f32 v12, v6, v70
    v_mul_f32 v13, v6, v71
    ds_read_b128 v[132:135], v5 offset:5120
    ds_read_b64_tr_b16 v[196:197], v8 offset:10240
    ds_read_b64_tr_b16 v[198:199], v8 offset:10752
    s_waitcnt lgkmcnt(9)
    v_mfma_f32_32x32x16_bf16 v[160:175], v[136:139], v[200:203], v[160:175]
    v_exp_f32 v10, v10
    v_exp_f32 v11, v11
    v_exp_f32 v12, v12
    ds_read_b128 v[136:139], v5 offset:6144
    ds_read_b64_tr_b16 v[200:201], v8 offset:12288
    ds_read_b64_tr_b16 v[202:203], v8 offset:12800
    s_waitcnt lgkmcnt(9)
    v_mfma_f32_32x32x16_bf16 v[160:175], v[140:143], v[204:207], v[160:175]
    v_exp_f32 v13, v13
    v_mul_f32 v14, v68, v76
    v_mul_f32 v15, v69, v77
    ds_read_b128 v[140:143], v5 offset:7168
    ds_read_b64_tr_b16 v[204:205], v8 offset:14336
    ds_read_b64_tr_b16 v[206:207], v8 offset:14848
    s_waitcnt lgkmcnt(9)
    v_mfma_f32_32x32x16_bf16 v[160:175], v[128:131], v[192:195], v[160:175]
    v_mul_f32 v16, v70, v78
    v_mul_f32 v17, v71, v79
    v_fma_f32 v10, v10, v7, v7
    v_fma_f32 v11, v11, v7, v7
    v_fma_f32 v12, v12, v7, v7
    s_waitcnt lgkmcnt(0)
    s_barrier
    v_add_u32 v5, 0xc000, v26
    v_add_u32 v8, 0x14000, v29
    ds_read_b128 v[128:131], v5 offset:0
    ds_read_b64_tr_b16 v[192:193], v8 offset:0
    ds_read_b64_tr_b16 v[194:195], v8 offset:512
    v_mfma_f32_32x32x16_bf16 v[160:175], v[132:135], v[196:199], v[160:175]
    ds_read_b128 v[132:135], v5 offset:1024
    ds_read_b64_tr_b16 v[196:197], v8 offset:2048
    ds_read_b64_tr_b16 v[198:199], v8 offset:2560
    v_mfma_f32_32x32x16_bf16 v[160:175], v[136:139], v[200:203], v[160:175]
    ds_read_b128 v[136:139], v5 offset:2048
    ds_read_b64_tr_b16 v[200:201], v8 offset:4096
    ds_read_b64_tr_b16 v[202:203], v8 offset:4608
    v_mfma_f32_32x32x16_bf16 v[160:175], v[140:143], v[204:207], v[160:175]
    ds_read_b128 v[140:143], v5 offset:3072
    ds_read_b64_tr_b16 v[204:205], v8 offset:6144
    ds_read_b64_tr_b16 v[206:207], v8 offset:6656
    s_waitcnt lgkmcnt(9)
    v_mfma_f32_32x32x16_bf16 v[160:175], v[128:131], v[192:195], v[160:175]
    v_fma_f32 v13, v13, v7, v7
    v_rcp_f32 v10, v10
    v_rcp_f32 v11, v11
    ds_read_b128 v[128:131], v5 offset:4096
    ds_read_b64_tr_b16 v[192:193], v8 offset:8192
    ds_read_b64_tr_b16 v[194:195], v8 offset:8704
    s_waitcnt lgkmcnt(9)
    v_mfma_f32_32x32x16_bf16 v[160:175], v[132:135], v[196:199], v[160:175]
    v_rcp_f32 v12, v12
    v_rcp_f32 v13, v13
    v_mul_f32 v14, v14, v10
    ds_read_b128 v[132:135], v5 offset:5120
    ds_read_b64_tr_b16 v[196:197], v8 offset:10240
    ds_read_b64_tr_b16 v[198:199], v8 offset:10752
    s_waitcnt lgkmcnt(9)
    v_mfma_f32_32x32x16_bf16 v[160:175], v[136:139], v[200:203], v[160:175]
    v_mul_f32 v15, v15, v11
    v_mul_f32 v16, v16, v12
    v_mul_f32 v17, v17, v13
    v_cvt_pk_bf16_f32 v66, v14, v15
    v_cvt_pk_bf16_f32 v67, v16, v17
    ds_read_b128 v[136:139], v5 offset:6144
    ds_read_b64_tr_b16 v[200:201], v8 offset:12288
    ds_read_b64_tr_b16 v[202:203], v8 offset:12800
    s_waitcnt lgkmcnt(9)
    v_mfma_f32_32x32x16_bf16 v[160:175], v[140:143], v[204:207], v[160:175]
    buffer_store_dwordx4 v[64:67], v1, s[60:63], s9 offen offset:1024 sc1
    v_mul_f32 v240, v240, v242
    v_sub_f32 v240, 0, v240
    v_lshlrev_b32 v10, 2, v0
    v_add_u32 v10, 0x24a00, v10
    ds_read_b128 v[140:143], v5 offset:7168
    ds_read_b64_tr_b16 v[204:205], v8 offset:14336
    ds_read_b64_tr_b16 v[206:207], v8 offset:14848
    s_waitcnt lgkmcnt(9)
    v_mfma_f32_32x32x16_bf16 v[160:175], v[128:131], v[192:195], v[160:175]
    ds_write_b32 v10, v240
    ds_write_b32 v10, v242 offset:512
    s_waitcnt lgkmcnt(0)
    s_barrier
    v_add_u32 v5, 0x1c000, v26
    v_add_u32 v8, 0x18000, v29
    ds_read_b128 v[128:131], v5 offset:0
    ds_read_b64_tr_b16 v[192:193], v8 offset:0
    ds_read_b64_tr_b16 v[194:195], v8 offset:512
    v_mfma_f32_32x32x16_bf16 v[160:175], v[132:135], v[196:199], v[160:175]
    ds_read_b128 v[132:135], v5 offset:1024
    ds_read_b64_tr_b16 v[196:197], v8 offset:2048
    ds_read_b64_tr_b16 v[198:199], v8 offset:2560
    v_mfma_f32_32x32x16_bf16 v[160:175], v[136:139], v[200:203], v[160:175]
    ds_read_b128 v[136:139], v5 offset:2048
    ds_read_b64_tr_b16 v[200:201], v8 offset:4096
    ds_read_b64_tr_b16 v[202:203], v8 offset:4608
    v_mfma_f32_32x32x16_bf16 v[160:175], v[140:143], v[204:207], v[160:175]
    ds_read_b128 v[140:143], v5 offset:3072
    ds_read_b64_tr_b16 v[204:205], v8 offset:6144
    ds_read_b64_tr_b16 v[206:207], v8 offset:6656
    s_waitcnt lgkmcnt(9)
    v_mfma_f32_32x32x16_bf16 v[160:175], v[128:131], v[192:195], v[160:175]
    ds_read_b128 v[128:131], v5 offset:4096
    ds_read_b64_tr_b16 v[192:193], v8 offset:8192
    ds_read_b64_tr_b16 v[194:195], v8 offset:8704
    s_waitcnt lgkmcnt(9)
    v_mfma_f32_32x32x16_bf16 v[160:175], v[132:135], v[196:199], v[160:175]
    ds_read_b128 v[132:135], v5 offset:5120
    ds_read_b64_tr_b16 v[196:197], v8 offset:10240
    ds_read_b64_tr_b16 v[198:199], v8 offset:10752
    s_waitcnt lgkmcnt(9)
    v_mfma_f32_32x32x16_bf16 v[160:175], v[136:139], v[200:203], v[160:175]
    ds_read_b128 v[136:139], v5 offset:6144
    ds_read_b64_tr_b16 v[200:201], v8 offset:12288
    ds_read_b64_tr_b16 v[202:203], v8 offset:12800
    s_waitcnt lgkmcnt(9)
    v_mfma_f32_32x32x16_bf16 v[160:175], v[140:143], v[204:207], v[160:175]
    ds_read_b128 v[140:143], v5 offset:7168
    ds_read_b64_tr_b16 v[204:205], v8 offset:14336
    ds_read_b64_tr_b16 v[206:207], v8 offset:14848
    s_waitcnt lgkmcnt(9)
    v_mfma_f32_32x32x16_bf16 v[160:175], v[128:131], v[192:195], v[160:175]
    s_waitcnt vmcnt(0)
    s_waitcnt lgkmcnt(0)
    s_barrier
    s_add_u32 s101, s26, 3
    v_mov_b32 v19, s101
    buffer_store_dword v19, v24, s[60:63], 0 offen offset:0 sc0 sc1
    v_add_u32 v5, 0x0, v26
    v_add_u32 v9, 0x20000, v30
    v_xor_b32 v20, 32, v9
    v_xor_b32 v21, 64, v9
    v_xor_b32 v22, 96, v9
    ds_read_b128 v[128:131], v5 offset:0
    ds_read_b128 v[192:195], v9 offset:0
    v_mfma_f32_32x32x16_bf16 v[160:175], v[132:135], v[196:199], v[160:175]
    ds_read_b128 v[132:135], v5 offset:1024
    ds_read_b128 v[196:199], v20 offset:0
    v_mfma_f32_32x32x16_bf16 v[160:175], v[136:139], v[200:203], v[160:175]
    ds_read_b128 v[136:139], v5 offset:2048
    ds_read_b128 v[200:203], v21 offset:0
    v_mfma_f32_32x32x16_bf16 v[160:175], v[140:143], v[204:207], v[160:175]
    ds_read_b128 v[140:143], v5 offset:3072
    ds_read_b128 v[204:207], v22 offset:0
    s_waitcnt lgkmcnt(6)
    v_mfma_f32_32x32x16_bf16 v[176:191], v[128:131], v[192:195], 0
    ds_read_b128 v[128:131], v5 offset:4096
    ds_read_b128 v[192:195], v9 offset:8192
    s_waitcnt lgkmcnt(6)
    v_mfma_f32_32x32x16_bf16 v[176:191], v[132:135], v[196:199], v[176:191]
    ds_read_b128 v[132:135], v5 offset:5120
    ds_read_b128 v[196:199], v20 offset:8192
    s_waitcnt lgkmcnt(6)
    v_mfma_f32_32x32x16_bf16 v[176:191], v[136:139], v[200:203], v[176:191]
    ds_read_b128 v[136:139], v5 offset:6144
    ds_read_b128 v[200:203], v21 offset:8192
    s_waitcnt lgkmcnt(6)
    v_mfma_f32_32x32x16_bf16 v[176:191], v[140:143], v[204:207], v[176:191]
    ds_read_b128 v[140:143], v5 offset:7168
    ds_read_b128 v[204:207], v22 offset:8192
    s_waitcnt lgkmcnt(6)
    v_mfma_f32_32x32x16_bf16 v[176:191], v[128:131], v[192:195], v[176:191]
    s_waitcnt lgkmcnt(0)
    s_barrier
    v_add_u32 v5, 0x10000, v26
    v_add_u32 v9, 0x4000, v30
    v_xor_b32 v20, 32, v9
    v_xor_b32 v21, 64, v9
    v_xor_b32 v22, 96, v9
    ds_read_b128 v[128:131], v5 offset:0
    ds_read_b128 v[192:195], v9 offset:0
    v_mfma_f32_32x32x16_bf16 v[176:191], v[132:135], v[196:199], v[176:191]
    ds_read_b128 v[132:135], v5 offset:1024
    ds_read_b128 v[196:199], v20 offset:0
    v_mfma_f32_32x32x16_bf16 v[176:191], v[136:139], v[200:203], v[176:191]
    ds_read_b128 v[136:139], v5 offset:2048
    ds_read_b128 v[200:203], v21 offset:0
    v_mfma_f32_32x32x16_bf16 v[176:191], v[140:143], v[204:207], v[176:191]
    ds_read_b128 v[140:143], v5 offset:3072
    ds_read_b128 v[204:207], v22 offset:0
    s_waitcnt lgkmcnt(6)
    v_mfma_f32_32x32x16_bf16 v[176:191], v[128:131], v[192:195], v[176:191]
    ds_read_b128 v[128:131], v5 offset:4096
    ds_read_b128 v[192:195], v9 offset:8192
    s_waitcnt lgkmcnt(6)
    v_mfma_f32_32x32x16_bf16 v[176:191], v[132:135], v[196:199], v[176:191]
    ds_read_b128 v[132:135], v5 offset:5120
    ds_read_b128 v[196:199], v20 offset:8192
    s_waitcnt lgkmcnt(6)
    v_mfma_f32_32x32x16_bf16 v[176:191], v[136:139], v[200:203], v[176:191]
    ds_read_b128 v[136:139], v5 offset:6144
    ds_read_b128 v[200:203], v21 offset:8192
    s_waitcnt lgkmcnt(6)
    v_mfma_f32_32x32x16_bf16 v[176:191], v[140:143], v[204:207], v[176:191]
    ds_read_b128 v[140:143], v5 offset:7168
    ds_read_b128 v[204:207], v22 offset:8192
    s_waitcnt lgkmcnt(6)
    v_mfma_f32_32x32x16_bf16 v[176:191], v[128:131], v[192:195], v[176:191]
    s_waitcnt lgkmcnt(0)
    s_barrier
    v_add_u32 v5, 0x14000, v26
    v_add_u32 v9, 0x8000, v30
    v_xor_b32 v20, 32, v9
    v_xor_b32 v21, 64, v9
    v_xor_b32 v22, 96, v9
    ds_read_b128 v[128:131], v5 offset:0
    ds_read_b128 v[192:195], v9 offset:0
    v_mfma_f32_32x32x16_bf16 v[176:191], v[132:135], v[196:199], v[176:191]
    ds_read_b128 v[132:135], v5 offset:1024
    ds_read_b128 v[196:199], v20 offset:0
    v_mfma_f32_32x32x16_bf16 v[176:191], v[136:139], v[200:203], v[176:191]
    ds_read_b128 v[136:139], v5 offset:2048
    ds_read_b128 v[200:203], v21 offset:0
    v_mfma_f32_32x32x16_bf16 v[176:191], v[140:143], v[204:207], v[176:191]
    ds_read_b128 v[140:143], v5 offset:3072
    ds_read_b128 v[204:207], v22 offset:0
    s_waitcnt lgkmcnt(6)
    v_mfma_f32_32x32x16_bf16 v[176:191], v[128:131], v[192:195], v[176:191]
    s_lshr_b32 s6, s92, 1
    s_and_b32 s7, s92, 1
    s_lshl_b32 s4, s6, 7
    v_lshrrev_b32 v14, 5, v0
    v_lshlrev_b32 v10, 6, v14
    v_add_u32 v10, s4, v10
    v_add_u32 v10, 0x24a00, v10
    ds_read_b128 v[128:131], v5 offset:4096
    ds_read_b128 v[192:195], v9 offset:8192
    s_waitcnt lgkmcnt(6)
    v_mfma_f32_32x32x16_bf16 v[176:191], v[132:135], v[196:199], v[176:191]
    s_lshl_b32 s4, s6, 12
    s_lshl_b32 s5, s7, 6
    s_add_u32 s4, s4, s5
    s_add_u32 s4, s4, 0x25b00
    v_lshlrev_b32 v14, 11, v14
    v_and_b32 v15, 31, v0
    v_lshl_add_u32 v14, v15, 1, v14
    v_add_u32 v14, s4, v14
    ds_read_b128 v[132:135], v5 offset:5120
    ds_read_b128 v[196:199], v20 offset:8192
    s_waitcnt lgkmcnt(6)
    v_mfma_f32_32x32x16_bf16 v[176:191], v[136:139], v[200:203], v[176:191]
    ds_read_u16 v208, v14 offset:0
    ds_read_u16 v209, v14 offset:128
    ds_read_u16 v210, v14 offset:256
    ds_read_u16 v211, v14 offset:384
    ds_read_u16 v212, v14 offset:512
    ds_read_u16 v213, v14 offset:640
    ds_read_u16 v214, v14 offset:768
    ds_read_b128 v[136:139], v5 offset:6144
    ds_read_b128 v[200:203], v21 offset:8192
    s_waitcnt lgkmcnt(13)
    v_mfma_f32_32x32x16_bf16 v[176:191], v[140:143], v[204:207], v[176:191]
    ds_read_u16 v215, v14 offset:896
    ds_read_u16 v216, v14 offset:1024
    ds_read_u16 v217, v14 offset:1152
    ds_read_u16 v218, v14 offset:1280
    ds_read_u16 v219, v14 offset:1408
    ds_read_u16 v220, v14 offset:1536
    ds_read_u16 v221, v14 offset:1664
    ds_read_u16 v222, v14 offset:1792
    ds_read_u16 v223, v14 offset:1920
    ds_read_b128 v[140:143], v5 offset:7168
    ds_read_b128 v[204:207], v22 offset:8192
    s_waitcnt lgkmcnt(15)
    v_mfma_f32_32x32x16_bf16 v[176:191], v[128:131], v[192:195], v[176:191]
    ds_read_b128 v[96:99], v10 offset:0
    ds_read_b128 v[80:83], v10 offset:512
    ds_read_b128 v[100:103], v10 offset:16
    ds_read_b128 v[84:87], v10 offset:528
    ds_read_b128 v[104:107], v10 offset:32
    ds_read_b128 v[88:91], v10 offset:544
    ds_read_b128 v[108:111], v10 offset:48
    ds_read_b128 v[92:95], v10 offset:560
    s_waitcnt lgkmcnt(0)
    s_barrier
    buffer_load_dword v27, v25, s[60:63], 0 offen sc0 sc1
    v_add_u32 v5, 0x18000, v26
    v_add_u32 v9, 0xc000, v30
    v_xor_b32 v20, 32, v9
    v_xor_b32 v21, 64, v9
    v_xor_b32 v22, 96, v9
    ds_read_b128 v[128:131], v5 offset:0
    ds_read_b128 v[192:195], v9 offset:0
    v_mfma_f32_32x32x16_bf16 v[176:191], v[132:135], v[196:199], v[176:191]
    ds_read_b128 v[132:135], v5 offset:1024
    ds_read_b128 v[196:199], v20 offset:0
    v_mfma_f32_32x32x16_bf16 v[176:191], v[136:139], v[200:203], v[176:191]
    ds_read_b128 v[136:139], v5 offset:2048
    ds_read_b128 v[200:203], v21 offset:0
    v_mfma_f32_32x32x16_bf16 v[176:191], v[140:143], v[204:207], v[176:191]
    ds_read_b128 v[140:143], v5 offset:3072
    ds_read_b128 v[204:207], v22 offset:0
    s_waitcnt lgkmcnt(6)
    v_mfma_f32_32x32x16_bf16 v[176:191], v[128:131], v[192:195], v[176:191]
    v_lshlrev_b32 v23, 16, v23
    v_lshlrev_b32 v208, 16, v208
    v_lshlrev_b32 v209, 16, v209
    v_lshlrev_b32 v210, 16, v210
    v_lshlrev_b32 v211, 16, v211
    ds_read_b128 v[128:131], v5 offset:4096
    ds_read_b128 v[192:195], v9 offset:8192
    s_waitcnt lgkmcnt(6)
    v_mfma_f32_32x32x16_bf16 v[176:191], v[132:135], v[196:199], v[176:191]
    v_lshlrev_b32 v212, 16, v212
    v_lshlrev_b32 v213, 16, v213
    v_lshlrev_b32 v214, 16, v214
    v_lshlrev_b32 v215, 16, v215
    v_lshlrev_b32 v216, 16, v216
    ds_read_b128 v[132:135], v5 offset:5120
    ds_read_b128 v[196:199], v20 offset:8192
    s_waitcnt lgkmcnt(6)
    v_mfma_f32_32x32x16_bf16 v[176:191], v[136:139], v[200:203], v[176:191]
    v_lshlrev_b32 v217, 16, v217
    v_lshlrev_b32 v218, 16, v218
    v_lshlrev_b32 v219, 16, v219
    v_lshlrev_b32 v220, 16, v220
    v_lshlrev_b32 v221, 16, v221
    ds_read_b128 v[136:139], v5 offset:6144
    ds_read_b128 v[200:203], v21 offset:8192
    s_waitcnt lgkmcnt(6)
    v_mfma_f32_32x32x16_bf16 v[176:191], v[140:143], v[204:207], v[176:191]
    v_lshlrev_b32 v222, 16, v222
    v_lshlrev_b32 v223, 16, v223
    v_fma_f32 v80, v208, v80, v96
    v_fma_f32 v81, v209, v81, v97
    v_fma_f32 v82, v210, v82, v98
    ds_read_b128 v[140:143], v5 offset:7168
    ds_read_b128 v[204:207], v22 offset:8192
    s_waitcnt lgkmcnt(6)
    v_mfma_f32_32x32x16_bf16 v[176:191], v[128:131], v[192:195], v[176:191]
    v_fma_f32 v83, v211, v83, v99
    v_fma_f32 v84, v212, v84, v100
    v_fma_f32 v85, v213, v85, v101
    v_fma_f32 v86, v214, v86, v102
    v_fma_f32 v87, v215, v87, v103
    s_add_u32 s101, s26, 3
    s_waitcnt vmcnt(0)
    v_subrev_u32 v27, s101, v27
    v_cmp_ge_u32 vcc, 4, v27
    s_nop 3
    s_cmp_eq_u64 vcc, exec
    s_cbranch_scc1 L_polld15
    s_mov_b32 s97, 400000
L_poll14:
    s_sleep 1
    buffer_load_dword v27, v25, s[60:63], 0 offen sc0 sc1
    s_waitcnt vmcnt(0)
    v_subrev_u32 v27, s101, v27
    v_cmp_ge_u32 vcc, 4, v27
    s_nop 4
    s_cmp_eq_u64 vcc, exec
    s_cbranch_scc1 L_polld15
    s_sub_u32 s97, s97, 1
    s_cmp_lg_u32 s97, 0
    s_cbranch_scc1 L_poll14
L_polld15:
    s_nop 4
    s_waitcnt lgkmcnt(0)
    s_barrier
    v_add_u32 v5, 0x20000, v26
    v_add_u32 v9, 0x1c000, v30
    v_xor_b32 v20, 32, v9
    v_xor_b32 v21, 64, v9
    v_xor_b32 v22, 96, v9
    ds_read_b128 v[128:131], v5 offset:0
    ds_read_b128 v[192:195], v9 offset:0
    v_mfma_f32_32x32x16_bf16 v[176:191], v[132:135], v[196:199], v[176:191]
    ds_read_b128 v[132:135], v5 offset:1024
    ds_read_b128 v[196:199], v20 offset:0
    v_mfma_f32_32x32x16_bf16 v[176:191], v[136:139], v[200:203], v[176:191]
    ds_read_b128 v[136:139], v5 offset:2048
    ds_read_b128 v[200:203], v21 offset:0
    v_mfma_f32_32x32x16_bf16 v[176:191], v[140:143], v[204:207], v[176:191]
    ds_read_b128 v[140:143], v5 offset:3072
    ds_read_b128 v[204:207], v22 offset:0
    s_waitcnt lgkmcnt(6)
    v_mfma_f32_32x32x16_bf16 v[176:191], v[128:131], v[192:195], v[176:191]
    v_fma_f32 v88, v216, v88, v104
    v_fma_f32 v89, v217, v89, v105
    v_fma_f32 v90, v218, v90, v106
    v_fma_f32 v91, v219, v91, v107
    v_fma_f32 v92, v220, v92, v108
    ds_read_b128 v[128:131], v5 offset:4096
    ds_read_b128 v[192:195], v9 offset:8192
    s_waitcnt lgkmcnt(6)
    v_mfma_f32_32x32x16_bf16 v[176:191], v[132:135], v[196:199], v[176:191]
    v_fma_f32 v93, v221, v93, v109
    v_fma_f32 v94, v222, v94, v110
    v_fma_f32 v95, v223, v95, v111
    s_mul_i32 s4, s92, 4608
    v_lshrrev_b32 v10, 5, v0
    v_mul_u32_u24 v10, 2304, v10
    ds_read_b128 v[132:135], v5 offset:5120
    ds_read_b128 v[196:199], v20 offset:8192
    s_waitcnt lgkmcnt(6)
    v_mfma_f32_32x32x16_bf16 v[176:191], v[136:139], v[200:203], v[176:191]
    v_and_b32 v11, 31, v0
    v_lshl_add_u32 v10, v11, 2, v10
    v_add_u32 v112, s4, v10
    v_lshrrev_b32 v10, 3, v0
    v_mul_u32_u24 v10, 144, v10
    ds_read_b128 v[136:139], v5 offset:6144
    ds_read_b128 v[200:203], v21 offset:8192
    s_waitcnt lgkmcnt(6)
    v_mfma_f32_32x32x16_bf16 v[176:191], v[140:143], v[204:207], v[176:191]
    v_and_b32 v11, 7, v0
    v_lshl_add_u32 v10, v11, 4, v10
    v_add_u32 v113, s4, v10
    s_lshl_b32 s4, s90, 6
    s_lshl_b32 s5, s6, 5
    s_add_u32 s4, s4, s5
    v_lshrrev_b32 v10, 3, v0
    ds_read_b128 v[140:143], v5 offset:7168
    ds_read_b128 v[204:207], v22 offset:8192
    s_waitcnt lgkmcnt(6)
    v_mfma_f32_32x32x16_bf16 v[176:191], v[128:131], v[192:195], v[176:191]
    v_add_u32 v10, s4, v10
    v_lshlrev_b32 v10, 11, v10
    s_lshl_b32 s4, s91, 8
    s_lshl_b32 s5, s7, 7
    s_add_u32 s4, s4, s5
    v_and_b32 v11, 7, v0
    v_lshl_add_u32 v10, v11, 4, v10
    s_waitcnt lgkmcnt(0)
    s_barrier
    v_add_u32 v5, 0x4000, v26
    v_add_u32 v9, 0x0, v30
    v_xor_b32 v20, 32, v9
    v_xor_b32 v21, 64, v9
    v_xor_b32 v22, 96, v9
    ds_read_b128 v[128:131], v5 offset:0
    ds_read_b128 v[192:195], v9 offset:0
    v_mfma_f32_32x32x16_bf16 v[176:191], v[132:135], v[196:199], v[176:191]
    ds_read_b128 v[132:135], v5 offset:1024
    ds_read_b128 v[196:199], v20 offset:0
    v_mfma_f32_32x32x16_bf16 v[176:191], v[136:139], v[200:203], v[176:191]
    ds_read_b128 v[136:139], v5 offset:2048
    ds_read_b128 v[200:203], v21 offset:0
    v_mfma_f32_32x32x16_bf16 v[176:191], v[140:143], v[204:207], v[176:191]
    ds_read_b128 v[140:143], v5 offset:3072
    ds_read_b128 v[204:207], v22 offset:0
    s_waitcnt lgkmcnt(6)
    v_mfma_f32_32x32x16_bf16 v[176:191], v[128:131], v[192:195], v[176:191]
    v_add_u32 v31, s4, v10
    ds_read_b128 v[128:131], v5 offset:4096
    ds_read_b128 v[192:195], v9 offset:8192
    s_waitcnt lgkmcnt(6)
    v_mfma_f32_32x32x16_bf16 v[176:191], v[132:135], v[196:199], v[176:191]
    ds_read_b128 v[132:135], v5 offset:5120
    ds_read_b128 v[196:199], v20 offset:8192
    s_waitcnt lgkmcnt(6)
    v_mfma_f32_32x32x16_bf16 v[176:191], v[136:139], v[200:203], v[176:191]
    ds_read_b128 v[136:139], v5 offset:6144
    ds_read_b128 v[200:203], v21 offset:8192
    s_waitcnt lgkmcnt(6)
    v_mfma_f32_32x32x16_bf16 v[176:191], v[140:143], v[204:207], v[176:191]
    ds_read_b128 v[140:143], v5 offset:7168
    ds_read_b128 v[204:207], v22 offset:8192
    s_waitcnt lgkmcnt(6)
    v_mfma_f32_32x32x16_bf16 v[176:191], v[128:131], v[192:195], v[176:191]
    s_waitcnt lgkmcnt(0)
    s_barrier
    v_add_u32 v5, 0x8000, v26
    v_add_u32 v9, 0x10000, v30
    v_xor_b32 v20, 32, v9
    v_xor_b32 v21, 64, v9
    v_xor_b32 v22, 96, v9
    ds_read_b128 v[128:131], v5 offset:0
    ds_read_b128 v[192:195], v9 offset:0
    v_mfma_f32_32x32x16_bf16 v[176:191], v[132:135], v[196:199], v[176:191]
    ds_read_b128 v[132:135], v5 offset:1024
    ds_read_b128 v[196:199], v20 offset:0
    v_mfma_f32_32x32x16_bf16 v[176:191], v[136:139], v[200:203], v[176:191]
    ds_read_b128 v[136:139], v5 offset:2048
    ds_read_b128 v[200:203], v21 offset:0
    v_mfma_f32_32x32x16_bf16 v[176:191], v[140:143], v[204:207], v[176:191]
    ds_read_b128 v[140:143], v5 offset:3072
    ds_read_b128 v[204:207], v22 offset:0
    s_waitcnt lgkmcnt(6)
    v_mfma_f32_32x32x16_bf16 v[176:191], v[128:131], v[192:195], v[176:191]
    ds_read_b128 v[128:131], v5 offset:4096
    ds_read_b128 v[192:195], v9 offset:8192
    s_waitcnt lgkmcnt(6)
    v_mfma_f32_32x32x16_bf16 v[176:191], v[132:135], v[196:199], v[176:191]
    ds_read_b128 v[132:135], v5 offset:5120
    ds_read_b128 v[196:199], v20 offset:8192
    s_waitcnt lgkmcnt(6)
    v_mfma_f32_32x32x16_bf16 v[176:191], v[136:139], v[200:203], v[176:191]
    ds_read_b128 v[136:139], v5 offset:6144
    ds_read_b128 v[200:203], v21 offset:8192
    s_waitcnt lgkmcnt(6)
    v_mfma_f32_32x32x16_bf16 v[176:191], v[140:143], v[204:207], v[176:191]
    ds_read_b128 v[140:143], v5 offset:7168
    ds_read_b128 v[204:207], v22 offset:8192
    s_waitcnt lgkmcnt(6)
    v_mfma_f32_32x32x16_bf16 v[176:191], v[128:131], v[192:195], v[176:191]
    s_waitcnt lgkmcnt(0)
    s_barrier
    v_add_u32 v5, 0xc000, v26
    v_add_u32 v9, 0x14000, v30
    v_xor_b32 v20, 32, v9
    v_xor_b32 v21, 64, v9
    v_xor_b32 v22, 96, v9
    ds_read_b128 v[128:131], v5 offset:0
    ds_read_b128 v[192:195], v9 offset:0
    v_mfma_f32_32x32x16_bf16 v[176:191], v[132:135], v[196:199], v[176:191]
    ds_read_b128 v[132:135], v5 offset:1024
    ds_read_b128 v[196:199], v20 offset:0
    v_mfma_f32_32x32x16_bf16 v[176:191], v[136:139], v[200:203], v[176:191]
    ds_read_b128 v[136:139], v5 offset:2048
    ds_read_b128 v[200:203], v21 offset:0
    v_mfma_f32_32x32x16_bf16 v[176:191], v[140:143], v[204:207], v[176:191]
    ds_read_b128 v[140:143], v5 offset:3072
    ds_read_b128 v[204:207], v22 offset:0
    s_waitcnt lgkmcnt(6)
    v_mfma_f32_32x32x16_bf16 v[176:191], v[128:131], v[192:195], v[176:191]
    ds_read_b128 v[128:131], v5 offset:4096
    ds_read_b128 v[192:195], v9 offset:8192
    s_waitcnt lgkmcnt(6)
    v_mfma_f32_32x32x16_bf16 v[176:191], v[132:135], v[196:199], v[176:191]
    ds_read_b128 v[132:135], v5 offset:5120
    ds_read_b128 v[196:199], v20 offset:8192
    s_waitcnt lgkmcnt(6)
    v_mfma_f32_32x32x16_bf16 v[176:191], v[136:139], v[200:203], v[176:191]
    ds_read_b128 v[136:139], v5 offset:6144
    ds_read_b128 v[200:203], v21 offset:8192
    s_waitcnt lgkmcnt(6)
    v_mfma_f32_32x32x16_bf16 v[176:191], v[140:143], v[204:207], v[176:191]
    ds_read_b128 v[140:143], v5 offset:7168
    ds_read_b128 v[204:207], v22 offset:8192
    s_waitcnt lgkmcnt(6)
    v_mfma_f32_32x32x16_bf16 v[176:191], v[128:131], v[192:195], v[176:191]
    s_waitcnt lgkmcnt(0)
    s_barrier
    v_add_u32 v5, 0x1c000, v26
    v_add_u32 v8, 0x18000, v29
    ds_read_b128 v[128:131], v5 offset:0
    ds_read_b64_tr_b16 v[192:193], v8 offset:0
    ds_read_b64_tr_b16 v[194:195], v8 offset:512
    v_mfma_f32_32x32x16_bf16 v[176:191], v[132:135], v[196:199], v[176:191]
    ds_read_b128 v[132:135], v5 offset:1024
    ds_read_b64_tr_b16 v[196:197], v8 offset:2048
    ds_read_b64_tr_b16 v[198:199], v8 offset:2560
    v_mfma_f32_32x32x16_bf16 v[176:191], v[136:139], v[200:203], v[176:191]
    ds_read_b128 v[136:139], v5 offset:2048
    ds_read_b64_tr_b16 v[200:201], v8 offset:4096
    ds_read_b64_tr_b16 v[202:203], v8 offset:4608
    v_mfma_f32_32x32x16_bf16 v[176:191], v[140:143], v[204:207], v[176:191]
    ds_read_b128 v[140:143], v5 offset:3072
    ds_read_b64_tr_b16 v[204:205], v8 offset:6144
    ds_read_b64_tr_b16 v[206:207], v8 offset:6656
    s_waitcnt lgkmcnt(9)
    v_mfma_f32_32x32x16_bf16 v[160:175], v[128:131], v[192:195], v[160:175]
    ds_read_b128 v[128:131], v5 offset:4096
    ds_read_b64_tr_b16 v[192:193], v8 offset:8192
    ds_read_b64_tr_b16 v[194:195], v8 offset:8704
    s_waitcnt lgkmcnt(9)
    v_mfma_f32_32x32x16_bf16 v[160:175], v[132:135], v[196:199], v[160:175]
    ds_read_b128 v[132:135], v5 offset:5120
    ds_read_b64_tr_b16 v[196:197], v8 offset:10240
    ds_read_b64_tr_b16 v[198:199], v8 offset:10752
    s_waitcnt lgkmcnt(9)
    v_mfma_f32_32x32x16_bf16 v[160:175], v[136:139], v[200:203], v[160:175]
    ds_read_b128 v[136:139], v5 offset:6144
    ds_read_b64_tr_b16 v[200:201], v8 offset:12288
    ds_read_b64_tr_b16 v[202:203], v8 offset:12800
    s_waitcnt lgkmcnt(9)
    v_mfma_f32_32x32x16_bf16 v[160:175], v[140:143], v[204:207], v[160:175]
    v_fma_f32 v176, v80, v23, v176
    v_fma_f32 v177, v81, v23, v177
    v_fma_f32 v178, v82, v23, v178
    v_fma_f32 v179, v83, v23, v179
    v_fma_f32 v180, v84, v23, v180
    v_fma_f32 v181, v85, v23, v181
    v_fma_f32 v182, v86, v23, v182
    v_fma_f32 v183, v87, v23, v183
    v_fma_f32 v184, v88, v23, v184
    v_fma_f32 v185, v89, v23, v185
    ds_read_b128 v[140:143], v5 offset:7168
    ds_read_b64_tr_b16 v[204:205], v8 offset:14336
    ds_read_b64_tr_b16 v[206:207], v8 offset:14848
    s_waitcnt lgkmcnt(9)
    v_mfma_f32_32x32x16_bf16 v[160:175], v[128:131], v[192:195], v[160:175]
    v_fma_f32 v186, v90, v23, v186
    v_fma_f32 v187, v91, v23, v187
    v_fma_f32 v188, v92, v23, v188
    v_fma_f32 v189, v93, v23, v189
    v_fma_f32 v190, v94, v23, v190
    s_waitcnt lgkmcnt(0)
    s_barrier
    v_add_u32 v5, 0x0, v26
    v_add_u32 v8, 0x20000, v29
    ds_read_b128 v[128:131], v5 offset:0
    ds_read_b64_tr_b16 v[192:193], v8 offset:0
    ds_read_b64_tr_b16 v[194:195], v8 offset:512
    v_mfma_f32_32x32x16_bf16 v[160:175], v[132:135], v[196:199], v[160:175]
    ds_read_b128 v[132:135], v5 offset:1024
    ds_read_b64_tr_b16 v[196:197], v8 offset:2048
    ds_read_b64_tr_b16 v[198:199], v8 offset:2560
    v_mfma_f32_32x32x16_bf16 v[160:175], v[136:139], v[200:203], v[160:175]
    ds_read_b128 v[136:139], v5 offset:2048
    ds_read_b64_tr_b16 v[200:201], v8 offset:4096
    ds_read_b64_tr_b16 v[202:203], v8 offset:4608
    v_mfma_f32_32x32x16_bf16 v[160:175], v[140:143], v[204:207], v[160:175]
    ds_read_b128 v[140:143], v5 offset:3072
    ds_read_b64_tr_b16 v[204:205], v8 offset:6144
    ds_read_b64_tr_b16 v[206:207], v8 offset:6656
    s_waitcnt lgkmcnt(9)
    v_mfma_f32_32x32x16_bf16 v[160:175], v[128:131], v[192:195], v[160:175]
    v_fma_f32 v191, v95, v23, v191
    ds_read_b128 v[128:131], v5 offset:4096
    ds_read_b64_tr_b16 v[192:193], v8 offset:8192
    ds_read_b64_tr_b16 v[194:195], v8 offset:8704
    s_waitcnt lgkmcnt(9)
    v_mfma_f32_32x32x16_bf16 v[160:175], v[132:135], v[196:199], v[160:175]
    ds_read_b128 v[132:135], v5 offset:5120
    ds_read_b64_tr_b16 v[196:197], v8 offset:10240
    ds_read_b64_tr_b16 v[198:199], v8 offset:10752
    s_waitcnt lgkmcnt(9)
    v_mfma_f32_32x32x16_bf16 v[160:175], v[136:139], v[200:203], v[160:175]
    ds_read_b128 v[136:139], v5 offset:6144
    ds_read_b64_tr_b16 v[200:201], v8 offset:12288
    ds_read_b64_tr_b16 v[202:203], v8 offset:12800
    s_waitcnt lgkmcnt(9)
    v_mfma_f32_32x32x16_bf16 v[160:175], v[140:143], v[204:207], v[160:175]
    ds_read_b128 v[140:143], v5 offset:7168
    ds_read_b64_tr_b16 v[204:205], v8 offset:14336
    ds_read_b64_tr_b16 v[206:207], v8 offset:14848
    s_waitcnt lgkmcnt(9)
    v_mfma_f32_32x32x16_bf16 v[160:175], v[128:131], v[192:195], v[160:175]
    s_waitcnt lgkmcnt(0)
    s_barrier
    v_add_u32 v5, 0x10000, v26
    v_add_u32 v8, 0x4000, v29
    ds_read_b128 v[128:131], v5 offset:0
    ds_read_b64_tr_b16 v[192:193], v8 offset:0
    ds_read_b64_tr_b16 v[194:195], v8 offset:512
    v_mfma_f32_32x32x16_bf16 v[160:175], v[132:135], v[196:199], v[160:175]
    ds_read_b128 v[132:135], v5 offset:1024
    ds_read_b64_tr_b16 v[196:197], v8 offset:2048
    ds_read_b64_tr_b16 v[198:199], v8 offset:2560
    v_mfma_f32_32x32x16_bf16 v[160:175], v[136:139], v[200:203], v[160:175]
    ds_read_b128 v[136:139], v5 offset:2048
    ds_read_b64_tr_b16 v[200:201], v8 offset:4096
    ds_read_b64_tr_b16 v[202:203], v8 offset:4608
    v_mfma_f32_32x32x16_bf16 v[160:175], v[140:143], v[204:207], v[160:175]
    ds_read_b128 v[140:143], v5 offset:3072
    ds_read_b64_tr_b16 v[204:205], v8 offset:6144
    ds_read_b64_tr_b16 v[206:207], v8 offset:6656
    s_waitcnt lgkmcnt(9)
    v_mfma_f32_32x32x16_bf16 v[160:175], v[128:131], v[192:195], v[160:175]
    ds_read_b128 v[128:131], v5 offset:4096
    ds_read_b64_tr_b16 v[192:193], v8 offset:8192
    ds_read_b64_tr_b16 v[194:195], v8 offset:8704
    s_waitcnt lgkmcnt(9)
    v_mfma_f32_32x32x16_bf16 v[160:175], v[132:135], v[196:199], v[160:175]
    ds_read_b128 v[132:135], v5 offset:5120
    ds_read_b64_tr_b16 v[196:197], v8 offset:10240
    ds_read_b64_tr_b16 v[198:199], v8 offset:10752
    s_waitcnt lgkmcnt(9)
    v_mfma_f32_32x32x16_bf16 v[160:175], v[136:139], v[200:203], v[160:175]
    ds_read_b128 v[136:139], v5 offset:6144
    ds_read_b64_tr_b16 v[200:201], v8 offset:12288
    ds_read_b64_tr_b16 v[202:203], v8 offset:12800
    s_waitcnt lgkmcnt(9)
    v_mfma_f32_32x32x16_bf16 v[160:175], v[140:143], v[204:207], v[160:175]
    ds_read_b128 v[140:143], v5 offset:7168
    ds_read_b64_tr_b16 v[204:205], v8 offset:14336
    ds_read_b64_tr_b16 v[206:207], v8 offset:14848
    s_waitcnt lgkmcnt(9)
    v_mfma_f32_32x32x16_bf16 v[160:175], v[128:131], v[192:195], v[160:175]
    s_waitcnt lgkmcnt(0)
    s_barrier
    v_add_u32 v5, 0x14000, v26
    v_add_u32 v8, 0x8000, v29
    ds_read_b128 v[128:131], v5 offset:0
    ds_read_b64_tr_b16 v[192:193], v8 offset:0
    ds_read_b64_tr_b16 v[194:195], v8 offset:512
    v_mfma_f32_32x32x16_bf16 v[160:175], v[132:135], v[196:199], v[160:175]
    ds_read_b128 v[132:135], v5 offset:1024
    ds_read_b64_tr_b16 v[196:197], v8 offset:2048
    ds_read_b64_tr_b16 v[198:199], v8 offset:2560
    v_mfma_f32_32x32x16_bf16 v[160:175], v[136:139], v[200:203], v[160:175]
    ds_read_b128 v[136:139], v5 offset:2048
    ds_read_b64_tr_b16 v[200:201], v8 offset:4096
    ds_read_b64_tr_b16 v[202:203], v8 offset:4608
    v_mfma_f32_32x32x16_bf16 v[160:175], v[140:143], v[204:207], v[160:175]
    ds_read_b128 v[140:143], v5 offset:3072
    ds_read_b64_tr_b16 v[204:205], v8 offset:6144
    ds_read_b64_tr_b16 v[206:207], v8 offset:6656
    s_waitcnt lgkmcnt(9)
    v_mfma_f32_32x32x16_bf16 v[160:175], v[128:131], v[192:195], v[160:175]
    ds_read_b128 v[128:131], v5 offset:4096
    ds_read_b64_tr_b16 v[192:193], v8 offset:8192
    ds_read_b64_tr_b16 v[194:195], v8 offset:8704
    s_waitcnt lgkmcnt(9)
    v_mfma_f32_32x32x16_bf16 v[160:175], v[132:135], v[196:199], v[160:175]
    ds_read_b128 v[132:135], v5 offset:5120
    ds_read_b64_tr_b16 v[196:197], v8 offset:10240
    ds_read_b64_tr_b16 v[198:199], v8 offset:10752
    s_waitcnt lgkmcnt(9)
    v_mfma_f32_32x32x16_bf16 v[160:175], v[136:139], v[200:203], v[160:175]
    ds_read_b128 v[136:139], v5 offset:6144
    ds_read_b64_tr_b16 v[200:201], v8 offset:12288
    ds_read_b64_tr_b16 v[202:203], v8 offset:12800
    s_waitcnt lgkmcnt(9)
    v_mfma_f32_32x32x16_bf16 v[160:175], v[140:143], v[204:207], v[160:175]
    ds_read_b128 v[140:143], v5 offset:7168
    ds_read_b64_tr_b16 v[204:205], v8 offset:14336
    ds_read_b64_tr_b16 v[206:207], v8 offset:14848
    s_waitcnt lgkmcnt(9)
    v_mfma_f32_32x32x16_bf16 v[160:175], v[128:131], v[192:195], v[160:175]
    s_waitcnt lgkmcnt(0)
    s_barrier
    v_add_u32 v5, 0x18000, v26
    v_add_u32 v8, 0xc000, v29
    ds_read_b128 v[128:131], v5 offset:0
    ds_read_b64_tr_b16 v[192:193], v8 offset:0
    ds_read_b64_tr_b16 v[194:195], v8 offset:512
    v_mfma_f32_32x32x16_bf16 v[160:175], v[132:135], v[196:199], v[160:175]
    ds_read_b128 v[132:135], v5 offset:1024
    ds_read_b64_tr_b16 v[196:197], v8 offset:2048
    ds_read_b64_tr_b16 v[198:199], v8 offset:2560
    v_mfma_f32_32x32x16_bf16 v[160:175], v[136:139], v[200:203], v[160:175]
    ds_read_b128 v[136:139], v5 offset:2048
    ds_read_b64_tr_b16 v[200:201], v8 offset:4096
    ds_read_b64_tr_b16 v[202:203], v8 offset:4608
    v_mfma_f32_32x32x16_bf16 v[160:175], v[140:143], v[204:207], v[160:175]
    ds_read_b128 v[140:143], v5 offset:3072
    ds_read_b64_tr_b16 v[204:205], v8 offset:6144
    ds_read_b64_tr_b16 v[206:207], v8 offset:6656
    s_waitcnt lgkmcnt(9)
    v_mfma_f32_32x32x16_bf16 v[160:175], v[128:131], v[192:195], v[160:175]
    ds_read_b128 v[128:131], v5 offset:4096
    ds_read_b64_tr_b16 v[192:193], v8 offset:8192
    ds_read_b64_tr_b16 v[194:195], v8 offset:8704
    s_waitcnt lgkmcnt(9)
    v_mfma_f32_32x32x16_bf16 v[160:175], v[132:135], v[196:199], v[160:175]
    ds_read_b128 v[132:135], v5 offset:5120
    ds_read_b64_tr_b16 v[196:197], v8 offset:10240
    ds_read_b64_tr_b16 v[198:199], v8 offset:10752
    s_waitcnt lgkmcnt(9)
    v_mfma_f32_32x32x16_bf16 v[160:175], v[136:139], v[200:203], v[160:175]
    ds_read_b128 v[136:139], v5 offset:6144
    ds_read_b64_tr_b16 v[200:201], v8 offset:12288
    ds_read_b64_tr_b16 v[202:203], v8 offset:12800
    s_waitcnt lgkmcnt(9)
    v_mfma_f32_32x32x16_bf16 v[160:175], v[140:143], v[204:207], v[160:175]
    ds_read_b128 v[140:143], v5 offset:7168
    ds_read_b64_tr_b16 v[204:205], v8 offset:14336
    ds_read_b64_tr_b16 v[206:207], v8 offset:14848
    s_waitcnt lgkmcnt(9)
    v_mfma_f32_32x32x16_bf16 v[160:175], v[128:131], v[192:195], v[160:175]
    s_waitcnt lgkmcnt(0)
    s_barrier
    v_add_u32 v5, 0x20000, v26
    v_add_u32 v8, 0x1c000, v29
    ds_read_b128 v[128:131], v5 offset:0
    ds_read_b64_tr_b16 v[192:193], v8 offset:0
    ds_read_b64_tr_b16 v[194:195], v8 offset:512
    v_mfma_f32_32x32x16_bf16 v[160:175], v[132:135], v[196:199], v[160:175]
    ds_read_b128 v[132:135], v5 offset:1024
    ds_read_b64_tr_b16 v[196:197], v8 offset:2048
    ds_read_b64_tr_b16 v[198:199], v8 offset:2560
    v_mfma_f32_32x32x16_bf16 v[160:175], v[136:139], v[200:203], v[160:175]
    ds_read_b128 v[136:139], v5 offset:2048
    ds_read_b64_tr_b16 v[200:201], v8 offset:4096
    ds_read_b64_tr_b16 v[202:203], v8 offset:4608
    v_mfma_f32_32x32x16_bf16 v[160:175], v[140:143], v[204:207], v[160:175]
    ds_read_b128 v[140:143], v5 offset:3072
    ds_read_b64_tr_b16 v[204:205], v8 offset:6144
    ds_read_b64_tr_b16 v[206:207], v8 offset:6656
    s_waitcnt lgkmcnt(9)
    v_mfma_f32_32x32x16_bf16 v[160:175], v[128:131], v[192:195], v[160:175]
    ds_read_b128 v[128:131], v5 offset:4096
    ds_read_b64_tr_b16 v[192:193], v8 offset:8192
    ds_read_b64_tr_b16 v[194:195], v8 offset:8704
    s_waitcnt lgkmcnt(9)
    v_mfma_f32_32x32x16_bf16 v[160:175], v[132:135], v[196:199], v[160:175]
    ds_read_b128 v[132:135], v5 offset:5120
    ds_read_b64_tr_b16 v[196:197], v8 offset:10240
    ds_read_b64_tr_b16 v[198:199], v8 offset:10752
    s_waitcnt lgkmcnt(9)
    v_mfma_f32_32x32x16_bf16 v[160:175], v[136:139], v[200:203], v[160:175]
    ds_read_b128 v[136:139], v5 offset:6144
    ds_read_b64_tr_b16 v[200:201], v8 offset:12288
    ds_read_b64_tr_b16 v[202:203], v8 offset:12800
    s_waitcnt lgkmcnt(9)
    v_mfma_f32_32x32x16_bf16 v[160:175], v[140:143], v[204:207], v[160:175]
    ds_read_b128 v[140:143], v5 offset:7168
    ds_read_b64_tr_b16 v[204:205], v8 offset:14336
    ds_read_b64_tr_b16 v[206:207], v8 offset:14848
    s_waitcnt lgkmcnt(9)
    v_mfma_f32_32x32x16_bf16 v[160:175], v[128:131], v[192:195], v[160:175]
    s_waitcnt lgkmcnt(6)
    v_mfma_f32_32x32x16_bf16 v[160:175], v[132:135], v[196:199], v[160:175]
    s_waitcnt lgkmcnt(3)
    v_mfma_f32_32x32x16_bf16 v[160:175], v[136:139], v[200:203], v[160:175]
    s_waitcnt lgkmcnt(0)
    v_mfma_f32_32x32x16_bf16 v[160:175], v[140:143], v[204:207], v[160:175]
    v_add_u32 v112, 0x0, v112
    v_add_u32 v113, 0x0, v113
    s_nop 9
    v_mul_f32 v10, 0xbfb8aa3b, v160
    v_mul_f32 v11, 0xbfb8aa3b, v161
    v_mul_f32 v12, 0xbfb8aa3b, v162
    v_mul_f32 v13, 0xbfb8aa3b, v163
    v_exp_f32 v10, v10
    v_exp_f32 v11, v11
    v_exp_f32 v12, v12
    v_exp_f32 v13, v13
    v_mul_f32 v14, v160, v176
    v_mul_f32 v15, v161, v177
    v_mul_f32 v16, v162, v178
    v_mul_f32 v17, v163, v179
    v_add_f32 v10, 1.0, v10
    v_add_f32 v11, 1.0, v11
    v_add_f32 v12, 1.0, v12
    v_add_f32 v13, 1.0, v13
    v_rcp_f32 v10, v10
    v_rcp_f32 v11, v11
    v_rcp_f32 v12, v12
    v_rcp_f32 v13, v13
    v_fma_f32 v14, v14, v10, v208
    v_fma_f32 v15, v15, v11, v209
    v_fma_f32 v16, v16, v12, v210
    v_fma_f32 v17, v17, v13, v211
    ds_write_b32 v112, v14 offset:0
    ds_write_b32 v112, v15 offset:144
    ds_write_b32 v112, v16 offset:288
    ds_write_b32 v112, v17 offset:432
    v_mul_f32 v10, 0xbfb8aa3b, v164
    v_mul_f32 v11, 0xbfb8aa3b, v165
    v_mul_f32 v12, 0xbfb8aa3b, v166
    v_mul_f32 v13, 0xbfb8aa3b, v167
    v_exp_f32 v10, v10
    v_exp_f32 v11, v11
    v_exp_f32 v12, v12
    v_exp_f32 v13, v13
    v_mul_f32 v14, v164, v180
    v_mul_f32 v15, v165, v181
    v_mul_f32 v16, v166, v182
    v_mul_f32 v17, v167, v183
    v_add_f32 v10, 1.0, v10
    v_add_f32 v11, 1.0, v11
    v_add_f32 v12, 1.0, v12
    v_add_f32 v13, 1.0, v13
    v_rcp_f32 v10, v10
    v_rcp_f32 v11, v11
    v_rcp_f32 v12, v12
    v_rcp_f32 v13, v13
    v_fma_f32 v14, v14, v10, v212
    v_fma_f32 v15, v15, v11, v213
    v_fma_f32 v16, v16, v12, v214
    v_fma_f32 v17, v17, v13, v215
    ds_write_b32 v112, v14 offset:576
    ds_write_b32 v112, v15 offset:720
    ds_write_b32 v112, v16 offset:864
    ds_write_b32 v112, v17 offset:1008
    v_mul_f32 v10, 0xbfb8aa3b, v168
    v_mul_f32 v11, 0xbfb8aa3b, v169
    v_mul_f32 v12, 0xbfb8aa3b, v170
    v_mul_f32 v13, 0xbfb8aa3b, v171
    v_exp_f32 v10, v10
    v_exp_f32 v11, v11
    v_exp_f32 v12, v12
    v_exp_f32 v13, v13
    v_mul_f32 v14, v168, v184
    v_mul_f32 v15, v169, v185
    v_mul_f32 v16, v170, v186
    v_mul_f32 v17, v171, v187
    v_add_f32 v10, 1.0, v10
    v_add_f32 v11, 1.0, v11
    v_add_f32 v12, 1.0, v12
    v_add_f32 v13, 1.0, v13
    v_rcp_f32 v10, v10
    v_rcp_f32 v11, v11
    v_rcp_f32 v12, v12
    v_rcp_f32 v13, v13
    v_fma_f32 v14, v14, v10, v216
    v_fma_f32 v15, v15, v11, v217
    v_fma_f32 v16, v16, v12, v218
    v_fma_f32 v17, v17, v13, v219
    ds_write_b32 v112, v14 offset:1152
    ds_write_b32 v112, v15 offset:1296
    ds_write_b32 v112, v16 offset:1440
    ds_write_b32 v112, v17 offset:1584
    v_mul_f32 v10, 0xbfb8aa3b, v172
    v_mul_f32 v11, 0xbfb8aa3b, v173
    v_mul_f32 v12, 0xbfb8aa3b, v174
    v_mul_f32 v13, 0xbfb8aa3b, v175
    v_exp_f32 v10, v10
    v_exp_f32 v11, v11
    v_exp_f32 v12, v12
    v_exp_f32 v13, v13
    v_mul_f32 v14, v172, v188
    v_mul_f32 v15, v173, v189
    v_mul_f32 v16, v174, v190
    v_mul_f32 v17, v175, v191
    v_add_f32 v10, 1.0, v10
    v_add_f32 v11, 1.0, v11
    v_add_f32 v12, 1.0, v12
    v_add_f32 v13, 1.0, v13
    v_rcp_f32 v10, v10
    v_rcp_f32 v11, v11
    v_rcp_f32 v12, v12
    v_rcp_f32 v13, v13
    v_fma_f32 v14, v14, v10, v220
    v_fma_f32 v15, v15, v11, v221
    v_fma_f32 v16, v16, v12, v222
    v_fma_f32 v17, v17, v13, v223
    ds_write_b32 v112, v14 offset:1728
    ds_write_b32 v112, v15 offset:1872
    ds_write_b32 v112, v16 offset:2016
    ds_write_b32 v112, v17 offset:2160
    ds_read_b128 v[128:131], v113 offset:0
    ds_read_b128 v[132:135], v113 offset:1152
    ds_read_b128 v[136:139], v113 offset:2304
    ds_read_b128 v[140:143], v113 offset:3456
    s_mov_b32 s95, 0
    s_waitcnt lgkmcnt(3)
    buffer_store_dwordx4 v[128:131], v31, s[76:79], s95 offen sc0 sc1
    s_mov_b32 s95, 16384
    s_waitcnt lgkmcnt(2)
    buffer_store_dwordx4 v[132:135], v31, s[76:79], s95 offen sc0 sc1
    s_mov_b32 s95, 32768
    s_waitcnt lgkmcnt(1)
    buffer_store_dwordx4 v[136:139], v31, s[76:79], s95 offen sc0 sc1
    s_mov_b32 s95, 49152
    s_waitcnt lgkmcnt(0)
    buffer_store_dwordx4 v[140:143], v31, s[76:79], s95 offen sc0 sc1
    s_waitcnt vmcnt(0)
    s_branch L_end
L_light1:
    v_add_u32 v48, 0x0, v8
    v_add_u32 v4, 0x4000, v2
    v_add_u32 v5, 0x4000, v3
    v_xor_b32 v49, 32, v48
    v_xor_b32 v50, 64, v48
    v_xor_b32 v51, 96, v48
    s_waitcnt vmcnt(20)
    s_waitcnt vmcnt(16)
    s_barrier
    ds_read_b128 v[128:131], v48
    ds_read_b64_tr_b16 v[32:33], v4 offset:0
    ds_read_b64_tr_b16 v[34:35], v4 offset:512
    ds_read_b64_tr_b16 v[36:37], v5 offset:0
    ds_read_b64_tr_b16 v[38:39], v5 offset:512
    ds_read_b128 v[132:135], v49
    ds_read_b128 v[136:139], v50
    ds_read_b128 v[140:143], v51
    ds_read_b64_tr_b16 v[40:41], v4 offset:4096
    ds_read_b64_tr_b16 v[42:43], v4 offset:4608
    ds_read_b64_tr_b16 v[44:45], v5 offset:4096
    ds_read_b64_tr_b16 v[46:47], v5 offset:4608
    ds_read_b64_tr_b16 v[80:81], v4 offset:8192
    ds_read_b64_tr_b16 v[82:83], v4 offset:8704
    ds_read_b64_tr_b16 v[84:85], v5 offset:8192
    ds_read_b64_tr_b16 v[86:87], v5 offset:8704
    s_waitcnt lgkmcnt(13)
    v_mfma_f32_32x32x16_bf16 v[96:111], v[32:35], v[128:131], 0
    s_mov_b32 s100, 384
    s_add_u32 m0, s86, 0x18000
    s_nop 0
    buffer_load_dwordx4 v24, s[40:43], s100 offen lds
    s_waitcnt lgkmcnt(11)
    v_mfma_f32_32x32x16_bf16 v[112:127], v[36:39], v[128:131], 0
    s_add_u32 m0, s86, 0x18400
    s_nop 0
    buffer_load_dwordx4 v25, s[40:43], s100 offen lds
    ds_read_b64_tr_b16 v[32:33], v4 offset:12288
    ds_read_b64_tr_b16 v[34:35], v4 offset:12800
    ds_read_b64_tr_b16 v[36:37], v5 offset:12288
    ds_read_b64_tr_b16 v[38:39], v5 offset:12800
    s_waitcnt lgkmcnt(10)
    v_mfma_f32_32x32x16_bf16 v[96:111], v[40:43], v[132:135], v[96:111]
    s_add_u32 m0, s86, 0x18800
    s_nop 0
    buffer_load_dwordx4 v26, s[40:43], s100 offen lds
    s_waitcnt lgkmcnt(8)
    v_mfma_f32_32x32x16_bf16 v[112:127], v[44:47], v[132:135], v[112:127]
    s_add_u32 m0, s86, 0x18c00
    s_nop 0
    buffer_load_dwordx4 v27, s[40:43], s100 offen lds
    v_add_u32 v72, 0x8000, v8
    v_add_u32 v76, 0xc000, v2
    v_add_u32 v77, 0xc000, v3
    v_xor_b32 v73, 32, v72
    s_add_u32 s100, s87, 0xa8000
    s_add_u32 m0, s86, 0x1c000
    s_nop 0
    buffer_load_dwordx4 v28, s[44:47], s100 offen lds
    s_add_u32 m0, s86, 0x1c400
    s_nop 0
    buffer_load_dwordx4 v29, s[48:51], s100 offen lds
    s_add_u32 s100, s87, 0xaf000
    s_add_u32 m0, s86, 0x1c800
    s_nop 0
    buffer_load_dwordx4 v28, s[44:47], s100 offen lds
    s_add_u32 m0, s86, 0x1cc00
    s_nop 0
    buffer_load_dwordx4 v29, s[48:51], s100 offen lds
    s_mov_b32 s100, 512
    s_add_u32 m0, s86, 0x20000
    s_nop 0
    buffer_load_dwordx4 v24, s[40:43], s100 offen lds
    s_add_u32 m0, s86, 0x20400
    s_nop 0
    buffer_load_dwordx4 v25, s[40:43], s100 offen lds
    s_add_u32 m0, s86, 0x20800
    s_nop 0
    buffer_load_dwordx4 v26, s[40:43], s100 offen lds
    s_add_u32 m0, s86, 0x20c00
    s_nop 0
    buffer_load_dwordx4 v27, s[40:43], s100 offen lds
    v_xor_b32 v74, 64, v72
    v_xor_b32 v75, 96, v72
    s_waitcnt vmcnt(24)
    s_waitcnt vmcnt(20)
    s_waitcnt lgkmcnt(0)
    s_barrier
    ds_read_b128 v[144:147], v72
    ds_read_b64_tr_b16 v[40:41], v76 offset:0
    ds_read_b64_tr_b16 v[42:43], v76 offset:512
    ds_read_b64_tr_b16 v[44:45], v77 offset:0
    ds_read_b64_tr_b16 v[46:47], v77 offset:512
    ds_read_b128 v[148:151], v73
    ds_read_b128 v[152:155], v74
    ds_read_b128 v[156:159], v75
    v_mfma_f32_32x32x16_bf16 v[96:111], v[80:83], v[136:139], v[96:111]
    s_add_u32 s100, s87, 0xe0000
    s_add_u32 m0, s86, 0x0
    s_nop 0
    buffer_load_dwordx4 v28, s[44:47], s100 offen lds
    v_mfma_f32_32x32x16_bf16 v[112:127], v[84:87], v[136:139], v[112:127]
    s_add_u32 m0, s86, 0x400
    s_nop 0
    buffer_load_dwordx4 v29, s[48:51], s100 offen lds
    ds_read_b64_tr_b16 v[80:81], v76 offset:4096
    ds_read_b64_tr_b16 v[82:83], v76 offset:4608
    ds_read_b64_tr_b16 v[84:85], v77 offset:4096
    ds_read_b64_tr_b16 v[86:87], v77 offset:4608
    v_mfma_f32_32x32x16_bf16 v[96:111], v[32:35], v[140:143], v[96:111]
    s_add_u32 s100, s87, 0xe7000
    s_add_u32 m0, s86, 0x800
    s_nop 0
    buffer_load_dwordx4 v28, s[44:47], s100 offen lds
    v_mfma_f32_32x32x16_bf16 v[112:127], v[36:39], v[140:143], v[112:127]
    s_add_u32 m0, s86, 0xc00
    s_nop 0
    buffer_load_dwordx4 v29, s[48:51], s100 offen lds
    v_add_u32 v48, 0x10000, v8
    v_add_u32 v4, 0x14000, v2
    v_add_u32 v5, 0x14000, v3
    v_xor_b32 v49, 32, v48
    ds_read_b64_tr_b16 v[32:33], v76 offset:8192
    ds_read_b64_tr_b16 v[34:35], v76 offset:8704
    ds_read_b64_tr_b16 v[36:37], v77 offset:8192
    ds_read_b64_tr_b16 v[38:39], v77 offset:8704
    s_waitcnt lgkmcnt(13)
    v_mfma_f32_32x32x16_bf16 v[96:111], v[40:43], v[144:147], v[96:111]
    s_mov_b32 s100, 640
    s_add_u32 m0, s86, 0x4000
    s_nop 0
    buffer_load_dwordx4 v24, s[40:43], s100 offen lds
    v_xor_b32 v50, 64, v48
    v_xor_b32 v51, 96, v48
    s_waitcnt lgkmcnt(11)
    v_mfma_f32_32x32x16_bf16 v[112:127], v[44:47], v[144:147], v[112:127]
    s_add_u32 m0, s86, 0x4400
    s_nop 0
    buffer_load_dwordx4 v25, s[40:43], s100 offen lds
    ds_read_b64_tr_b16 v[40:41], v76 offset:12288
    ds_read_b64_tr_b16 v[42:43], v76 offset:12800
    ds_read_b64_tr_b16 v[44:45], v77 offset:12288
    ds_read_b64_tr_b16 v[46:47], v77 offset:12800
    s_waitcnt lgkmcnt(10)
    v_mfma_f32_32x32x16_bf16 v[96:111], v[80:83], v[148:151], v[96:111]
    s_add_u32 m0, s86, 0x4800
    s_nop 0
    buffer_load_dwordx4 v26, s[40:43], s100 offen lds
    s_waitcnt lgkmcnt(8)
    v_mfma_f32_32x32x16_bf16 v[112:127], v[84:87], v[148:151], v[112:127]
    s_add_u32 m0, s86, 0x4c00
    s_nop 0
    buffer_load_dwordx4 v27, s[40:43], s100 offen lds
    s_waitcnt vmcnt(24)
    s_waitcnt vmcnt(20)
    s_waitcnt lgkmcnt(0)
    s_barrier
    ds_read_b128 v[160:163], v48
    ds_read_b64_tr_b16 v[80:81], v4 offset:0
    ds_read_b64_tr_b16 v[82:83], v4 offset:512
    ds_read_b64_tr_b16 v[84:85], v5 offset:0
    ds_read_b64_tr_b16 v[86:87], v5 offset:512
    ds_read_b128 v[164:167], v49
    ds_read_b128 v[168:171], v50
    ds_read_b128 v[172:175], v51
    v_mfma_f32_32x32x16_bf16 v[96:111], v[32:35], v[152:155], v[96:111]
    s_add_u32 s100, s87, 0x118000
    s_add_u32 m0, s86, 0x8000
    s_nop 0
    buffer_load_dwordx4 v28, s[44:47], s100 offen lds
    v_mfma_f32_32x32x16_bf16 v[112:127], v[36:39], v[152:155], v[112:127]
    s_add_u32 m0, s86, 0x8400
    s_nop 0
    buffer_load_dwordx4 v29, s[48:51], s100 offen lds
    ds_read_b64_tr_b16 v[32:33], v4 offset:4096
    ds_read_b64_tr_b16 v[34:35], v4 offset:4608
    ds_read_b64_tr_b16 v[36:37], v5 offset:4096
    ds_read_b64_tr_b16 v[38:39], v5 offset:4608
    v_mfma_f32_32x32x16_bf16 v[96:111], v[40:43], v[156:159], v[96:111]
    s_add_u32 s100, s87, 0x11f000
    s_add_u32 m0, s86, 0x8800
    s_nop 0
    buffer_load_dwordx4 v28, s[44:47], s100 offen lds
    v_mfma_f32_32x32x16_bf16 v[112:127], v[44:47], v[156:159], v[112:127]
    s_add_u32 m0, s86, 0x8c00
    s_nop 0
    buffer_load_dwordx4 v29, s[48:51], s100 offen lds
    v_add_u32 v72, 0x18000, v8
    v_add_u32 v76, 0x1c000, v2
    v_add_u32 v77, 0x1c000, v3
    v_xor_b32 v73, 32, v72
    ds_read_b64_tr_b16 v[40:41], v4 offset:8192
    ds_read_b64_tr_b16 v[42:43], v4 offset:8704
    ds_read_b64_tr_b16 v[44:45], v5 offset:8192
    ds_read_b64_tr_b16 v[46:47], v5 offset:8704
    s_waitcnt lgkmcnt(13)
    v_mfma_f32_32x32x16_bf16 v[96:111], v[80:83], v[160:163], v[96:111]
    s_mov_b32 s100, 768
    s_add_u32 m0, s86, 0xc000
    s_nop 0
    buffer_load_dwordx4 v24, s[40:43], s100 offen lds
    v_xor_b32 v74, 64, v72
    v_xor_b32 v75, 96, v72
    s_waitcnt lgkmcnt(11)
    v_mfma_f32_32x32x16_bf16 v[112:127], v[84:87], v[160:163], v[112:127]
    s_add_u32 m0, s86, 0xc400
    s_nop 0
    buffer_load_dwordx4 v25, s[40:43], s100 offen lds
    ds_read_b64_tr_b16 v[80:81], v4 offset:12288
    ds_read_b64_tr_b16 v[82:83], v4 offset:12800
    ds_read_b64_tr_b16 v[84:85], v5 offset:12288
    ds_read_b64_tr_b16 v[86:87], v5 offset:12800
    s_waitcnt lgkmcnt(10)
    v_mfma_f32_32x32x16_bf16 v[96:111], v[32:35], v[164:167], v[96:111]
    s_add_u32 m0, s86, 0xc800
    s_nop 0
    buffer_load_dwordx4 v26, s[40:43], s100 offen lds
    s_waitcnt lgkmcnt(8)
    v_mfma_f32_32x32x16_bf16 v[112:127], v[36:39], v[164:167], v[112:127]
    s_add_u32 m0, s86, 0xcc00
    s_nop 0
    buffer_load_dwordx4 v27, s[40:43], s100 offen lds
    s_waitcnt vmcnt(24)
    s_waitcnt vmcnt(20)
    s_waitcnt lgkmcnt(0)
    s_barrier
    ds_read_b128 v[176:179], v72
    ds_read_b64_tr_b16 v[32:33], v76 offset:0
    ds_read_b64_tr_b16 v[34:35], v76 offset:512
    ds_read_b64_tr_b16 v[36:37], v77 offset:0
    ds_read_b64_tr_b16 v[38:39], v77 offset:512
    ds_read_b128 v[180:183], v73
    ds_read_b128 v[184:187], v74
    ds_read_b128 v[188:191], v75
    v_mfma_f32_32x32x16_bf16 v[96:111], v[40:43], v[168:171], v[96:111]
    s_add_u32 s100, s87, 0x150000
    s_add_u32 m0, s86, 0x10000
    s_nop 0
    buffer_load_dwordx4 v28, s[44:47], s100 offen lds
    v_mfma_f32_32x32x16_bf16 v[112:127], v[44:47], v[168:171], v[112:127]
    s_add_u32 m0, s86, 0x10400
    s_nop 0
    buffer_load_dwordx4 v29, s[48:51], s100 offen lds
    ds_read_b64_tr_b16 v[40:41], v76 offset:4096
    ds_read_b64_tr_b16 v[42:43], v76 offset:4608
    ds_read_b64_tr_b16 v[44:45], v77 offset:4096
    ds_read_b64_tr_b16 v[46:47], v77 offset:4608
    v_mfma_f32_32x32x16_bf16 v[96:111], v[80:83], v[172:175], v[96:111]
    s_add_u32 s100, s87, 0x157000
    s_add_u32 m0, s86, 0x10800
    s_nop 0
    buffer_load_dwordx4 v28, s[44:47], s100 offen lds
    v_mfma_f32_32x32x16_bf16 v[112:127], v[84:87], v[172:175], v[112:127]
    s_add_u32 m0, s86, 0x10c00
    s_nop 0
    buffer_load_dwordx4 v29, s[48:51], s100 offen lds
    v_add_u32 v48, 0x20000, v8
    v_add_u32 v4, 0x0, v2
    v_add_u32 v5, 0x0, v3
    v_xor_b32 v49, 32, v48
    ds_read_b64_tr_b16 v[80:81], v76 offset:8192
    ds_read_b64_tr_b16 v[82:83], v76 offset:8704
    ds_read_b64_tr_b16 v[84:85], v77 offset:8192
    ds_read_b64_tr_b16 v[86:87], v77 offset:8704
    s_waitcnt lgkmcnt(13)
    v_mfma_f32_32x32x16_bf16 v[96:111], v[32:35], v[176:179], v[96:111]
    s_mov_b32 s100, 896
    s_add_u32 m0, s86, 0x14000
    s_nop 0
    buffer_load_dwordx4 v24, s[40:43], s100 offen lds
    v_xor_b32 v50, 64, v48
    v_xor_b32 v51, 96, v48
    s_waitcnt lgkmcnt(11)
    v_mfma_f32_32x32x16_bf16 v[112:127], v[36:39], v[176:179], v[112:127]
    s_add_u32 m0, s86, 0x14400
    s_nop 0
    buffer_load_dwordx4 v25, s[40:43], s100 offen lds
    ds_read_b64_tr_b16 v[32:33], v76 offset:12288
    ds_read_b64_tr_b16 v[34:35], v76 offset:12800
    ds_read_b64_tr_b16 v[36:37], v77 offset:12288
    ds_read_b64_tr_b16 v[38:39], v77 offset:12800
    s_waitcnt lgkmcnt(10)
    v_mfma_f32_32x32x16_bf16 v[96:111], v[40:43], v[180:183], v[96:111]
    s_add_u32 m0, s86, 0x14800
    s_nop 0
    buffer_load_dwordx4 v26, s[40:43], s100 offen lds
    s_waitcnt lgkmcnt(8)
    v_mfma_f32_32x32x16_bf16 v[112:127], v[44:47], v[180:183], v[112:127]
    s_add_u32 m0, s86, 0x14c00
    s_nop 0
    buffer_load_dwordx4 v27, s[40:43], s100 offen lds
    s_waitcnt vmcnt(24)
    s_waitcnt vmcnt(20)
    s_waitcnt lgkmcnt(0)
    s_barrier
    ds_read_b128 v[192:195], v48
    ds_read_b64_tr_b16 v[40:41], v4 offset:0
    ds_read_b64_tr_b16 v[42:43], v4 offset:512
    ds_read_b64_tr_b16 v[44:45], v5 offset:0
    ds_read_b64_tr_b16 v[46:47], v5 offset:512
    ds_read_b128 v[196:199], v49
    ds_read_b128 v[200:203], v50
    ds_read_b128 v[204:207], v51
    v_mfma_f32_32x32x16_bf16 v[96:111], v[80:83], v[184:187], v[96:111]
    s_add_u32 s100, s87, 0x188000
    s_add_u32 m0, s86, 0x18000
    s_nop 0
    buffer_load_dwordx4 v28, s[44:47], s100 offen lds
    v_mfma_f32_32x32x16_bf16 v[112:127], v[84:87], v[184:187], v[112:127]
    s_add_u32 m0, s86, 0x18400
    s_nop 0
    buffer_load_dwordx4 v29, s[48:51], s100 offen lds
    ds_read_b64_tr_b16 v[80:81], v4 offset:4096
    ds_read_b64_tr_b16 v[82:83], v4 offset:4608
    ds_read_b64_tr_b16 v[84:85], v5 offset:4096
    ds_read_b64_tr_b16 v[86:87], v5 offset:4608
    v_mfma_f32_32x32x16_bf16 v[96:111], v[32:35], v[188:191], v[96:111]
    s_add_u32 s100, s87, 0x18f000
    s_add_u32 m0, s86, 0x18800
    s_nop 0
    buffer_load_dwordx4 v28, s[44:47], s100 offen lds
    v_mfma_f32_32x32x16_bf16 v[112:127], v[36:39], v[188:191], v[112:127]
    s_add_u32 m0, s86, 0x18c00
    s_nop 0
    buffer_load_dwordx4 v29, s[48:51], s100 offen lds
    v_add_u32 v72, 0x4000, v8
    v_add_u32 v76, 0x8000, v2
    v_add_u32 v77, 0x8000, v3
    v_xor_b32 v73, 32, v72
    ds_read_b64_tr_b16 v[32:33], v4 offset:8192
    ds_read_b64_tr_b16 v[34:35], v4 offset:8704
    ds_read_b64_tr_b16 v[36:37], v5 offset:8192
    ds_read_b64_tr_b16 v[38:39], v5 offset:8704
    s_waitcnt lgkmcnt(13)
    v_mfma_f32_32x32x16_bf16 v[96:111], v[40:43], v[192:195], v[96:111]
    s_add_u32 s100, s85, 0x0
    s_add_u32 m0, s84, 0x1c000
    s_nop 0
    buffer_load_dwordx4 v30, s[52:55], s100 offen lds
    v_xor_b32 v74, 64, v72
    v_xor_b32 v75, 96, v72
    s_lshr_b32 s4, s92, 1
    s_mul_i32 s4, s4, 0x2c000
    s_and_b32 s5, s92, 1
    s_lshl_b32 s5, s5, 12
    s_add_u32 s4, s4, s5
    v_lshlrev_b32 v24, 4, v0
    s_waitcnt lgkmcnt(11)
    v_mfma_f32_32x32x16_bf16 v[112:127], v[44:47], v[192:195], v[112:127]
    s_add_u32 m0, s84, 0x1e000
    s_nop 0
    buffer_load_dwordx4 v30, s[56:59], s100 offen lds
    v_add_u32 v24, s4, v24
    v_lshrrev_b32 v10, 3, v0
    s_lshl_b32 s4, s92, 5
    v_add_u32 v10, s4, v10
    ds_read_b64_tr_b16 v[40:41], v4 offset:12288
    ds_read_b64_tr_b16 v[42:43], v4 offset:12800
    ds_read_b64_tr_b16 v[44:45], v5 offset:12288
    ds_read_b64_tr_b16 v[46:47], v5 offset:12800
    s_waitcnt lgkmcnt(10)
    v_mfma_f32_32x32x16_bf16 v[96:111], v[80:83], v[196:199], v[96:111]
    s_add_u32 m0, s84, 0x1c400
    s_nop 0
    buffer_load_dwordx4 v31, s[52:55], s100 offen lds
    v_lshlrev_b32 v10, 10, v10
    v_bfe_u32 v11, v0, 4, 1
    v_lshlrev_b32 v11, 2, v11
    v_and_b32 v12, 7, v0
    s_waitcnt lgkmcnt(8)
    v_mfma_f32_32x32x16_bf16 v[112:127], v[84:87], v[196:199], v[112:127]
    s_add_u32 m0, s84, 0x1e400
    s_nop 0
    buffer_load_dwordx4 v31, s[56:59], s100 offen lds
    v_xor_b32 v11, v11, v12
    v_lshl_add_u32 v25, v11, 4, v10
    s_lshl_b32 s4, s91, 7
    v_add_u32 v25, s4, v25
    v_lshrrev_b32 v10, 3, v0
    s_waitcnt vmcnt(24)
    s_waitcnt vmcnt(20)
    s_waitcnt lgkmcnt(0)
    s_barrier
    ds_read_b128 v[208:211], v72
    ds_read_b64_tr_b16 v[80:81], v76 offset:0
    ds_read_b64_tr_b16 v[82:83], v76 offset:512
    ds_read_b64_tr_b16 v[84:85], v77 offset:0
    ds_read_b64_tr_b16 v[86:87], v77 offset:512
    ds_read_b128 v[212:215], v73
    ds_read_b128 v[216:219], v74
    ds_read_b128 v[220:223], v75
    v_mfma_f32_32x32x16_bf16 v[96:111], v[32:35], v[200:203], v[96:111]
    s_add_u32 s100, s85, 0x4000
    s_add_u32 m0, s84, 0x20000
    s_nop 0
    buffer_load_dwordx4 v30, s[52:55], s100 offen lds
    v_mfma_f32_32x32x16_bf16 v[112:127], v[36:39], v[200:203], v[112:127]
    s_add_u32 m0, s84, 0x22000
    s_nop 0
    buffer_load_dwordx4 v30, s[56:59], s100 offen lds
    ds_read_b64_tr_b16 v[32:33], v76 offset:4096
    ds_read_b64_tr_b16 v[34:35], v76 offset:4608
    ds_read_b64_tr_b16 v[36:37], v77 offset:4096
    ds_read_b64_tr_b16 v[38:39], v77 offset:4608
    v_mfma_f32_32x32x16_bf16 v[96:111], v[40:43], v[204:207], v[96:111]
    s_add_u32 m0, s84, 0x20400
    s_nop 0
    buffer_load_dwordx4 v31, s[52:55], s100 offen lds
    v_mfma_f32_32x32x16_bf16 v[112:127], v[44:47], v[204:207], v[112:127]
    s_add_u32 m0, s84, 0x22400
    s_nop 0
    buffer_load_dwordx4 v31, s[56:59], s100 offen lds
    v_add_u32 v48, 0xc000, v8
    v_add_u32 v4, 0x10000, v2
    v_add_u32 v5, 0x10000, v3
    v_xor_b32 v49, 32, v48
    ds_read_b64_tr_b16 v[40:41], v76 offset:8192
    ds_read_b64_tr_b16 v[42:43], v76 offset:8704
    ds_read_b64_tr_b16 v[44:45], v77 offset:8192
    ds_read_b64_tr_b16 v[46:47], v77 offset:8704
    s_waitcnt lgkmcnt(13)
    v_mfma_f32_32x32x16_bf16 v[96:111], v[80:83], v[208:211], v[96:111]
    s_add_u32 s100, s85, 0x200
    s_add_u32 m0, s84, 0x0
    s_nop 0
    buffer_load_dwordx4 v30, s[52:55], s100 offen lds
    v_xor_b32 v50, 64, v48
    v_xor_b32 v51, 96, v48
    s_lshl_b32 s4, s92, 4
    s_lshl_b32 s5, s91, 6
    s_add_u32 s4, s4, s5
    s_add_u32 s4, s4, 0
    v_add_u32 v10, s4, v10
    s_waitcnt lgkmcnt(11)
    v_mfma_f32_32x32x16_bf16 v[112:127], v[84:87], v[208:211], v[112:127]
    s_add_u32 m0, s84, 0x2000
    s_nop 0
    buffer_load_dwordx4 v30, s[56:59], s100 offen lds
    v_lshlrev_b32 v10, 10, v10
    v_lshrrev_b32 v11, 4, v0
    v_and_b32 v12, 7, v0
    v_xor_b32 v11, v11, v12
    ds_read_b64_tr_b16 v[80:81], v76 offset:12288
    ds_read_b64_tr_b16 v[82:83], v76 offset:12800
    ds_read_b64_tr_b16 v[84:85], v77 offset:12288
    ds_read_b64_tr_b16 v[86:87], v77 offset:12800
    s_waitcnt lgkmcnt(10)
    v_mfma_f32_32x32x16_bf16 v[96:111], v[32:35], v[212:215], v[96:111]
    s_add_u32 m0, s84, 0x400
    s_nop 0
    buffer_load_dwordx4 v31, s[52:55], s100 offen lds
    v_lshl_add_u32 v26, v11, 4, v10
    v_lshrrev_b32 v10, 3, v0
    s_lshl_b32 s4, s92, 4
    s_lshl_b32 s5, s91, 6
    s_add_u32 s4, s4, s5
    s_add_u32 s4, s4, 8
    s_waitcnt lgkmcnt(8)
    v_mfma_f32_32x32x16_bf16 v[112:127], v[36:39], v[212:215], v[112:127]
    s_add_u32 m0, s84, 0x2400
    s_nop 0
    buffer_load_dwordx4 v31, s[56:59], s100 offen lds
    v_add_u32 v10, s4, v10
    v_lshlrev_b32 v10, 10, v10
    v_lshrrev_b32 v11, 4, v0
    v_xor_b32 v11, 4, v11
    s_waitcnt vmcnt(24)
    s_waitcnt vmcnt(20)
    s_waitcnt lgkmcnt(0)
    s_barrier
    v_and_b32 v12, 7, v0
    v_xor_b32 v11, v11, v12
    v_lshl_add_u32 v27, v11, 4, v10
    ds_read_b128 v[224:227], v48
    ds_read_b64_tr_b16 v[32:33], v4 offset:0
    ds_read_b64_tr_b16 v[34:35], v4 offset:512
    ds_read_b64_tr_b16 v[36:37], v5 offset:0
    ds_read_b64_tr_b16 v[38:39], v5 offset:512
    ds_read_b128 v[228:231], v49
    ds_read_b128 v[232:235], v50
    ds_read_b128 v[236:239], v51
    v_mfma_f32_32x32x16_bf16 v[96:111], v[40:43], v[216:219], v[96:111]
    s_add_u32 s100, s85, 0x4200
    s_add_u32 m0, s84, 0x4000
    s_nop 0
    buffer_load_dwordx4 v30, s[52:55], s100 offen lds
    v_mfma_f32_32x32x16_bf16 v[112:127], v[44:47], v[216:219], v[112:127]
    s_add_u32 m0, s84, 0x6000
    s_nop 0
    buffer_load_dwordx4 v30, s[56:59], s100 offen lds
    ds_read_b64_tr_b16 v[40:41], v4 offset:4096
    ds_read_b64_tr_b16 v[42:43], v4 offset:4608
    ds_read_b64_tr_b16 v[44:45], v5 offset:4096
    ds_read_b64_tr_b16 v[46:47], v5 offset:4608
    v_mfma_f32_32x32x16_bf16 v[96:111], v[80:83], v[220:223], v[96:111]
    s_add_u32 m0, s84, 0x4400
    s_nop 0
    buffer_load_dwordx4 v31, s[52:55], s100 offen lds
    v_mfma_f32_32x32x16_bf16 v[112:127], v[84:87], v[220:223], v[112:127]
    s_add_u32 m0, s84, 0x6400
    s_nop 0
    buffer_load_dwordx4 v31, s[56:59], s100 offen lds
    v_add_u32 v72, 0x14000, v8
    v_add_u32 v76, 0x18000, v2
    v_add_u32 v77, 0x18000, v3
    v_xor_b32 v73, 32, v72
    ds_read_b64_tr_b16 v[80:81], v4 offset:8192
    ds_read_b64_tr_b16 v[82:83], v4 offset:8704
    ds_read_b64_tr_b16 v[84:85], v5 offset:8192
    ds_read_b64_tr_b16 v[86:87], v5 offset:8704
    s_waitcnt lgkmcnt(13)
    v_mfma_f32_32x32x16_bf16 v[96:111], v[32:35], v[224:227], v[96:111]
    s_mov_b32 s100, 0x0
    s_add_u32 m0, s86, 0x8000
    s_nop 0
    buffer_load_dwordx4 v25, s[64:67], s100 offen lds
    v_xor_b32 v74, 64, v72
    v_xor_b32 v75, 96, v72
    v_mov_b32 v15, 0x27b00
    ds_read_b32 v16, v15
    s_waitcnt lgkmcnt(0)
    v_readfirstlane_b32 s26, v16
    v_mfma_f32_32x32x16_bf16 v[112:127], v[36:39], v[224:227], v[112:127]
    s_mov_b32 s100, 0x2000
    s_add_u32 m0, s86, 0x8400
    s_nop 0
    buffer_load_dwordx4 v25, s[64:67], s100 offen lds
    ds_read_b64_tr_b16 v[32:33], v4 offset:12288
    ds_read_b64_tr_b16 v[34:35], v4 offset:12800
    ds_read_b64_tr_b16 v[36:37], v5 offset:12288
    ds_read_b64_tr_b16 v[38:39], v5 offset:12800
    v_mfma_f32_32x32x16_bf16 v[96:111], v[40:43], v[228:231], v[96:111]
    s_mov_b32 s100, 0x4000
    s_add_u32 m0, s86, 0x8800
    s_nop 0
    buffer_load_dwordx4 v25, s[64:67], s100 offen lds
    v_mfma_f32_32x32x16_bf16 v[112:127], v[44:47], v[228:231], v[112:127]
    s_mov_b32 s100, 0x6000
    s_add_u32 m0, s86, 0x8c00
    s_nop 0
    buffer_load_dwordx4 v25, s[64:67], s100 offen lds
    s_waitcnt vmcnt(24)
    s_waitcnt vmcnt(20)
    s_waitcnt lgkmcnt(0)
    s_barrier
    ds_read_b128 v[240:243], v72
    ds_read_b64_tr_b16 v[40:41], v76 offset:0
    ds_read_b64_tr_b16 v[42:43], v76 offset:512
    ds_read_b64_tr_b16 v[44:45], v77 offset:0
    ds_read_b64_tr_b16 v[46:47], v77 offset:512
    ds_read_b128 v[244:247], v73
    ds_read_b128 v[248:251], v74
    ds_read_b128 v[252:255], v75
    v_mfma_f32_32x32x16_bf16 v[96:111], v[80:83], v[232:235], v[96:111]
    s_mov_b32 s100, 0x20000
    s_add_u32 m0, s86, 0xc000
    s_nop 0
    buffer_load_dwordx4 v25, s[64:67], s100 offen lds
    v_mfma_f32_32x32x16_bf16 v[112:127], v[84:87], v[232:235], v[112:127]
    s_mov_b32 s100, 0x22000
    s_add_u32 m0, s86, 0xc400
    s_nop 0
    buffer_load_dwordx4 v25, s[64:67], s100 offen lds
    ds_read_b64_tr_b16 v[80:81], v76 offset:4096
    ds_read_b64_tr_b16 v[82:83], v76 offset:4608
    ds_read_b64_tr_b16 v[84:85], v77 offset:4096
    ds_read_b64_tr_b16 v[86:87], v77 offset:4608
    v_mfma_f32_32x32x16_bf16 v[96:111], v[32:35], v[236:239], v[96:111]
    s_mov_b32 s100, 0x24000
    s_add_u32 m0, s86, 0xc800
    s_nop 0
    buffer_load_dwordx4 v25, s[64:67], s100 offen lds
    v_mfma_f32_32x32x16_bf16 v[112:127], v[36:39], v[236:239], v[112:127]
    s_mov_b32 s100, 0x26000
    s_add_u32 m0, s86, 0xcc00
    s_nop 0
    buffer_load_dwordx4 v25, s[64:67], s100 offen lds
    ds_read_b64_tr_b16 v[32:33], v76 offset:8192
    ds_read_b64_tr_b16 v[34:35], v76 offset:8704
    ds_read_b64_tr_b16 v[36:37], v77 offset:8192
    ds_read_b64_tr_b16 v[38:39], v77 offset:8704
    s_waitcnt lgkmcnt(13)
    v_mfma_f32_32x32x16_bf16 v[96:111], v[40:43], v[240:243], v[96:111]
    s_waitcnt lgkmcnt(11)
    v_mfma_f32_32x32x16_bf16 v[112:127], v[44:47], v[240:243], v[112:127]
    ds_read_b64_tr_b16 v[40:41], v76 offset:12288
    ds_read_b64_tr_b16 v[42:43], v76 offset:12800
    ds_read_b64_tr_b16 v[44:45], v77 offset:12288
    ds_read_b64_tr_b16 v[46:47], v77 offset:12800
    s_waitcnt lgkmcnt(10)
    v_mfma_f32_32x32x16_bf16 v[96:111], v[80:83], v[244:247], v[96:111]
    s_waitcnt lgkmcnt(8)
    v_mfma_f32_32x32x16_bf16 v[112:127], v[84:87], v[244:247], v[112:127]
    s_waitcnt lgkmcnt(6)
    v_mfma_f32_32x32x16_bf16 v[96:111], v[32:35], v[248:251], v[96:111]
    s_waitcnt lgkmcnt(4)
    v_mfma_f32_32x32x16_bf16 v[112:127], v[36:39], v[248:251], v[112:127]
    s_waitcnt lgkmcnt(2)
    v_mfma_f32_32x32x16_bf16 v[96:111], v[40:43], v[252:255], v[96:111]
    s_waitcnt lgkmcnt(0)
    v_mfma_f32_32x32x16_bf16 v[112:127], v[44:47], v[252:255], v[112:127]
    s_waitcnt vmcnt(20)
    s_waitcnt vmcnt(16)
    s_barrier
    s_mov_b32 s7, 0x20000
    v_and_b32 v49, 31, v0
    v_lshrrev_b32 v50, 5, v0
    v_and_b32 v51, 15, v0
    v_xor_b32 v50, v50, v51
    v_lshlrev_b32 v50, 4, v50
    v_lshl_add_u32 v8, v49, 9, v50
    v_add_u32 v48, s7, v8
    v_xor_b32 v49, 0, v48
    ds_read_b128 v[32:35], v49
    v_xor_b32 v50, 32, v48
    ds_read_b128 v[36:39], v50
    v_xor_b32 v49, 64, v48
    ds_read_b128 v[40:43], v49
    v_xor_b32 v50, 96, v48
    ds_read_b128 v[44:47], v50
    s_waitcnt lgkmcnt(3)
    v_mfma_f32_32x32x16_bf16 v[80:95], v[128:131], v[32:35], 0
    s_mov_b32 s100, 0x40000
    s_add_u32 m0, s86, 0x10000
    s_nop 0
    buffer_load_dwordx4 v25, s[64:67], s100 offen lds
    v_xor_b32 v49, 128, v48
    ds_read_b128 v[32:35], v49
    s_waitcnt lgkmcnt(3)
    v_mfma_f32_32x32x16_bf16 v[80:95], v[132:135], v[36:39], v[80:95]
    s_mov_b32 s100, 0x42000
    s_add_u32 m0, s86, 0x10400
    s_nop 0
    buffer_load_dwordx4 v25, s[64:67], s100 offen lds
    v_xor_b32 v50, 160, v48
    ds_read_b128 v[36:39], v50
    s_waitcnt lgkmcnt(3)
    v_mfma_f32_32x32x16_bf16 v[80:95], v[136:139], v[40:43], v[80:95]
    s_mov_b32 s100, 0x44000
    s_add_u32 m0, s86, 0x10800
    s_nop 0
    buffer_load_dwordx4 v25, s[64:67], s100 offen lds
    v_xor_b32 v49, 192, v48
    ds_read_b128 v[40:43], v49
    s_waitcnt lgkmcnt(3)
    v_mfma_f32_32x32x16_bf16 v[80:95], v[140:143], v[44:47], v[80:95]
    s_mov_b32 s100, 0x46000
    s_add_u32 m0, s86, 0x10c00
    s_nop 0
    buffer_load_dwordx4 v25, s[64:67], s100 offen lds
    v_lshlrev_b32 v9, 4, v0
    v_add_u32 v9, s86, v9
    v_lshrrev_b32 v10, 3, v0
    s_lshl_b32 s4, s90, 6
    s_lshl_b32 s5, s92, 4
    s_add_u32 s4, s4, s5
    v_add_u32 v10, s4, v10
    v_xor_b32 v50, 224, v48
    ds_read_b128 v[44:47], v50
    s_waitcnt lgkmcnt(3)
    v_mfma_f32_32x32x16_bf16 v[80:95], v[144:147], v[32:35], v[80:95]
    v_lshlrev_b32 v10, 10, v10
    v_and_b32 v11, 7, v0
    v_lshl_add_u32 v10, v11, 4, v10
    s_lshl_b32 s4, s91, 7
    v_add_u32 v30, s4, v10
    s_lshl_b32 s6, s93, 9
    s_add_u32 s6, s6, 0x24000
    v_and_b32 v18, 31, v0
    v_lshlrev_b32 v18, 3, v18
    v_add_u32 v18, s6, v18
    ds_read_b64 v[56:57], v18
    v_mov_b32 v58, 0
    v_mov_b32 v59, 0
    v_xor_b32 v49, 256, v48
    ds_read_b128 v[32:35], v49
    s_waitcnt lgkmcnt(4)
    v_mfma_f32_32x32x16_bf16 v[80:95], v[148:151], v[36:39], v[80:95]
    v_xor_b32 v50, 288, v48
    ds_read_b128 v[36:39], v50
    s_waitcnt lgkmcnt(4)
    v_mfma_f32_32x32x16_bf16 v[80:95], v[152:155], v[40:43], v[80:95]
    s_lshl_b32 s6, s93, 9
    s_add_u32 s6, s6, 0x24100
    v_and_b32 v18, 31, v0
    v_lshlrev_b32 v18, 3, v18
    v_add_u32 v18, s6, v18
    ds_read_b64 v[60:61], v18
    v_mov_b32 v62, 0
    v_mov_b32 v63, 0
    v_xor_b32 v49, 320, v48
    ds_read_b128 v[40:43], v49
    s_waitcnt lgkmcnt(5)
    v_mfma_f32_32x32x16_bf16 v[80:95], v[156:159], v[44:47], v[80:95]
    v_bfe_u32 v10, v0, 2, 1
    v_lshlrev_b32 v10, 4, v10
    v_bfe_u32 v11, v0, 3, 2
    v_xor_b32 v50, 352, v48
    ds_read_b128 v[44:47], v50
    s_waitcnt lgkmcnt(4)
    v_mfma_f32_32x32x16_bf16 v[80:95], v[160:163], v[32:35], v[80:95]
    v_lshl_add_u32 v10, v11, 2, v10
    v_and_b32 v11, 3, v0
    v_add_u32 v10, v10, v11
    s_lshl_b32 s4, s92, 5
    v_add_u32 v10, s4, v10
    v_lshlrev_b32 v10, 2, v10
    v_xor_b32 v49, 384, v48
    ds_read_b128 v[32:35], v49
    s_waitcnt lgkmcnt(4)
    v_mfma_f32_32x32x16_bf16 v[80:95], v[164:167], v[36:39], v[80:95]
    v_add_u32 v10, 0x24a00, v10
    ds_read_b32 v11, v10
    ds_read_b32 v12, v10 offset:512
    v_cmp_gt_u32 vcc, 32, v0
    v_mov_b32 v22, 0
    v_mov_b32 v23, 0
    v_xor_b32 v50, 416, v48
    ds_read_b128 v[36:39], v50
    s_waitcnt lgkmcnt(5)
    v_mfma_f32_32x32x16_bf16 v[80:95], v[168:171], v[40:43], v[80:95]
    s_waitcnt lgkmcnt(2)
    v_sub_f32 v11, 0, v11
    v_cvt_pk_bf16_f32 v20, v11, v11
    s_waitcnt lgkmcnt(1)
    v_mul_f32 v6, 0xbfb8aa3b, v12
    v_mul_f32 v7, v12, v12
    v_and_b32 v13, 0xffff0000, v20
    v_xor_b32 v49, 448, v48
    ds_read_b128 v[40:43], v49
    v_mfma_f32_32x32x16_bf16 v[80:95], v[172:175], v[44:47], v[80:95]
    v_sub_f32 v13, v11, v13
    v_rcp_f32 v7, v7
    v_cvt_pk_bf16_f32 v21, v13, 0
    v_cndmask_b32 v20, 0, v20, vcc
    v_xor_b32 v50, 480, v48
    ds_read_b128 v[44:47], v50
    v_mfma_f32_32x32x16_bf16 v[80:95], v[176:179], v[32:35], v[80:95]
    v_cndmask_b32 v21, 0, v21, vcc
    s_nop 1
    v_mfma_f32_32x32x16_bf16 v[96:111], v[56:59], v[20:23], v[96:111]
    v_mfma_f32_32x32x16_bf16 v[112:127], v[60:63], v[20:23], v[112:127]
    s_waitcnt vmcnt(16)
    s_waitcnt vmcnt(12)
    s_waitcnt lgkmcnt(0)
    s_barrier
    s_mov_b32 s7, 0x4000
    v_add_u32 v48, s7, v8
    v_xor_b32 v49, 0, v48
    ds_read_b128 v[32:35], v49
    v_mfma_f32_32x32x16_bf16 v[80:95], v[180:183], v[36:39], v[80:95]
    s_mov_b32 s100, 0x60000
    s_add_u32 m0, s86, 0x14000
    s_nop 0
    buffer_load_dwordx4 v25, s[64:67], s100 offen lds
    v_xor_b32 v50, 32, v48
    ds_read_b128 v[36:39], v50
    v_mfma_f32_32x32x16_bf16 v[80:95], v[184:187], v[40:43], v[80:95]
    s_mov_b32 s100, 0x62000
    s_add_u32 m0, s86, 0x14400
    s_nop 0
    buffer_load_dwordx4 v25, s[64:67], s100 offen lds
    v_xor_b32 v49, 64, v48
    ds_read_b128 v[40:43], v49
    v_mfma_f32_32x32x16_bf16 v[80:95], v[188:191], v[44:47], v[80:95]
    s_mov_b32 s100, 0x64000
    s_add_u32 m0, s86, 0x14800
    s_nop 0
    buffer_load_dwordx4 v25, s[64:67], s100 offen lds
    v_xor_b32 v50, 96, v48
    ds_read_b128 v[44:47], v50
    s_waitcnt lgkmcnt(3)
    v_mfma_f32_32x32x16_bf16 v[80:95], v[192:195], v[32:35], v[80:95]
    s_mov_b32 s100, 0x66000
    s_add_u32 m0, s86, 0x14c00
    s_nop 0
    buffer_load_dwordx4 v25, s[64:67], s100 offen lds
    s_lshl_b32 s6, s93, 8
    s_add_u32 s6, s6, 0x24800
    v_and_b32 v18, 31, v0
    v_lshlrev_b32 v18, 3, v18
    v_add_u32 v18, s6, v18
    ds_read_b64 v[64:65], v18
    v_mov_b32 v66, 0
    v_mov_b32 v67, 0
    v_xor_b32 v49, 128, v48
    ds_read_b128 v[32:35], v49
    s_waitcnt lgkmcnt(4)
    v_mfma_f32_32x32x16_bf16 v[80:95], v[196:199], v[36:39], v[80:95]
    s_lshl_b32 s4, s89, 2
    s_lshl_b32 s5, s93, 1
    s_add_u32 s4, s4, s5
    s_add_u32 s4, s4, 0
    s_lshl_b32 s4, s4, 10
    s_mul_i32 s5, s88, 0xb0000
    s_add_u32 s4, s4, s5
    s_add_u32 s9, s4, 0x200000
    v_mul_f32 v10, v6, v96
    v_xor_b32 v50, 160, v48
    ds_read_b128 v[36:39], v50
    s_waitcnt lgkmcnt(4)
    v_mfma_f32_32x32x16_bf16 v[80:95], v[200:203], v[40:43], v[80:95]
    v_mul_f32 v11, v6, v97
    v_mul_f32 v12, v6, v98
    v_mul_f32 v13, v6, v99
    v_exp_f32 v10, v10
    v_xor_b32 v49, 192, v48
    ds_read_b128 v[40:43], v49
    s_waitcnt lgkmcnt(4)
    v_mfma_f32_32x32x16_bf16 v[80:95], v[204:207], v[44:47], v[80:95]
    v_exp_f32 v11, v11
    v_exp_f32 v12, v12
    v_exp_f32 v13, v13
    v_xor_b32 v50, 224, v48
    ds_read_b128 v[44:47], v50
    s_waitcnt lgkmcnt(3)
    v_mfma_f32_32x32x16_bf16 v[80:95], v[208:211], v[32:35], v[80:95]
    v_mul_f32 v14, v96, v104
    v_mul_f32 v15, v97, v105
    v_mul_f32 v16, v98, v106
    v_mul_f32 v17, v99, v107
    v_xor_b32 v49, 256, v48
    ds_read_b128 v[32:35], v49
    s_waitcnt lgkmcnt(3)
    v_mfma_f32_32x32x16_bf16 v[80:95], v[212:215], v[36:39], v[80:95]
    v_fma_f32 v10, v10, v7, v7
    v_fma_f32 v11, v11, v7, v7
    v_fma_f32 v12, v12, v7, v7
    v_fma_f32 v13, v13, v7, v7
    v_rcp_f32 v10, v10
    v_xor_b32 v50, 288, v48
    ds_read_b128 v[36:39], v50
    s_waitcnt lgkmcnt(3)
    v_mfma_f32_32x32x16_bf16 v[80:95], v[216:219], v[40:43], v[80:95]
    v_rcp_f32 v11, v11
    v_rcp_f32 v12, v12
    v_xor_b32 v49, 320, v48
    ds_read_b128 v[40:43], v49
    s_waitcnt lgkmcnt(3)
    v_mfma_f32_32x32x16_bf16 v[80:95], v[220:223], v[44:47], v[80:95]
    v_rcp_f32 v13, v13
    v_mul_f32 v14, v14, v10
    v_mul_f32 v15, v15, v11
    v_mul_f32 v16, v16, v12
    v_xor_b32 v50, 352, v48
    ds_read_b128 v[44:47], v50
    s_waitcnt lgkmcnt(3)
    v_mfma_f32_32x32x16_bf16 v[80:95], v[224:227], v[32:35], v[80:95]
    v_mul_f32 v17, v17, v13
    v_cvt_pk_bf16_f32 v96, v14, v15
    v_cvt_pk_bf16_f32 v97, v16, v17
    v_mul_f32 v10, v6, v100
    v_mul_f32 v11, v6, v101
    v_xor_b32 v49, 384, v48
    ds_read_b128 v[32:35], v49
    s_waitcnt lgkmcnt(3)
    v_mfma_f32_32x32x16_bf16 v[80:95], v[228:231], v[36:39], v[80:95]
    v_mul_f32 v12, v6, v102
    v_mul_f32 v13, v6, v103
    v_exp_f32 v10, v10
    v_exp_f32 v11, v11
    v_xor_b32 v50, 416, v48
    ds_read_b128 v[36:39], v50
    s_waitcnt lgkmcnt(3)
    v_mfma_f32_32x32x16_bf16 v[80:95], v[232:235], v[40:43], v[80:95]
    v_exp_f32 v12, v12
    v_exp_f32 v13, v13
    v_xor_b32 v49, 448, v48
    ds_read_b128 v[40:43], v49
    s_waitcnt lgkmcnt(3)
    v_mfma_f32_32x32x16_bf16 v[80:95], v[236:239], v[44:47], v[80:95]
    v_mul_f32 v14, v100, v108
    v_mul_f32 v15, v101, v109
    v_mul_f32 v16, v102, v110
    v_mul_f32 v17, v103, v111
    v_fma_f32 v10, v10, v7, v7
    v_xor_b32 v50, 480, v48
    ds_read_b128 v[44:47], v50
    s_waitcnt lgkmcnt(3)
    v_mfma_f32_32x32x16_bf16 v[80:95], v[240:243], v[32:35], v[80:95]
    v_fma_f32 v11, v11, v7, v7
    v_fma_f32 v12, v12, v7, v7
    v_fma_f32 v13, v13, v7, v7
    v_rcp_f32 v10, v10
    s_waitcnt lgkmcnt(2)
    v_mfma_f32_32x32x16_bf16 v[80:95], v[244:247], v[36:39], v[80:95]
    v_rcp_f32 v11, v11
    v_rcp_f32 v12, v12
    v_rcp_f32 v13, v13
    s_waitcnt lgkmcnt(1)
    v_mfma_f32_32x32x16_bf16 v[80:95], v[248:251], v[40:43], v[80:95]
    v_mul_f32 v14, v14, v10
    v_mul_f32 v15, v15, v11
    v_mul_f32 v16, v16, v12
    v_mul_f32 v17, v17, v13
    s_waitcnt lgkmcnt(0)
    v_mfma_f32_32x32x16_bf16 v[80:95], v[252:255], v[44:47], v[80:95]
    v_cvt_pk_bf16_f32 v98, v14, v15
    v_cvt_pk_bf16_f32 v99, v16, v17
    buffer_store_dwordx4 v[96:99], v1, s[60:63], s9 offen offset:0 sc1
    v_mul_f32 v10, v6, v112
    v_mul_f32 v11, v6, v113
    v_mul_f32 v12, v6, v114
    v_mul_f32 v13, v6, v115
    v_exp_f32 v10, v10
    v_exp_f32 v11, v11
    v_exp_f32 v12, v12
    v_exp_f32 v13, v13
    v_mul_f32 v14, v112, v120
    v_mul_f32 v15, v113, v121
    v_mul_f32 v16, v114, v122
    v_mul_f32 v17, v115, v123
    v_fma_f32 v10, v10, v7, v7
    v_fma_f32 v11, v11, v7, v7
    v_fma_f32 v12, v12, v7, v7
    v_fma_f32 v13, v13, v7, v7
    v_rcp_f32 v10, v10
    v_rcp_f32 v11, v11
    v_rcp_f32 v12, v12
    v_rcp_f32 v13, v13
    v_mul_f32 v14, v14, v10
    v_mul_f32 v15, v15, v11
    v_mul_f32 v16, v16, v12
    v_mul_f32 v17, v17, v13
    v_cvt_pk_bf16_f32 v112, v14, v15
    v_cvt_pk_bf16_f32 v113, v16, v17
    v_mul_f32 v10, v6, v116
    v_mul_f32 v11, v6, v117
    v_mul_f32 v12, v6, v118
    v_mul_f32 v13, v6, v119
    v_exp_f32 v10, v10
    v_exp_f32 v11, v11
    v_exp_f32 v12, v12
    v_exp_f32 v13, v13
    v_mul_f32 v14, v116, v124
    v_mul_f32 v15, v117, v125
    v_mul_f32 v16, v118, v126
    v_mul_f32 v17, v119, v127
    v_fma_f32 v10, v10, v7, v7
    v_fma_f32 v11, v11, v7, v7
    v_fma_f32 v12, v12, v7, v7
    v_fma_f32 v13, v13, v7, v7
    v_rcp_f32 v10, v10
    v_rcp_f32 v11, v11
    v_rcp_f32 v12, v12
    v_rcp_f32 v13, v13
    v_mul_f32 v14, v14, v10
    v_mul_f32 v15, v15, v11
    v_mul_f32 v16, v16, v12
    v_mul_f32 v17, v17, v13
    v_cvt_pk_bf16_f32 v114, v14, v15
    v_cvt_pk_bf16_f32 v115, v16, v17
    buffer_store_dwordx4 v[112:115], v1, s[60:63], s9 offen offset:1024 sc1
    v_mfma_f32_32x32x16_bf16 v[80:95], v[20:23], v[64:67], v[80:95]
    s_waitcnt vmcnt(0)
    s_nop 7
    v_and_b32 v10, 15, v0
    s_lshl_b32 s4, s93, 4
    v_add_u32 v10, s4, v10
    v_lshlrev_b32 v10, 6, v10
    v_add_u32 v10, 0x24e00, v10
    v_lshrrev_b32 v11, 4, v0
    v_lshlrev_b32 v11, 5, v11
    s_lshl_b32 s4, s92, 7
    s_add_u32 s4, s4, 0x24c00
    v_add_u32 v11, s4, v11
    ds_read_b128 v[108:111], v11
    ds_read_b128 v[112:115], v11 offset:16
    ds_read_b128 v[96:99], v10
    ds_read_b128 v[100:103], v10 offset:16
    ds_read_b128 v[104:107], v10 offset:32
    v_permlane16_swap_b32 v80, v88
    v_permlane16_swap_b32 v81, v89
    v_permlane16_swap_b32 v82, v90
    v_permlane16_swap_b32 v83, v91
    v_permlane16_swap_b32 v84, v92
    v_permlane16_swap_b32 v85, v93
    v_permlane16_swap_b32 v86, v94
    v_permlane16_swap_b32 v87, v95
    s_waitcnt lgkmcnt(4)
    v_mul_f32 v80, v108, v80
    v_mul_f32 v88, v108, v88
    v_mul_f32 v81, v109, v81
    v_mul_f32 v89, v109, v89
    v_mul_f32 v82, v110, v82
    v_mul_f32 v90, v110, v90
    v_mul_f32 v83, v111, v83
    v_mul_f32 v91, v111, v91
    s_waitcnt lgkmcnt(3)
    v_mul_f32 v84, v112, v84
    v_mul_f32 v92, v112, v92
    v_mul_f32 v85, v113, v85
    v_mul_f32 v93, v113, v93
    v_mul_f32 v86, v114, v86
    v_mul_f32 v94, v114, v94
    v_mul_f32 v87, v115, v87
    v_mul_f32 v95, v115, v95
    s_waitcnt lgkmcnt(2)
    v_fma_f32 v118, v98, v80, v81
    v_fma_f32 v119, v98, v88, v89
    v_fma_f32 v118, -v99, v88, v118
    v_fma_f32 v119, v99, v80, v119
    v_fma_f32 v120, v98, v118, v82
    v_fma_f32 v121, v98, v119, v90
    v_fma_f32 v120, -v99, v119, v120
    v_fma_f32 v121, v99, v118, v121
    v_fma_f32 v118, v98, v120, v83
    v_fma_f32 v119, v98, v121, v91
    v_fma_f32 v118, -v99, v121, v118
    v_fma_f32 v119, v99, v120, v119
    v_fma_f32 v120, v98, v118, v84
    v_fma_f32 v121, v98, v119, v92
    v_fma_f32 v120, -v99, v119, v120
    v_fma_f32 v121, v99, v118, v121
    v_fma_f32 v118, v98, v120, v85
    v_fma_f32 v119, v98, v121, v93
    v_fma_f32 v118, -v99, v121, v118
    v_fma_f32 v119, v99, v120, v119
    v_fma_f32 v120, v98, v118, v86
    v_fma_f32 v121, v98, v119, v94
    v_fma_f32 v120, -v99, v119, v120
    v_fma_f32 v121, v99, v118, v121
    v_fma_f32 v118, v98, v120, v87
    v_fma_f32 v119, v98, v121, v95
    v_fma_f32 v118, -v99, v121, v118
    v_fma_f32 v119, v99, v120, v119
    v_mov_b32 v120, v118
    v_mov_b32 v122, v118
    v_mov_b32 v121, v119
    v_mov_b32 v123, v119
    v_bfe_u32 v12, v0, 4, 1
    v_cmp_eq_u32 vcc, 1, v12
    v_permlane16_swap_b32 v120, v122
    v_permlane16_swap_b32 v121, v123
    v_lshrrev_b32 v12, 4, v0
    v_and_b32 v10, 15, v0
    v_lshlrev_b32 v10, 5, v10
    s_waitcnt lgkmcnt(1)
    v_fma_f32 v118, v102, v120, v122
    v_fma_f32 v119, v102, v121, v123
    v_fma_f32 v118, -v103, v121, v118
    v_fma_f32 v119, v103, v120, v119
    v_cndmask_b32 v116, 0, v120, vcc
    v_cndmask_b32 v117, 0, v121, vcc
    v_mov_b32 v124, v118
    v_mov_b32 v126, v118
    v_mov_b32 v125, v119
    v_mov_b32 v127, v119
    s_lshl_b32 s4, s93, 9
    s_lshl_b32 s5, s92, 3
    s_add_u32 s4, s4, s5
    s_add_u32 s4, s4, 0x25600
    v_permlane32_swap_b32 v124, v126
    v_permlane32_swap_b32 v125, v127
    v_add_u32 v10, s4, v10
    s_waitcnt lgkmcnt(0)
    v_fma_f32 v126, v104, v124, v126
    v_fma_f32 v127, v104, v125, v127
    v_fma_f32 v126, -v105, v125, v126
    v_fma_f32 v127, v105, v124, v127
    ds_write_b64 v10, v[126:127]
    v_fma_f32 v120, v102, v124, v116
    v_fma_f32 v121, v102, v125, v117
    v_fma_f32 v120, -v103, v125, v120
    v_fma_f32 v121, v103, v124, v121
    v_add_f32 v122, v124, v116
    v_add_f32 v123, v125, v117
    v_cmp_eq_u32 vcc, 2, v12
    s_nop 1
    v_cndmask_b32 v116, v116, v122, vcc
    v_cndmask_b32 v117, v117, v123, vcc
    v_cmp_eq_u32 vcc, 3, v12
    s_nop 1
    v_cndmask_b32 v116, v116, v120, vcc
    v_cndmask_b32 v117, v117, v121, vcc
    s_waitcnt lgkmcnt(0)
    s_barrier
    v_and_b32 v10, 15, v0
    v_lshlrev_b32 v10, 5, v10
    s_lshl_b32 s4, s93, 9
    s_add_u32 s4, s4, 0x25600
    v_add_u32 v10, s4, v10
    ds_read_b128 v[108:111], v10
    ds_read_b128 v[112:115], v10 offset:16
    s_lshl_b32 s4, s89, 13
    s_lshl_b32 s5, s88, 9
    s_add_u32 s4, s4, s5
    s_lshl_b32 s5, s93, 8
    s_add_u32 s4, s4, s5
    s_add_u32 s4, s4, 0x10000
    s_cmp_eq_u32 s92, 0
    s_cselect_b32 s4, s4, 0x7ff00000
    v_lshlrev_b32 v11, 4, v0
    v_mov_b32 v12, 0x7ff00000
    v_cmp_gt_u32 vcc, 16, v0
    s_nop 1
    v_cndmask_b32 v11, v12, v11, vcc
    v_add_u32 v11, s4, v11
    v_mov_b32 v125, s26
    v_mov_b32 v127, s26
    s_waitcnt lgkmcnt(1)
    v_fma_f32 v110, v106, v108, v110
    v_fma_f32 v111, v106, v109, v111
    v_fma_f32 v110, -v107, v109, v110
    v_fma_f32 v111, v107, v108, v111
    s_waitcnt lgkmcnt(0)
    v_fma_f32 v112, v106, v110, v112
    v_fma_f32 v113, v106, v111, v113
    v_fma_f32 v112, -v107, v111, v112
    v_fma_f32 v113, v107, v110, v113
    v_fma_f32 v114, v106, v112, v114
    v_fma_f32 v115, v106, v113, v115
    v_fma_f32 v114, -v107, v113, v114
    v_fma_f32 v115, v107, v112, v115
    v_mov_b32 v124, v114
    v_mov_b32 v126, v115
    buffer_store_dwordx4 v[124:127], v11, s[60:63], 0 offen sc0 sc1
    v_mov_b32 v118, 0
    v_mov_b32 v119, 0
    s_cmp_eq_u32 s92, 1
    s_cselect_b64 s[98:99], -1, 0
    v_cndmask_b32 v118, v118, v108, s[98:99]
    v_cndmask_b32 v119, v119, v109, s[98:99]
    s_cmp_eq_u32 s92, 2
    s_cselect_b64 s[98:99], -1, 0
    v_cndmask_b32 v118, v118, v110, s[98:99]
    v_cndmask_b32 v119, v119, v111, s[98:99]
    s_cmp_eq_u32 s92, 3
    s_cselect_b64 s[98:99], -1, 0
    v_cndmask_b32 v118, v118, v112, s[98:99]
    v_cndmask_b32 v119, v119, v113, s[98:99]
    v_lshrrev_b32 v11, 4, v0
    v_lshlrev_b32 v11, 3, v11
    v_cvt_f32_u32 v12, v11
    s_lshl_b32 s4, s92, 5
    v_add_u32 v11, s4, v11
    v_cvt_f32_u32 v13, v11
    v_mul_f32 v14, v12, v96
    v_mul_f32 v121, v12, v97
    v_exp_f32 v14, v14
    v_fract_f32 v121, v121
    v_cos_f32 v120, v121
    v_sin_f32 v121, v121
    s_nop 0
    v_mul_f32 v120, v120, v14
    v_mul_f32 v121, v121, v14
    v_fma_f32 v116, v120, v118, v116
    v_fma_f32 v117, v120, v119, v117
    v_fma_f32 v116, -v121, v119, v116
    v_fma_f32 v117, v121, v118, v117
    v_mul_f32 v14, v13, v96
    v_mul_f32 v121, v13, v97
    v_exp_f32 v14, v14
    v_fract_f32 v121, v121
    v_cos_f32 v120, v121
    v_sin_f32 v121, v121
    s_nop 0
    v_mul_f32 v120, v120, v14
    v_mul_f32 v121, v121, v14
    v_mul_f32 v122, v120, v100
    v_mul_f32 v123, v120, v101
    v_fma_f32 v122, -v121, v101, v122
    v_fma_f32 v123, v121, v100, v123
    v_mul_f32 v120, v116, v100
    v_mul_f32 v121, v116, v101
    v_fma_f32 v120, -v117, v101, v120
    v_fma_f32 v121, v117, v100, v121
    v_mov_b32 v116, v120
    v_mov_b32 v117, v121
    v_mul_f32 v12, v100, v80
    v_mul_f32 v13, v101, v80
    v_fma_f32 v80, -v101, v88, v12
    v_fma_f32 v88, v100, v88, v13
    v_mul_f32 v10, v100, v81
    v_mul_f32 v11, v101, v81
    v_fma_f32 v81, -v101, v89, v10
    v_fma_f32 v89, v100, v89, v11
    v_mul_f32 v12, v100, v82
    v_mul_f32 v13, v101, v82
    v_fma_f32 v82, -v101, v90, v12
    v_fma_f32 v90, v100, v90, v13
    v_mul_f32 v10, v100, v83
    v_mul_f32 v11, v101, v83
    v_fma_f32 v83, -v101, v91, v10
    v_fma_f32 v91, v100, v91, v11
    v_mul_f32 v12, v100, v84
    v_mul_f32 v13, v101, v84
    v_fma_f32 v84, -v101, v92, v12
    v_fma_f32 v92, v100, v92, v13
    v_mul_f32 v10, v100, v85
    v_mul_f32 v11, v101, v85
    v_fma_f32 v85, -v101, v93, v10
    v_fma_f32 v93, v100, v93, v11
    v_mul_f32 v12, v100, v86
    v_mul_f32 v13, v101, v86
    v_fma_f32 v86, -v101, v94, v12
    v_fma_f32 v94, v100, v94, v13
    v_mul_f32 v10, v100, v87
    v_mul_f32 v11, v101, v87
    v_fma_f32 v87, -v101, v95, v10
    v_fma_f32 v95, v100, v95, v11
    s_lshl_b32 s4, s93, 2
    s_add_u32 s4, s4, s92
    s_lshl_b32 s4, s4, 10
    s_add_u32 s4, s4, 0x25b00
    v_and_b32 v10, 15, v0
    v_lshlrev_b32 v10, 6, v10
    v_lshrrev_b32 v11, 4, v0
    v_lshl_add_u32 v10, v11, 4, v10
    v_add_u32 v124, s4, v10
    v_lshrrev_b32 v11, 5, v0
    v_lshlrev_b32 v11, 9, v11
    v_bfe_u32 v12, v0, 2, 2
    v_lshl_add_u32 v11, v12, 6, v11
    v_and_b32 v12, 1, v0
    v_lshl_add_u32 v11, v12, 5, v11
    v_bfe_u32 v12, v0, 4, 1
    v_lshl_add_u32 v11, v12, 4, v11
    v_bfe_u32 v12, v0, 1, 1
    v_lshl_add_u32 v11, v12, 3, v11
    v_add_u32 v125, s4, v11
    s_lshl_b32 s4, s89, 1
    s_add_u32 s4, s4, s93
    s_lshr_b32 s5, s4, 2
    s_lshl_b32 s5, s5, 3
    s_and_b32 s4, s4, 3
    s_add_u32 s4, s4, s5
    s_add_u32 s4, s4, 64
    s_lshl_b32 s4, s4, 10
    s_mul_i32 s5, s88, 0xb0000
    s_add_u32 s4, s4, s5
    s_add_u32 s27, s4, 0x200000
    s_add_u32 s8, s27, 4096
    v_and_b32 v10, 15, v0
    s_lshl_b32 s4, s93, 4
    v_add_u32 v10, s4, v10
    v_lshlrev_b32 v10, 3, v10
    v_add_u32 v126, 0x25a00, v10
    s_barrier
    ds_read_b64 v[108:109], v126
    s_waitcnt lgkmcnt(0)
    v_fma_f32 v116, v122, v108, v116
    v_fma_f32 v117, v122, v109, v117
    v_fma_f32 v116, -v123, v109, v116
    v_fma_f32 v117, v123, v108, v117
    v_fma_f32 v80, v98, v116, v80
    v_fma_f32 v88, v98, v117, v88
    v_fma_f32 v80, -v99, v117, v80
    v_fma_f32 v88, v99, v116, v88
    v_fma_f32 v81, v98, v80, v81
    v_fma_f32 v89, v98, v88, v89
    v_fma_f32 v81, -v99, v88, v81
    v_fma_f32 v89, v99, v80, v89
    v_fma_f32 v82, v98, v81, v82
    v_fma_f32 v90, v98, v89, v90
    v_fma_f32 v82, -v99, v89, v82
    v_fma_f32 v90, v99, v81, v90
    v_fma_f32 v83, v98, v82, v83
    v_fma_f32 v91, v98, v90, v91
    v_fma_f32 v83, -v99, v90, v83
    v_fma_f32 v91, v99, v82, v91
    v_fma_f32 v84, v98, v83, v84
    v_fma_f32 v92, v98, v91, v92
    v_fma_f32 v84, -v99, v91, v84
    v_fma_f32 v92, v99, v83, v92
    v_fma_f32 v85, v98, v84, v85
    v_fma_f32 v93, v98, v92, v93
    v_fma_f32 v85, -v99, v92, v85
    v_fma_f32 v93, v99, v84, v93
    v_fma_f32 v86, v98, v85, v86
    v_fma_f32 v94, v98, v93, v94
    v_fma_f32 v86, -v99, v93, v86
    v_fma_f32 v94, v99, v85, v94
    v_fma_f32 v87, v98, v86, v87
    v_fma_f32 v95, v98, v94, v95
    v_fma_f32 v87, -v99, v94, v87
    v_fma_f32 v95, v99, v86, v95
    v_cvt_pk_bf16_f32 v108, v80, v81
    v_cvt_pk_bf16_f32 v109, v82, v83
    v_cvt_pk_bf16_f32 v110, v84, v85
    v_cvt_pk_bf16_f32 v111, v86, v87
    ds_write_b128 v124, v[108:111]
    ds_read_b64_tr_b16 v[96:97], v125 offset:0
    ds_read_b64_tr_b16 v[98:99], v125 offset:256
    v_cvt_pk_bf16_f32 v112, -v88, -v89
    v_cvt_pk_bf16_f32 v113, -v90, -v91
    v_cvt_pk_bf16_f32 v114, -v92, -v93
    v_cvt_pk_bf16_f32 v115, -v94, -v95
    ds_write_b128 v124, v[112:115]
    ds_read_b64_tr_b16 v[100:101], v125 offset:0
    ds_read_b64_tr_b16 v[102:103], v125 offset:256
    s_waitcnt lgkmcnt(3)
    buffer_store_dwordx4 v[96:99], v1, s[60:63], s27 offen sc1
    s_waitcnt lgkmcnt(0)
    buffer_store_dwordx4 v[100:103], v1, s[60:63], s8 offen sc1
    s_add_u32 s100, s83, 0x0
    s_add_u32 m0, s86, 0x18000
    s_nop 0
    buffer_load_dwordx4 v24, s[60:63], s100 offen offset:0 sc1 lds
    buffer_load_dwordx4 v24, s[60:63], s100 offen offset:1024 sc1 lds
    buffer_load_dwordx4 v24, s[60:63], s100 offen offset:2048 sc1 lds
    buffer_load_dwordx4 v24, s[60:63], s100 offen offset:3072 sc1 lds
    s_add_u32 s100, s83, 0x2000
    s_add_u32 m0, s86, 0x1c000
    s_nop 0
    buffer_load_dwordx4 v24, s[60:63], s100 offen offset:0 sc1 lds
    buffer_load_dwordx4 v24, s[60:63], s100 offen offset:1024 sc1 lds
    buffer_load_dwordx4 v24, s[60:63], s100 offen offset:2048 sc1 lds
    buffer_load_dwordx4 v24, s[60:63], s100 offen offset:3072 sc1 lds
    s_add_u32 s100, s83, 0x4000
    s_add_u32 m0, s86, 0x20000
    s_nop 0
    buffer_load_dwordx4 v24, s[60:63], s100 offen offset:0 sc1 lds
    buffer_load_dwordx4 v24, s[60:63], s100 offen offset:1024 sc1 lds
    buffer_load_dwordx4 v24, s[60:63], s100 offen offset:2048 sc1 lds
    buffer_load_dwordx4 v24, s[60:63], s100 offen offset:3072 sc1 lds
    s_add_u32 s100, s83, 0x6000
    s_add_u32 m0, s86, 0x0
    s_nop 0
    buffer_load_dwordx4 v24, s[60:63], s100 offen offset:0 sc1 lds
    buffer_load_dwordx4 v24, s[60:63], s100 offen offset:1024 sc1 lds
    buffer_load_dwordx4 v24, s[60:63], s100 offen offset:2048 sc1 lds
    buffer_load_dwordx4 v24, s[60:63], s100 offen offset:3072 sc1 lds
    s_mov_b32 s100, 0x80000
    s_add_u32 m0, s86, 0x4000
    s_nop 0
    buffer_load_dwordx4 v25, s[64:67], s100 offen lds
    s_mov_b32 s100, 0x82000
    s_add_u32 m0, s86, 0x4400
    s_nop 0
    buffer_load_dwordx4 v25, s[64:67], s100 offen lds
    s_mov_b32 s100, 0x84000
    s_add_u32 m0, s86, 0x4800
    s_nop 0
    buffer_load_dwordx4 v25, s[64:67], s100 offen lds
    s_mov_b32 s100, 0x86000
    s_add_u32 m0, s86, 0x4c00
    s_nop 0
    buffer_load_dwordx4 v25, s[64:67], s100 offen lds
    s_waitcnt vmcnt(16)
    s_barrier
    s_mov_b32 s100, 0
    s_add_u32 m0, s84, 0x25b00
    s_nop 0
    buffer_load_dwordx4 v30, s[40:43], s100 offen lds
    s_mov_b32 s100, 8192
    s_add_u32 m0, s84, 0x25f00
    s_nop 0
    buffer_load_dwordx4 v30, s[40:43], s100 offen lds
    s_waitcnt vmcnt(14)
    s_barrier
    s_add_u32 s100, s83, 0x8000
    s_add_u32 m0, s86, 0x8000
    s_nop 0
    buffer_load_dwordx4 v24, s[60:63], s100 offen offset:0 sc1 lds
    buffer_load_dwordx4 v24, s[60:63], s100 offen offset:1024 sc1 lds
    buffer_load_dwordx4 v24, s[60:63], s100 offen offset:2048 sc1 lds
    buffer_load_dwordx4 v24, s[60:63], s100 offen offset:3072 sc1 lds
    s_mov_b32 s100, 0xa0000
    s_add_u32 m0, s86, 0x18000
    s_nop 0
    buffer_load_dwordx4 v25, s[64:67], s100 offen lds
    s_mov_b32 s100, 0xa2000
    s_add_u32 m0, s86, 0x18400
    s_nop 0
    buffer_load_dwordx4 v25, s[64:67], s100 offen lds
    s_mov_b32 s100, 0xa4000
    s_add_u32 m0, s86, 0x18800
    s_nop 0
    buffer_load_dwordx4 v25, s[64:67], s100 offen lds
    s_mov_b32 s100, 0xa6000
    s_add_u32 m0, s86, 0x18c00
    s_nop 0
    buffer_load_dwordx4 v25, s[64:67], s100 offen lds
    s_waitcnt vmcnt(18)
    s_barrier
    s_add_u32 s100, s83, 0xa000
    s_add_u32 m0, s86, 0xc000
    s_nop 0
    buffer_load_dwordx4 v24, s[60:63], s100 offen offset:0 sc1 lds
    buffer_load_dwordx4 v24, s[60:63], s100 offen offset:1024 sc1 lds
    buffer_load_dwordx4 v24, s[60:63], s100 offen offset:2048 sc1 lds
    buffer_load_dwordx4 v24, s[60:63], s100 offen offset:3072 sc1 lds
    s_mov_b32 s100, 0xc0000
    s_add_u32 m0, s86, 0x1c000
    s_nop 0
    buffer_load_dwordx4 v25, s[64:67], s100 offen lds
    s_mov_b32 s100, 0xc2000
    s_add_u32 m0, s86, 0x1c400
    s_nop 0
    buffer_load_dwordx4 v25, s[64:67], s100 offen lds
    s_mov_b32 s100, 0xc4000
    s_add_u32 m0, s86, 0x1c800
    s_nop 0
    buffer_load_dwordx4 v25, s[64:67], s100 offen lds
    s_mov_b32 s100, 0xc6000
    s_add_u32 m0, s86, 0x1cc00
    s_nop 0
    buffer_load_dwordx4 v25, s[64:67], s100 offen lds
    s_waitcnt vmcnt(22)
    s_barrier
    s_add_u32 s100, s83, 0xc000
    s_add_u32 m0, s86, 0x10000
    s_nop 0
    buffer_load_dwordx4 v24, s[60:63], s100 offen offset:0 sc1 lds
    buffer_load_dwordx4 v24, s[60:63], s100 offen offset:1024 sc1 lds
    buffer_load_dwordx4 v24, s[60:63], s100 offen offset:2048 sc1 lds
    buffer_load_dwordx4 v24, s[60:63], s100 offen offset:3072 sc1 lds
    s_mov_b32 s100, 0xe0000
    s_add_u32 m0, s86, 0x20000
    s_nop 0
    buffer_load_dwordx4 v25, s[64:67], s100 offen lds
    s_mov_b32 s100, 0xe2000
    s_add_u32 m0, s86, 0x20400
    s_nop 0
    buffer_load_dwordx4 v25, s[64:67], s100 offen lds
    s_mov_b32 s100, 0xe4000
    s_add_u32 m0, s86, 0x20800
    s_nop 0
    buffer_load_dwordx4 v25, s[64:67], s100 offen lds
    s_mov_b32 s100, 0xe6000
    s_add_u32 m0, s86, 0x20c00
    s_nop 0
    buffer_load_dwordx4 v25, s[64:67], s100 offen lds
    s_waitcnt vmcnt(26)
    s_waitcnt vmcnt(20)
    s_barrier
    s_add_u32 s100, s83, 0xe000
    s_add_u32 m0, s86, 0x14000
    s_nop 0
    buffer_load_dwordx4 v24, s[60:63], s100 offen offset:0 sc1 lds
    buffer_load_dwordx4 v24, s[60:63], s100 offen offset:1024 sc1 lds
    buffer_load_dwordx4 v24, s[60:63], s100 offen offset:2048 sc1 lds
    buffer_load_dwordx4 v24, s[60:63], s100 offen offset:3072 sc1 lds
    s_mov_b32 s100, 0
    s_add_u32 m0, s84, 0x0
    s_nop 0
    buffer_load_dwordx4 v26, s[68:71], s100 offen lds
    s_add_u32 m0, s84, 0x2000
    s_nop 0
    buffer_load_dwordx4 v26, s[72:75], s100 offen lds
    s_add_u32 m0, s84, 0x400
    s_nop 0
    buffer_load_dwordx4 v27, s[68:71], s100 offen lds
    s_add_u32 m0, s84, 0x2400
    s_nop 0
    buffer_load_dwordx4 v27, s[72:75], s100 offen lds
    s_waitcnt vmcnt(24)
    s_waitcnt vmcnt(20)
    s_barrier
    s_add_u32 s100, s83, 0x10000
    s_add_u32 m0, s86, 0x4000
    s_nop 0
    buffer_load_dwordx4 v24, s[60:63], s100 offen offset:0 sc1 lds
    buffer_load_dwordx4 v24, s[60:63], s100 offen offset:1024 sc1 lds
    buffer_load_dwordx4 v24, s[60:63], s100 offen offset:2048 sc1 lds
    buffer_load_dwordx4 v24, s[60:63], s100 offen offset:3072 sc1 lds
    s_mov_b32 s100, 128
    s_add_u32 m0, s84, 0x8000
    s_nop 0
    buffer_load_dwordx4 v26, s[68:71], s100 offen lds
    s_add_u32 m0, s84, 0xa000
    s_nop 0
    buffer_load_dwordx4 v26, s[72:75], s100 offen lds
    s_add_u32 m0, s84, 0x8400
    s_nop 0
    buffer_load_dwordx4 v27, s[68:71], s100 offen lds
    s_add_u32 m0, s84, 0xa400
    s_nop 0
    buffer_load_dwordx4 v27, s[72:75], s100 offen lds
    s_waitcnt vmcnt(24)
    s_waitcnt vmcnt(20)
    s_barrier
    s_add_u32 s100, s83, 0x12000
    s_add_u32 m0, s86, 0x18000
    s_nop 0
    buffer_load_dwordx4 v24, s[60:63], s100 offen offset:0 sc1 lds
    buffer_load_dwordx4 v24, s[60:63], s100 offen offset:1024 sc1 lds
    buffer_load_dwordx4 v24, s[60:63], s100 offen offset:2048 sc1 lds
    buffer_load_dwordx4 v24, s[60:63], s100 offen offset:3072 sc1 lds
    s_mov_b32 s100, 256
    s_add_u32 m0, s84, 0xc000
    s_nop 0
    buffer_load_dwordx4 v26, s[68:71], s100 offen lds
    s_add_u32 m0, s84, 0xe000
    s_nop 0
    buffer_load_dwordx4 v26, s[72:75], s100 offen lds
    s_add_u32 m0, s84, 0xc400
    s_nop 0
    buffer_load_dwordx4 v27, s[68:71], s100 offen lds
    s_add_u32 m0, s84, 0xe400
    s_nop 0
    buffer_load_dwordx4 v27, s[72:75], s100 offen lds
    s_waitcnt vmcnt(24)
    s_waitcnt vmcnt(20)
    s_barrier
    s_add_u32 s100, s83, 0x14000
    s_add_u32 m0, s86, 0x1c000
    s_nop 0
    buffer_load_dwordx4 v24, s[60:63], s100 offen offset:0 sc1 lds
    buffer_load_dwordx4 v24, s[60:63], s100 offen offset:1024 sc1 lds
    buffer_load_dwordx4 v24, s[60:63], s100 offen offset:2048 sc1 lds
    buffer_load_dwordx4 v24, s[60:63], s100 offen offset:3072 sc1 lds
    s_mov_b32 s100, 384
    s_add_u32 m0, s84, 0x10000
    s_nop 0
    buffer_load_dwordx4 v26, s[68:71], s100 offen lds
    s_add_u32 m0, s84, 0x12000
    s_nop 0
    buffer_load_dwordx4 v26, s[72:75], s100 offen lds
    s_add_u32 m0, s84, 0x10400
    s_nop 0
    buffer_load_dwordx4 v27, s[68:71], s100 offen lds
    s_add_u32 m0, s84, 0x12400
    s_nop 0
    buffer_load_dwordx4 v27, s[72:75], s100 offen lds
    s_waitcnt vmcnt(24)
    s_waitcnt vmcnt(20)
    s_barrier
    s_add_u32 s100, s83, 0x16000
    s_add_u32 m0, s86, 0x20000
    s_nop 0
    buffer_load_dwordx4 v24, s[60:63], s100 offen offset:0 sc1 lds
    buffer_load_dwordx4 v24, s[60:63], s100 offen offset:1024 sc1 lds
    buffer_load_dwordx4 v24, s[60:63], s100 offen offset:2048 sc1 lds
    buffer_load_dwordx4 v24, s[60:63], s100 offen offset:3072 sc1 lds
    s_mov_b32 s100, 512
    s_add_u32 m0, s84, 0x14000
    s_nop 0
    buffer_load_dwordx4 v26, s[68:71], s100 offen lds
    s_add_u32 m0, s84, 0x16000
    s_nop 0
    buffer_load_dwordx4 v26, s[72:75], s100 offen lds
    s_add_u32 m0, s84, 0x14400
    s_nop 0
    buffer_load_dwordx4 v27, s[68:71], s100 offen lds
    s_add_u32 m0, s84, 0x16400
    s_nop 0
    buffer_load_dwordx4 v27, s[72:75], s100 offen lds
    s_waitcnt vmcnt(24)
    s_waitcnt vmcnt(20)
    s_barrier
    s_add_u32 s100, s83, 0x18000
    s_add_u32 m0, s86, 0x0
    s_nop 0
    buffer_load_dwordx4 v24, s[60:63], s100 offen offset:0 sc1 lds
    buffer_load_dwordx4 v24, s[60:63], s100 offen offset:1024 sc1 lds
    buffer_load_dwordx4 v24, s[60:63], s100 offen offset:2048 sc1 lds
    buffer_load_dwordx4 v24, s[60:63], s100 offen offset:3072 sc1 lds
    s_mov_b32 s100, 640
    s_add_u32 m0, s84, 0x4000
    s_nop 0
    buffer_load_dwordx4 v26, s[68:71], s100 offen lds
    s_add_u32 m0, s84, 0x6000
    s_nop 0
    buffer_load_dwordx4 v26, s[72:75], s100 offen lds
    s_add_u32 m0, s84, 0x4400
    s_nop 0
    buffer_load_dwordx4 v27, s[68:71], s100 offen lds
    s_add_u32 m0, s84, 0x6400
    s_nop 0
    buffer_load_dwordx4 v27, s[72:75], s100 offen lds
    s_waitcnt vmcnt(24)
    s_waitcnt vmcnt(20)
    s_barrier
    s_add_u32 s100, s83, 0x1a000
    s_add_u32 m0, s86, 0x8000
    s_nop 0
    buffer_load_dwordx4 v24, s[60:63], s100 offen offset:0 sc1 lds
    buffer_load_dwordx4 v24, s[60:63], s100 offen offset:1024 sc1 lds
    buffer_load_dwordx4 v24, s[60:63], s100 offen offset:2048 sc1 lds
    buffer_load_dwordx4 v24, s[60:63], s100 offen offset:3072 sc1 lds
    s_mov_b32 s100, 768
    s_add_u32 m0, s84, 0x18000
    s_nop 0
    buffer_load_dwordx4 v26, s[68:71], s100 offen lds
    s_add_u32 m0, s84, 0x1a000
    s_nop 0
    buffer_load_dwordx4 v26, s[72:75], s100 offen lds
    s_add_u32 m0, s84, 0x18400
    s_nop 0
    buffer_load_dwordx4 v27, s[68:71], s100 offen lds
    s_add_u32 m0, s84, 0x1a400
    s_nop 0
    buffer_load_dwordx4 v27, s[72:75], s100 offen lds
    s_waitcnt vmcnt(24)
    s_waitcnt vmcnt(20)
    s_barrier
    s_add_u32 s100, s83, 0x1c000
    s_add_u32 m0, s86, 0xc000
    s_nop 0
    buffer_load_dwordx4 v24, s[60:63], s100 offen offset:0 sc1 lds
    buffer_load_dwordx4 v24, s[60:63], s100 offen offset:1024 sc1 lds
    buffer_load_dwordx4 v24, s[60:63], s100 offen offset:2048 sc1 lds
    buffer_load_dwordx4 v24, s[60:63], s100 offen offset:3072 sc1 lds
    s_mov_b32 s100, 896
    s_add_u32 m0, s84, 0x1c000
    s_nop 0
    buffer_load_dwordx4 v26, s[68:71], s100 offen lds
    s_add_u32 m0, s84, 0x1e000
    s_nop 0
    buffer_load_dwordx4 v26, s[72:75], s100 offen lds
    s_add_u32 m0, s84, 0x1c400
    s_nop 0
    buffer_load_dwordx4 v27, s[68:71], s100 offen lds
    s_add_u32 m0, s84, 0x1e400
    s_nop 0
    buffer_load_dwordx4 v27, s[72:75], s100 offen lds
    s_waitcnt vmcnt(24)
    s_waitcnt vmcnt(20)
    s_barrier
    s_add_u32 s100, s83, 0x1e000
    s_add_u32 m0, s86, 0x10000
    s_nop 0
    buffer_load_dwordx4 v24, s[60:63], s100 offen offset:0 sc1 lds
    buffer_load_dwordx4 v24, s[60:63], s100 offen offset:1024 sc1 lds
    buffer_load_dwordx4 v24, s[60:63], s100 offen offset:2048 sc1 lds
    buffer_load_dwordx4 v24, s[60:63], s100 offen offset:3072 sc1 lds
    s_mov_b32 s100, 0x100000
    s_add_u32 m0, s86, 0x20000
    s_nop 0
    buffer_load_dwordx4 v25, s[64:67], s100 offen lds
    s_mov_b32 s100, 0x102000
    s_add_u32 m0, s86, 0x20400
    s_nop 0
    buffer_load_dwordx4 v25, s[64:67], s100 offen lds
    s_mov_b32 s100, 0x104000
    s_add_u32 m0, s86, 0x20800
    s_nop 0
    buffer_load_dwordx4 v25, s[64:67], s100 offen lds
    s_mov_b32 s100, 0x106000
    s_add_u32 m0, s86, 0x20c00
    s_nop 0
    buffer_load_dwordx4 v25, s[64:67], s100 offen lds
    s_waitcnt vmcnt(24)
    s_waitcnt vmcnt(20)
    s_barrier
    s_add_u32 s100, s83, 0x20000
    s_add_u32 m0, s86, 0x14000
    s_nop 0
    buffer_load_dwordx4 v24, s[60:63], s100 offen offset:0 sc1 lds
    buffer_load_dwordx4 v24, s[60:63], s100 offen offset:1024 sc1 lds
    buffer_load_dwordx4 v24, s[60:63], s100 offen offset:2048 sc1 lds
    buffer_load_dwordx4 v24, s[60:63], s100 offen offset:3072 sc1 lds
    s_mov_b32 s100, 0x120000
    s_add_u32 m0, s86, 0x0
    s_nop 0
    buffer_load_dwordx4 v25, s[64:67], s100 offen lds
    s_mov_b32 s100, 0x122000
    s_add_u32 m0, s86, 0x400
    s_nop 0
    buffer_load_dwordx4 v25, s[64:67], s100 offen lds
    s_mov_b32 s100, 0x124000
    s_add_u32 m0, s86, 0x800
    s_nop 0
    buffer_load_dwordx4 v25, s[64:67], s100 offen lds
    s_mov_b32 s100, 0x126000
    s_add_u32 m0, s86, 0xc00
    s_nop 0
    buffer_load_dwordx4 v25, s[64:67], s100 offen lds
    s_waitcnt vmcnt(24)
    s_waitcnt vmcnt(20)
    s_barrier
    s_add_u32 s100, s83, 0x22000
    s_add_u32 m0, s86, 0x4000
    s_nop 0
    buffer_load_dwordx4 v24, s[60:63], s100 offen offset:0 sc1 lds
    buffer_load_dwordx4 v24, s[60:63], s100 offen offset:1024 sc1 lds
    buffer_load_dwordx4 v24, s[60:63], s100 offen offset:2048 sc1 lds
    buffer_load_dwordx4 v24, s[60:63], s100 offen offset:3072 sc1 lds
    s_mov_b32 s100, 0x140000
    s_add_u32 m0, s86, 0x8000
    s_nop 0
    buffer_load_dwordx4 v25, s[64:67], s100 offen lds
    s_mov_b32 s100, 0x142000
    s_add_u32 m0, s86, 0x8400
    s_nop 0
    buffer_load_dwordx4 v25, s[64:67], s100 offen lds
    s_mov_b32 s100, 0x144000
    s_add_u32 m0, s86, 0x8800
    s_nop 0
    buffer_load_dwordx4 v25, s[64:67], s100 offen lds
    s_mov_b32 s100, 0x146000
    s_add_u32 m0, s86, 0x8c00
    s_nop 0
    buffer_load_dwordx4 v25, s[64:67], s100 offen lds
    s_waitcnt vmcnt(24)
    s_waitcnt vmcnt(20)
    s_barrier
    s_add_u32 s100, s83, 0x24000
    s_add_u32 m0, s86, 0x18000
    s_nop 0
    buffer_load_dwordx4 v24, s[60:63], s100 offen offset:0 sc1 lds
    buffer_load_dwordx4 v24, s[60:63], s100 offen offset:1024 sc1 lds
    buffer_load_dwordx4 v24, s[60:63], s100 offen offset:2048 sc1 lds
    buffer_load_dwordx4 v24, s[60:63], s100 offen offset:3072 sc1 lds
    s_mov_b32 s100, 0x160000
    s_add_u32 m0, s86, 0xc000
    s_nop 0
    buffer_load_dwordx4 v25, s[64:67], s100 offen lds
    s_mov_b32 s100, 0x162000
    s_add_u32 m0, s86, 0xc400
    s_nop 0
    buffer_load_dwordx4 v25, s[64:67], s100 offen lds
    s_mov_b32 s100, 0x164000
    s_add_u32 m0, s86, 0xc800
    s_nop 0
    buffer_load_dwordx4 v25, s[64:67], s100 offen lds
    s_mov_b32 s100, 0x166000
    s_add_u32 m0, s86, 0xcc00
    s_nop 0
    buffer_load_dwordx4 v25, s[64:67], s100 offen lds
    s_waitcnt vmcnt(24)
    s_waitcnt vmcnt(20)
    s_barrier
    s_add_u32 s100, s83, 0x26000
    s_add_u32 m0, s86, 0x1c000
    s_nop 0
    buffer_load_dwordx4 v24, s[60:63], s100 offen offset:0 sc1 lds
    buffer_load_dwordx4 v24, s[60:63], s100 offen offset:1024 sc1 lds
    buffer_load_dwordx4 v24, s[60:63], s100 offen offset:2048 sc1 lds
    buffer_load_dwordx4 v24, s[60:63], s100 offen offset:3072 sc1 lds
    s_mov_b32 s100, 0x180000
    s_add_u32 m0, s86, 0x10000
    s_nop 0
    buffer_load_dwordx4 v25, s[64:67], s100 offen lds
    s_mov_b32 s100, 0x182000
    s_add_u32 m0, s86, 0x10400
    s_nop 0
    buffer_load_dwordx4 v25, s[64:67], s100 offen lds
    s_mov_b32 s100, 0x184000
    s_add_u32 m0, s86, 0x10800
    s_nop 0
    buffer_load_dwordx4 v25, s[64:67], s100 offen lds
    s_mov_b32 s100, 0x186000
    s_add_u32 m0, s86, 0x10c00
    s_nop 0
    buffer_load_dwordx4 v25, s[64:67], s100 offen lds
    s_waitcnt vmcnt(24)
    s_waitcnt vmcnt(20)
    s_barrier
    s_add_u32 s100, s83, 0x28000
    s_add_u32 m0, s86, 0x20000
    s_nop 0
    buffer_load_dwordx4 v24, s[60:63], s100 offen offset:0 sc1 lds
    buffer_load_dwordx4 v24, s[60:63], s100 offen offset:1024 sc1 lds
    buffer_load_dwordx4 v24, s[60:63], s100 offen offset:2048 sc1 lds
    buffer_load_dwordx4 v24, s[60:63], s100 offen offset:3072 sc1 lds
    s_mov_b32 s100, 0x1a0000
    s_add_u32 m0, s86, 0x14000
    s_nop 0
    buffer_load_dwordx4 v25, s[64:67], s100 offen lds
    s_mov_b32 s100, 0x1a2000
    s_add_u32 m0, s86, 0x14400
    s_nop 0
    buffer_load_dwordx4 v25, s[64:67], s100 offen lds
    s_mov_b32 s100, 0x1a4000
    s_add_u32 m0, s86, 0x14800
    s_nop 0
    buffer_load_dwordx4 v25, s[64:67], s100 offen lds
    s_mov_b32 s100, 0x1a6000
    s_add_u32 m0, s86, 0x14c00
    s_nop 0
    buffer_load_dwordx4 v25, s[64:67], s100 offen lds
    s_waitcnt vmcnt(24)
    s_waitcnt vmcnt(20)
    s_barrier
    s_add_u32 s100, s83, 0x2a000
    s_add_u32 m0, s86, 0x0
    s_nop 0
    buffer_load_dwordx4 v24, s[60:63], s100 offen offset:0 sc1 lds
    buffer_load_dwordx4 v24, s[60:63], s100 offen offset:1024 sc1 lds
    buffer_load_dwordx4 v24, s[60:63], s100 offen offset:2048 sc1 lds
    buffer_load_dwordx4 v24, s[60:63], s100 offen offset:3072 sc1 lds
    s_waitcnt vmcnt(20)
    s_waitcnt vmcnt(16)
    s_barrier
    s_waitcnt vmcnt(12)
    s_waitcnt vmcnt(8)
    s_barrier
    s_waitcnt vmcnt(4)
    s_waitcnt vmcnt(0)
    s_barrier
    s_branch L_end
L_light0:
    v_add_u32 v48, 0x0, v8
    v_add_u32 v4, 0x4000, v2
    v_add_u32 v5, 0x4000, v3
    v_xor_b32 v49, 32, v48
    v_xor_b32 v50, 64, v48
    v_xor_b32 v51, 96, v48
    s_waitcnt lgkmcnt(0)
    s_barrier
    ds_read_b128 v[128:131], v48
    ds_read_b64_tr_b16 v[32:33], v4 offset:0
    ds_read_b64_tr_b16 v[34:35], v4 offset:512
    ds_read_b64_tr_b16 v[36:37], v5 offset:0
    ds_read_b64_tr_b16 v[38:39], v5 offset:512
    ds_read_b128 v[132:135], v49
    ds_read_b128 v[136:139], v50
    ds_read_b128 v[140:143], v51
    ds_read_b64_tr_b16 v[40:41], v4 offset:4096
    ds_read_b64_tr_b16 v[42:43], v4 offset:4608
    ds_read_b64_tr_b16 v[44:45], v5 offset:4096
    ds_read_b64_tr_b16 v[46:47], v5 offset:4608
    ds_read_b64_tr_b16 v[80:81], v4 offset:8192
    ds_read_b64_tr_b16 v[82:83], v4 offset:8704
    ds_read_b64_tr_b16 v[84:85], v5 offset:8192
    ds_read_b64_tr_b16 v[86:87], v5 offset:8704
    s_waitcnt lgkmcnt(13)
    v_mfma_f32_32x32x16_bf16 v[96:111], v[32:35], v[128:131], 0
    s_waitcnt lgkmcnt(11)
    v_mfma_f32_32x32x16_bf16 v[112:127], v[36:39], v[128:131], 0
    ds_read_b64_tr_b16 v[32:33], v4 offset:12288
    ds_read_b64_tr_b16 v[34:35], v4 offset:12800
    ds_read_b64_tr_b16 v[36:37], v5 offset:12288
    ds_read_b64_tr_b16 v[38:39], v5 offset:12800
    s_waitcnt lgkmcnt(10)
    v_mfma_f32_32x32x16_bf16 v[96:111], v[40:43], v[132:135], v[96:111]
    s_waitcnt lgkmcnt(8)
    v_mfma_f32_32x32x16_bf16 v[112:127], v[44:47], v[132:135], v[112:127]
    v_add_u32 v72, 0x8000, v8
    v_add_u32 v76, 0xc000, v2
    v_add_u32 v77, 0xc000, v3
    v_xor_b32 v73, 32, v72
    v_xor_b32 v74, 64, v72
    v_xor_b32 v75, 96, v72
    s_waitcnt lgkmcnt(0)
    s_barrier
    ds_read_b128 v[144:147], v72
    ds_read_b64_tr_b16 v[40:41], v76 offset:0
    ds_read_b64_tr_b16 v[42:43], v76 offset:512
    ds_read_b64_tr_b16 v[44:45], v77 offset:0
    ds_read_b64_tr_b16 v[46:47], v77 offset:512
    ds_read_b128 v[148:151], v73
    ds_read_b128 v[152:155], v74
    ds_read_b128 v[156:159], v75
    v_mfma_f32_32x32x16_bf16 v[96:111], v[80:83], v[136:139], v[96:111]
    v_mfma_f32_32x32x16_bf16 v[112:127], v[84:87], v[136:139], v[112:127]
    ds_read_b64_tr_b16 v[80:81], v76 offset:4096
    ds_read_b64_tr_b16 v[82:83], v76 offset:4608
    ds_read_b64_tr_b16 v[84:85], v77 offset:4096
    ds_read_b64_tr_b16 v[86:87], v77 offset:4608
    v_mfma_f32_32x32x16_bf16 v[96:111], v[32:35], v[140:143], v[96:111]
    v_mfma_f32_32x32x16_bf16 v[112:127], v[36:39], v[140:143], v[112:127]
    v_add_u32 v48, 0x10000, v8
    v_add_u32 v4, 0x14000, v2
    v_add_u32 v5, 0x14000, v3
    v_xor_b32 v49, 32, v48
    ds_read_b64_tr_b16 v[32:33], v76 offset:8192
    ds_read_b64_tr_b16 v[34:35], v76 offset:8704
    ds_read_b64_tr_b16 v[36:37], v77 offset:8192
    ds_read_b64_tr_b16 v[38:39], v77 offset:8704
    s_waitcnt lgkmcnt(13)
    v_mfma_f32_32x32x16_bf16 v[96:111], v[40:43], v[144:147], v[96:111]
    v_xor_b32 v50, 64, v48
    v_xor_b32 v51, 96, v48
    s_lshl_b32 s4, s88, 2
    s_add_u32 s4, s4, s92
    s_bitcmp1_b32 s4, 4
    s_cselect_b32 s76, s16, s14
    s_cselect_b32 s77, s17, s15
    s_waitcnt lgkmcnt(11)
    v_mfma_f32_32x32x16_bf16 v[112:127], v[44:47], v[144:147], v[112:127]
    s_mov_b32 s78, 0x80000
    s_mov_b32 s79, 0x20000
    s_lshr_b32 s5, s4, 5
    s_lshl_b32 s5, s5, 4
    s_and_b32 s4, s4, 15
    s_add_u32 s4, s4, s5
    s_lshl_b32 s5, s89, 5
    s_add_u32 s4, s4, s5
    s_lshl_b32 s96, s4, 10
    v_lshlrev_b32 v11, 4, v0
    ds_read_b64_tr_b16 v[40:41], v76 offset:12288
    ds_read_b64_tr_b16 v[42:43], v76 offset:12800
    ds_read_b64_tr_b16 v[44:45], v77 offset:12288
    ds_read_b64_tr_b16 v[46:47], v77 offset:12800
    s_waitcnt lgkmcnt(10)
    v_mfma_f32_32x32x16_bf16 v[96:111], v[80:83], v[148:151], v[96:111]
    s_waitcnt lgkmcnt(8)
    v_mfma_f32_32x32x16_bf16 v[112:127], v[84:87], v[148:151], v[112:127]
    buffer_load_dwordx4 v[88:91], v11, s[76:79], s96 offen
    v_and_b32 v12, 31, v0
    s_lshl_b32 s4, s89, 5
    v_add_u32 v12, s4, v12
    v_lshlrev_b32 v12, 1, v12
    global_load_ushort v52, v12, s[10:11]
    global_load_ushort v53, v12, s[12:13]
    global_load_ushort v54, v12, s[22:23]
    s_waitcnt lgkmcnt(0)
    s_barrier
    ds_read_b128 v[160:163], v48
    ds_read_b64_tr_b16 v[80:81], v4 offset:0
    ds_read_b64_tr_b16 v[82:83], v4 offset:512
    ds_read_b64_tr_b16 v[84:85], v5 offset:0
    ds_read_b64_tr_b16 v[86:87], v5 offset:512
    ds_read_b128 v[164:167], v49
    ds_read_b128 v[168:171], v50
    ds_read_b128 v[172:175], v51
    v_mfma_f32_32x32x16_bf16 v[96:111], v[32:35], v[152:155], v[96:111]
    v_mfma_f32_32x32x16_bf16 v[112:127], v[36:39], v[152:155], v[112:127]
    ds_read_b64_tr_b16 v[32:33], v4 offset:4096
    ds_read_b64_tr_b16 v[34:35], v4 offset:4608
    ds_read_b64_tr_b16 v[36:37], v5 offset:4096
    ds_read_b64_tr_b16 v[38:39], v5 offset:4608
    v_mfma_f32_32x32x16_bf16 v[96:111], v[40:43], v[156:159], v[96:111]
    v_mfma_f32_32x32x16_bf16 v[112:127], v[44:47], v[156:159], v[112:127]
    v_add_u32 v72, 0x18000, v8
    v_add_u32 v76, 0x1c000, v2
    v_add_u32 v77, 0x1c000, v3
    v_xor_b32 v73, 32, v72
    ds_read_b64_tr_b16 v[40:41], v4 offset:8192
    ds_read_b64_tr_b16 v[42:43], v4 offset:8704
    ds_read_b64_tr_b16 v[44:45], v5 offset:8192
    ds_read_b64_tr_b16 v[46:47], v5 offset:8704
    s_waitcnt lgkmcnt(13)
    v_mfma_f32_32x32x16_bf16 v[96:111], v[80:83], v[160:163], v[96:111]
    v_xor_b32 v74, 64, v72
    v_xor_b32 v75, 96, v72
    s_lshl_b32 s4, s89, 16
    s_add_u32 s9, s4, 0x100000
    s_lshl_b32 s5, s92, 9
    s_add_u32 s27, s9, s5
    v_and_b32 v60, 31, v0
    s_waitcnt lgkmcnt(11)
    v_mfma_f32_32x32x16_bf16 v[112:127], v[84:87], v[160:163], v[112:127]
    v_lshlrev_b32 v60, 4, v60
    v_lshrrev_b32 v12, 5, v0
    v_lshl_add_u32 v60, v12, 12, v60
    v_and_b32 v63, 31, v0
    ds_read_b64_tr_b16 v[80:81], v4 offset:12288
    ds_read_b64_tr_b16 v[82:83], v4 offset:12800
    ds_read_b64_tr_b16 v[84:85], v5 offset:12288
    ds_read_b64_tr_b16 v[86:87], v5 offset:12800
    s_waitcnt lgkmcnt(10)
    v_mfma_f32_32x32x16_bf16 v[96:111], v[32:35], v[164:167], v[96:111]
    s_lshl_b32 s4, s92, 5
    v_add_u32 v63, s4, v63
    s_lshl_b32 s4, s88, 11
    s_add_u32 s4, s4, 0x8000
    v_lshl_add_u32 v62, v63, 4, s4
    s_waitcnt lgkmcnt(8)
    v_mfma_f32_32x32x16_bf16 v[112:127], v[36:39], v[164:167], v[112:127]
    buffer_load_dwordx4 v[56:59], v62, s[60:63], 0 offen sc0 sc1
    s_add_u32 s8, s27, 0
    buffer_load_dwordx4 v[224:227], v60, s[60:63], s8 offen sc0 sc1
    s_add_u32 s8, s27, 8192
    buffer_load_dwordx4 v[228:231], v60, s[60:63], s8 offen sc0 sc1
    s_add_u32 s8, s27, 16384
    buffer_load_dwordx4 v[232:235], v60, s[60:63], s8 offen sc0 sc1
    s_add_u32 s8, s27, 24576
    buffer_load_dwordx4 v[236:239], v60, s[60:63], s8 offen sc0 sc1
    s_waitcnt lgkmcnt(0)
    s_barrier
    ds_read_b128 v[176:179], v72
    ds_read_b64_tr_b16 v[32:33], v76 offset:0
    ds_read_b64_tr_b16 v[34:35], v76 offset:512
    ds_read_b64_tr_b16 v[36:37], v77 offset:0
    ds_read_b64_tr_b16 v[38:39], v77 offset:512
    ds_read_b128 v[180:183], v73
    ds_read_b128 v[184:187], v74
    ds_read_b128 v[188:191], v75
    v_mfma_f32_32x32x16_bf16 v[96:111], v[40:43], v[168:171], v[96:111]
    v_mfma_f32_32x32x16_bf16 v[112:127], v[44:47], v[168:171], v[112:127]
    ds_read_b64_tr_b16 v[40:41], v76 offset:4096
    ds_read_b64_tr_b16 v[42:43], v76 offset:4608
    ds_read_b64_tr_b16 v[44:45], v77 offset:4096
    ds_read_b64_tr_b16 v[46:47], v77 offset:4608
    v_mfma_f32_32x32x16_bf16 v[96:111], v[80:83], v[172:175], v[96:111]
    v_mfma_f32_32x32x16_bf16 v[112:127], v[84:87], v[172:175], v[112:127]
    v_add_u32 v48, 0x20000, v8
    v_add_u32 v4, 0x0, v2
    v_add_u32 v5, 0x0, v3
    v_xor_b32 v49, 32, v48
    ds_read_b64_tr_b16 v[80:81], v76 offset:8192
    ds_read_b64_tr_b16 v[82:83], v76 offset:8704
    ds_read_b64_tr_b16 v[84:85], v77 offset:8192
    ds_read_b64_tr_b16 v[86:87], v77 offset:8704
    s_waitcnt lgkmcnt(13)
    v_mfma_f32_32x32x16_bf16 v[96:111], v[32:35], v[176:179], v[96:111]
    v_xor_b32 v50, 64, v48
    v_xor_b32 v51, 96, v48
    s_waitcnt lgkmcnt(11)
    v_mfma_f32_32x32x16_bf16 v[112:127], v[36:39], v[176:179], v[112:127]
    ds_read_b64_tr_b16 v[32:33], v76 offset:12288
    ds_read_b64_tr_b16 v[34:35], v76 offset:12800
    ds_read_b64_tr_b16 v[36:37], v77 offset:12288
    ds_read_b64_tr_b16 v[38:39], v77 offset:12800
    s_waitcnt lgkmcnt(10)
    v_mfma_f32_32x32x16_bf16 v[96:111], v[40:43], v[180:183], v[96:111]
    s_waitcnt lgkmcnt(8)
    v_mfma_f32_32x32x16_bf16 v[112:127], v[44:47], v[180:183], v[112:127]
    s_add_u32 s8, s27, 32768
    buffer_load_dwordx4 v[240:243], v60, s[60:63], s8 offen sc0 sc1
    s_add_u32 s8, s27, 40960
    buffer_load_dwordx4 v[244:247], v60, s[60:63], s8 offen sc0 sc1
    s_add_u32 s8, s27, 49152
    buffer_load_dwordx4 v[248:251], v60, s[60:63], s8 offen sc0 sc1
    s_add_u32 s8, s27, 57344
    buffer_load_dwordx4 v[252:255], v60, s[60:63], s8 offen sc0 sc1
    s_lshr_b32 s6, s92, 1
    s_and_b32 s7, s92, 1
    s_lshl_b32 s4, s6, 13
    v_lshlrev_b32 v26, 4, v0
    v_add_u32 v26, s4, v26
    v_lshrrev_b32 v10, 5, v0
    v_lshlrev_b32 v10, 10, v10
    v_bfe_u32 v11, v0, 2, 2
    v_lshl_add_u32 v10, v11, 7, v10
    v_bfe_u32 v11, v0, 3, 1
    v_xor_b32 v11, s7, v11
    v_lshl_add_u32 v10, v11, 6, v10
    v_bfe_u32 v11, v0, 4, 1
    v_lshl_add_u32 v10, v11, 5, v10
    v_and_b32 v11, 3, v0
    v_lshl_add_u32 v29, v11, 3, v10
    v_and_b32 v10, 31, v0
    s_lshl_b32 s4, s7, 5
    v_add_u32 v10, s4, v10
    v_lshlrev_b32 v10, 7, v10
    v_bfe_u32 v11, v0, 1, 3
    v_lshrrev_b32 v12, 5, v0
    v_xor_b32 v11, v11, v12
    v_lshl_add_u32 v30, v11, 4, v10
    s_waitcnt lgkmcnt(0)
    s_barrier
    ds_read_b128 v[192:195], v48
    ds_read_b64_tr_b16 v[40:41], v4 offset:0
    ds_read_b64_tr_b16 v[42:43], v4 offset:512
    ds_read_b64_tr_b16 v[44:45], v5 offset:0
    ds_read_b64_tr_b16 v[46:47], v5 offset:512
    ds_read_b128 v[196:199], v49
    ds_read_b128 v[200:203], v50
    ds_read_b128 v[204:207], v51
    v_mfma_f32_32x32x16_bf16 v[96:111], v[80:83], v[184:187], v[96:111]
    v_mfma_f32_32x32x16_bf16 v[112:127], v[84:87], v[184:187], v[112:127]
    ds_read_b64_tr_b16 v[80:81], v4 offset:4096
    ds_read_b64_tr_b16 v[82:83], v4 offset:4608
    ds_read_b64_tr_b16 v[84:85], v5 offset:4096
    ds_read_b64_tr_b16 v[86:87], v5 offset:4608
    v_mfma_f32_32x32x16_bf16 v[96:111], v[32:35], v[188:191], v[96:111]
    v_mfma_f32_32x32x16_bf16 v[112:127], v[36:39], v[188:191], v[112:127]
    v_add_u32 v72, 0x4000, v8
    v_add_u32 v76, 0x8000, v2
    v_add_u32 v77, 0x8000, v3
    v_xor_b32 v73, 32, v72
    ds_read_b64_tr_b16 v[32:33], v4 offset:8192
    ds_read_b64_tr_b16 v[34:35], v4 offset:8704
    ds_read_b64_tr_b16 v[36:37], v5 offset:8192
    ds_read_b64_tr_b16 v[38:39], v5 offset:8704
    s_waitcnt lgkmcnt(13)
    v_mfma_f32_32x32x16_bf16 v[96:111], v[40:43], v[192:195], v[96:111]
    v_xor_b32 v74, 64, v72
    v_xor_b32 v75, 96, v72
    s_waitcnt vmcnt(12)
    v_lshlrev_b32 v92, 16, v88
    v_and_b32 v88, 0xffff0000, v88
    s_waitcnt lgkmcnt(11)
    v_mfma_f32_32x32x16_bf16 v[112:127], v[44:47], v[192:195], v[112:127]
    v_add_f32 v88, v88, v92
    v_lshlrev_b32 v92, 16, v89
    v_and_b32 v89, 0xffff0000, v89
    v_add_f32 v89, v89, v92
    ds_read_b64_tr_b16 v[40:41], v4 offset:12288
    ds_read_b64_tr_b16 v[42:43], v4 offset:12800
    ds_read_b64_tr_b16 v[44:45], v5 offset:12288
    ds_read_b64_tr_b16 v[46:47], v5 offset:12800
    s_waitcnt lgkmcnt(10)
    v_mfma_f32_32x32x16_bf16 v[96:111], v[80:83], v[196:199], v[96:111]
    v_lshlrev_b32 v92, 16, v90
    v_and_b32 v90, 0xffff0000, v90
    v_add_f32 v90, v90, v92
    v_lshlrev_b32 v92, 16, v91
    s_waitcnt lgkmcnt(8)
    v_mfma_f32_32x32x16_bf16 v[112:127], v[84:87], v[196:199], v[112:127]
    v_and_b32 v91, 0xffff0000, v91
    v_add_f32 v91, v91, v92
    v_add_f32 v88, v88, v89
    v_add_f32 v90, v90, v91
    s_waitcnt lgkmcnt(0)
    s_barrier
    ds_read_b128 v[208:211], v72
    ds_read_b64_tr_b16 v[80:81], v76 offset:0
    ds_read_b64_tr_b16 v[82:83], v76 offset:512
    ds_read_b64_tr_b16 v[84:85], v77 offset:0
    ds_read_b64_tr_b16 v[86:87], v77 offset:512
    ds_read_b128 v[212:215], v73
    ds_read_b128 v[216:219], v74
    ds_read_b128 v[220:223], v75
    v_mfma_f32_32x32x16_bf16 v[96:111], v[32:35], v[200:203], v[96:111]
    v_mfma_f32_32x32x16_bf16 v[112:127], v[36:39], v[200:203], v[112:127]
    ds_read_b64_tr_b16 v[32:33], v76 offset:4096
    ds_read_b64_tr_b16 v[34:35], v76 offset:4608
    ds_read_b64_tr_b16 v[36:37], v77 offset:4096
    ds_read_b64_tr_b16 v[38:39], v77 offset:4608
    v_mfma_f32_32x32x16_bf16 v[96:111], v[40:43], v[204:207], v[96:111]
    v_mfma_f32_32x32x16_bf16 v[112:127], v[44:47], v[204:207], v[112:127]
    v_add_u32 v48, 0xc000, v8
    v_add_u32 v4, 0x10000, v2
    v_add_u32 v5, 0x10000, v3
    v_xor_b32 v49, 32, v48
    ds_read_b64_tr_b16 v[40:41], v76 offset:8192
    ds_read_b64_tr_b16 v[42:43], v76 offset:8704
    ds_read_b64_tr_b16 v[44:45], v77 offset:8192
    ds_read_b64_tr_b16 v[46:47], v77 offset:8704
    s_waitcnt lgkmcnt(13)
    v_mfma_f32_32x32x16_bf16 v[96:111], v[80:83], v[208:211], v[96:111]
    v_xor_b32 v50, 64, v48
    v_xor_b32 v51, 96, v48
    v_add_f32 v92, v88, v90
    s_nop 1
    v_add_f32_dpp v92, v92, v92 row_ror:8 row_mask:0xf bank_mask:0xf
    s_waitcnt lgkmcnt(11)
    v_mfma_f32_32x32x16_bf16 v[112:127], v[84:87], v[208:211], v[112:127]
    v_add_f32_dpp v92, v92, v92 row_ror:4 row_mask:0xf bank_mask:0xf
    s_nop 1
    v_add_f32_dpp v92, v92, v92 row_ror:2 row_mask:0xf bank_mask:0xf
    s_nop 1
    v_add_f32_dpp v92, v92, v92 row_ror:1 row_mask:0xf bank_mask:0xf
    v_mov_b32 v93, v92
    ds_read_b64_tr_b16 v[80:81], v76 offset:12288
    ds_read_b64_tr_b16 v[82:83], v76 offset:12800
    ds_read_b64_tr_b16 v[84:85], v77 offset:12288
    ds_read_b64_tr_b16 v[86:87], v77 offset:12800
    s_waitcnt lgkmcnt(10)
    v_mfma_f32_32x32x16_bf16 v[96:111], v[32:35], v[212:215], v[96:111]
    v_permlane16_swap_b32 v92, v93
    v_add_f32 v92, v92, v93
    v_mov_b32 v93, v92
    s_nop 1
    v_permlane32_swap_b32 v92, v93
    s_waitcnt lgkmcnt(8)
    v_mfma_f32_32x32x16_bf16 v[112:127], v[36:39], v[212:215], v[112:127]
    v_add_f32 v92, v92, v93
    s_lshl_b32 s4, s89, 16
    s_lshl_b32 s5, s88, 12
    s_add_u32 s4, s4, s5
    s_add_u32 s6, s4, 0x100000
    v_mov_b32 v10, 0
    v_mov_b32 v11, 0x7ff00000
    v_cmp_eq_u32 vcc, 0, v0
    s_nop 1
    v_cndmask_b32 v10, v11, v10, vcc
    s_lshl_b32 s5, s92, 3
    s_add_u32 s95, s6, s5
    s_add_u32 s95, s95, 2048
    v_mov_b32 v93, s26
    buffer_store_dwordx2 v[92:93], v10, s[60:63], s95 offen sc0 sc1
    s_mov_b32 s97, 400000
    s_waitcnt vmcnt(1)
    v_mov_b32 v64, v255
    v_xor_b32 v64, s26, v225
    v_xor_b32 v65, s26, v227
    v_or_b32 v64, v64, v65
    v_xor_b32 v65, s26, v229
    v_or_b32 v64, v64, v65
    v_xor_b32 v65, s26, v231
    v_or_b32 v64, v64, v65
    v_xor_b32 v65, s26, v233
    v_or_b32 v64, v64, v65
    v_xor_b32 v65, s26, v235
    v_or_b32 v64, v64, v65
    v_xor_b32 v65, s26, v237
    v_or_b32 v64, v64, v65
    v_xor_b32 v65, s26, v239
    v_or_b32 v64, v64, v65
    v_xor_b32 v65, s26, v241
    v_or_b32 v64, v64, v65
    v_xor_b32 v65, s26, v243
    v_or_b32 v64, v64, v65
    v_xor_b32 v65, s26, v245
    v_or_b32 v64, v64, v65
    v_xor_b32 v65, s26, v247
    v_or_b32 v64, v64, v65
    v_xor_b32 v65, s26, v249
    v_or_b32 v64, v64, v65
    v_xor_b32 v65, s26, v251
    v_or_b32 v64, v64, v65
    v_xor_b32 v65, s26, v253
    v_or_b32 v64, v64, v65
    v_xor_b32 v65, s26, v255
    v_or_b32 v64, v64, v65
    v_xor_b32 v65, s26, v57
    v_or_b32 v64, v64, v65
    v_xor_b32 v65, s26, v59
    v_or_b32 v64, v64, v65
    v_cmp_eq_u32 vcc, 0, v64
    s_nop 4
    s_cmp_eq_u64 vcc, exec
    s_cbranch_scc1 L_tabd20
L_tab19:
    s_sub_u32 s97, s97, 1
    s_sleep 1
    s_add_u32 s8, s27, 0
    buffer_load_dwordx4 v[224:227], v60, s[60:63], s8 offen sc0 sc1
    s_add_u32 s8, s27, 8192
    buffer_load_dwordx4 v[228:231], v60, s[60:63], s8 offen sc0 sc1
    s_add_u32 s8, s27, 16384
    buffer_load_dwordx4 v[232:235], v60, s[60:63], s8 offen sc0 sc1
    s_add_u32 s8, s27, 24576
    buffer_load_dwordx4 v[236:239], v60, s[60:63], s8 offen sc0 sc1
    s_add_u32 s8, s27, 32768
    buffer_load_dwordx4 v[240:243], v60, s[60:63], s8 offen sc0 sc1
    s_add_u32 s8, s27, 40960
    buffer_load_dwordx4 v[244:247], v60, s[60:63], s8 offen sc0 sc1
    s_add_u32 s8, s27, 49152
    buffer_load_dwordx4 v[248:251], v60, s[60:63], s8 offen sc0 sc1
    s_add_u32 s8, s27, 57344
    buffer_load_dwordx4 v[252:255], v60, s[60:63], s8 offen sc0 sc1
    buffer_load_dwordx4 v[56:59], v62, s[60:63], 0 offen sc0 sc1
    s_waitcnt vmcnt(0)
    v_xor_b32 v64, s26, v225
    v_xor_b32 v65, s26, v227
    v_or_b32 v64, v64, v65
    v_xor_b32 v65, s26, v229
    v_or_b32 v64, v64, v65
    v_xor_b32 v65, s26, v231
    v_or_b32 v64, v64, v65
    v_xor_b32 v65, s26, v233
    v_or_b32 v64, v64, v65
    v_xor_b32 v65, s26, v235
    v_or_b32 v64, v64, v65
    v_xor_b32 v65, s26, v237
    v_or_b32 v64, v64, v65
    v_xor_b32 v65, s26, v239
    v_or_b32 v64, v64, v65
    v_xor_b32 v65, s26, v241
    v_or_b32 v64, v64, v65
    v_xor_b32 v65, s26, v243
    v_or_b32 v64, v64, v65
    v_xor_b32 v65, s26, v245
    v_or_b32 v64, v64, v65
    v_xor_b32 v65, s26, v247
    v_or_b32 v64, v64, v65
    v_xor_b32 v65, s26, v249
    v_or_b32 v64, v64, v65
    v_xor_b32 v65, s26, v251
    v_or_b32 v64, v64, v65
    v_xor_b32 v65, s26, v253
    v_or_b32 v64, v64, v65
    v_xor_b32 v65, s26, v255
    v_or_b32 v64, v64, v65
    v_xor_b32 v65, s26, v57
    v_or_b32 v64, v64, v65
    v_xor_b32 v65, s26, v59
    v_or_b32 v64, v64, v65
    v_cmp_eq_u32 vcc, 0, v64
    s_nop 4
    s_cmp_eq_u64 vcc, exec
    s_cbranch_scc1 L_tabd20
    s_cmp_lg_u32 s97, 0
    s_cbranch_scc1 L_tab19
L_tabd20:
    s_nop 4
    v_add_f32 v224, v224, v228
    v_add_f32 v232, v232, v236
    v_add_f32 v240, v240, v244
    v_add_f32 v248, v248, v252
    v_add_f32 v224, v224, v232
    v_add_f32 v240, v240, v248
    v_add_f32 v64, v224, v240
    v_add_f32 v226, v226, v230
    v_add_f32 v234, v234, v238
    v_add_f32 v242, v242, v246
    v_add_f32 v250, v250, v254
    v_add_f32 v226, v226, v234
    v_add_f32 v242, v242, v250
    v_add_f32 v65, v226, v242
    s_nop 1
    v_permlane32_swap_b32 v64, v65
    v_add_f32 v64, v64, v65
    v_and_b32 v12, 31, v0
    v_lshlrev_b32 v12, 1, v12
    v_lshrrev_b32 v13, 5, v0
    v_add_u32 v12, v12, v13
    v_and_b32 v10, 3, v12
    v_bfe_u32 v11, v12, 3, 1
    v_lshl_add_u32 v10, v11, 2, v10
    v_bfe_u32 v11, v12, 2, 1
    v_lshl_add_u32 v10, v11, 3, v10
    v_lshlrev_b32 v10, 3, v10
    v_lshrrev_b32 v11, 4, v12
    v_lshl_add_u32 v10, v11, 8, v10
    s_lshr_b32 s4, s92, 1
    s_lshl_b32 s4, s4, 10
    s_and_b32 s5, s92, 1
    s_lshl_b32 s5, s5, 7
    s_add_u32 s4, s4, s5
    s_add_u32 s4, s4, 0x24000
    v_add_u32 v10, s4, v10
    v_cvt_pk_bf16_f32 v67, v64, 0
    v_lshlrev_b32 v68, 16, v67
    v_sub_f32 v68, v64, v68
    v_cvt_pk_bf16_f32 v68, v68, 0
    v_lshl_or_b32 v66, v68, 16, v67
    ds_write_b64 v10, v[66:67]
    v_lshlrev_b32 v63, 2, v63
    v_add_u32 v63, 0x24a00, v63
    ds_write_b32 v63, v56
    ds_write_b32 v63, v58 offset:512
    s_waitcnt lgkmcnt(0)
    s_barrier
    ds_read_b128 v[224:227], v48
    ds_read_b64_tr_b16 v[32:33], v4 offset:0
    ds_read_b64_tr_b16 v[34:35], v4 offset:512
    ds_read_b64_tr_b16 v[36:37], v5 offset:0
    ds_read_b64_tr_b16 v[38:39], v5 offset:512
    ds_read_b128 v[228:231], v49
    ds_read_b128 v[232:235], v50
    ds_read_b128 v[236:239], v51
    v_mfma_f32_32x32x16_bf16 v[96:111], v[40:43], v[216:219], v[96:111]
    v_mfma_f32_32x32x16_bf16 v[112:127], v[44:47], v[216:219], v[112:127]
    ds_read_b64_tr_b16 v[40:41], v4 offset:4096
    ds_read_b64_tr_b16 v[42:43], v4 offset:4608
    ds_read_b64_tr_b16 v[44:45], v5 offset:4096
    ds_read_b64_tr_b16 v[46:47], v5 offset:4608
    v_mfma_f32_32x32x16_bf16 v[96:111], v[80:83], v[220:223], v[96:111]
    v_mfma_f32_32x32x16_bf16 v[112:127], v[84:87], v[220:223], v[112:127]
    v_add_u32 v72, 0x14000, v8
    v_add_u32 v76, 0x18000, v2
    v_add_u32 v77, 0x18000, v3
    v_xor_b32 v73, 32, v72
    ds_read_b64_tr_b16 v[80:81], v4 offset:8192
    ds_read_b64_tr_b16 v[82:83], v4 offset:8704
    ds_read_b64_tr_b16 v[84:85], v5 offset:8192
    ds_read_b64_tr_b16 v[86:87], v5 offset:8704
    s_waitcnt lgkmcnt(13)
    v_mfma_f32_32x32x16_bf16 v[96:111], v[32:35], v[224:227], v[96:111]
    v_xor_b32 v74, 64, v72
    v_xor_b32 v75, 96, v72
    v_mov_b32 v11, 0x7ff00000
    s_lshl_b32 s7, s88, 4
    s_add_u32 s7, s7, s89
    s_mul_i32 s5, s7, 56
    s_waitcnt lgkmcnt(11)
    v_mfma_f32_32x32x16_bf16 v[112:127], v[36:39], v[224:227], v[112:127]
    s_mul_i32 s6, s92, 14
    s_add_u32 s5, s5, s6
    v_add_u32 v10, s5, v0
    v_lshlrev_b32 v10, 7, v10
    v_cmp_gt_u32 vcc, 14, v0
    ds_read_b64_tr_b16 v[32:33], v4 offset:12288
    ds_read_b64_tr_b16 v[34:35], v4 offset:12800
    ds_read_b64_tr_b16 v[36:37], v5 offset:12288
    ds_read_b64_tr_b16 v[38:39], v5 offset:12800
    s_waitcnt lgkmcnt(10)
    v_mfma_f32_32x32x16_bf16 v[96:111], v[40:43], v[228:231], v[96:111]
    v_cndmask_b32 v10, v11, v10, vcc
    s_mov_b32 s84, s32
    s_mov_b32 s85, s33
    s_mov_b32 s86, 0x1c0000
    s_mov_b32 s87, 0x20000
    s_waitcnt lgkmcnt(8)
    v_mfma_f32_32x32x16_bf16 v[112:127], v[44:47], v[228:231], v[112:127]
    buffer_load_dword v92, v10, s[84:87], 0 offen
    s_lshl_b32 s5, s7, 4
    s_and_b32 s6, s92, 1
    s_lshl_b32 s6, s6, 3
    s_add_u32 s5, s5, s6
    v_add_u32 v10, s5, v0
    v_lshlrev_b32 v10, 7, v10
    v_cmp_gt_u32 vcc, 8, v0
    s_nop 1
    v_cndmask_b32 v10, v11, v10, vcc
    s_and_b32 s4, s92, 2
    s_cmp_eq_u32 s4, 0
    s_cselect_b32 s84, s18, s20
    s_cselect_b32 s85, s19, s21
    s_mov_b32 s86, 0x80000
    s_mov_b32 s87, 0x20000
    buffer_load_dword v93, v10, s[84:87], 0 offen
    s_and_b32 s6, s92, 1
    s_lshl_b32 s4, s89, 13
    s_lshl_b32 s5, s6, 8
    s_add_u32 s4, s4, s5
    s_add_u32 s4, s4, 0x10000
    v_lshrrev_b32 v12, 4, v0
    v_and_b32 v13, 15, v0
    v_lshlrev_b32 v13, 4, v13
    v_lshl_add_u32 v13, v12, 9, v13
    v_add_u32 v28, s4, v13
    v_lshlrev_b32 v52, 16, v52
    v_lshlrev_b32 v53, 16, v53
    v_lshlrev_b32 v54, 16, v54
    v_mul_f32 v54, 0x3fb8aa3b, v54
    v_exp_f32 v54, v54
    v_and_b32 v12, 31, v0
    v_lshlrev_b32 v12, 6, v12
    v_cvt_pk_bf16_f32 v54, v54, v54
    v_and_b32 v54, 0xffff0000, v54
    v_mul_f32 v56, v54, v52
    v_mul_f32 v57, v54, v53
    v_mul_f32 v56, 0x3fb8aa3b, v56
    v_mul_f32 v57, 0x3e22f983, v57
    v_exp_f32 v68, v56
    v_cos_f32 v58, v57
    v_sin_f32 v59, v57
    v_add_u32 v12, 0x24e00, v12
    v_mul_f32 v58, v58, v68
    v_mul_f32 v59, v59, v68
    v_add_f32 v68, -1.0, v58
    v_mul_f32 v60, v68, v52
    v_fmac_f32 v60, v59, v53
    v_mul_f32 v61, v59, v52
    v_fma_f32 v61, -v68, v53, v61
    v_mul_f32 v68, v52, v52
    v_fmac_f32 v68, v53, v53
    v_rcp_f32 v68, v68
    ds_write_b128 v12, v[56:59]
    v_add_f32 v68, v68, v68
    v_mul_f32 v60, v60, v68
    v_mul_f32 v61, v61, v68
    v_mul_f32 v68, 0x41000000, v56
    v_mul_f32 v63, 0x41000000, v57
    v_exp_f32 v68, v68
    v_fract_f32 v63, v63
    v_cos_f32 v62, v63
    v_sin_f32 v63, v63
    v_mov_b32 v69, v68
    v_mul_f32 v62, v62, v69
    v_mul_f32 v63, v63, v69
    v_mul_f32 v68, 0x41800000, v56
    v_mul_f32 v65, 0x41800000, v57
    v_exp_f32 v68, v68
    v_fract_f32 v65, v65
    v_cos_f32 v64, v65
    v_sin_f32 v65, v65
    v_mov_b32 v69, v68
    v_mul_f32 v64, v64, v69
    v_mul_f32 v65, v65, v69
    v_mul_f32 v68, 0x42000000, v56
    v_mul_f32 v67, 0x42000000, v57
    v_exp_f32 v68, v68
    v_fract_f32 v67, v67
    v_cos_f32 v66, v67
    v_sin_f32 v67, v67
    v_mov_b32 v69, v68
    v_mul_f32 v66, v66, v69
    v_mul_f32 v67, v67, v69
    ds_write_b128 v12, v[60:63] offset:16
    ds_write_b128 v12, v[64:67] offset:32
    s_waitcnt lgkmcnt(0)
    s_barrier
    ds_read_b128 v[240:243], v72
    ds_read_b64_tr_b16 v[40:41], v76 offset:0
    ds_read_b64_tr_b16 v[42:43], v76 offset:512
    ds_read_b64_tr_b16 v[44:45], v77 offset:0
    ds_read_b64_tr_b16 v[46:47], v77 offset:512
    ds_read_b128 v[244:247], v73
    ds_read_b128 v[248:251], v74
    ds_read_b128 v[252:255], v75
    v_mfma_f32_32x32x16_bf16 v[96:111], v[80:83], v[232:235], v[96:111]
    v_mfma_f32_32x32x16_bf16 v[112:127], v[84:87], v[232:235], v[112:127]
    ds_read_b64_tr_b16 v[80:81], v76 offset:4096
    ds_read_b64_tr_b16 v[82:83], v76 offset:4608
    ds_read_b64_tr_b16 v[84:85], v77 offset:4096
    ds_read_b64_tr_b16 v[86:87], v77 offset:4608
    v_mfma_f32_32x32x16_bf16 v[96:111], v[32:35], v[236:239], v[96:111]
    v_mfma_f32_32x32x16_bf16 v[112:127], v[36:39], v[236:239], v[112:127]
    s_lshl_b32 s4, s89, 16
    s_add_u32 s4, s4, 0x100800
    v_lshrrev_b32 v70, 2, v0
    v_lshlrev_b32 v70, 12, v70
    v_and_b32 v12, 3, v0
    v_lshl_add_u32 v70, v12, 3, v70
    ds_read_b64_tr_b16 v[32:33], v76 offset:8192
    ds_read_b64_tr_b16 v[34:35], v76 offset:8704
    ds_read_b64_tr_b16 v[36:37], v77 offset:8192
    ds_read_b64_tr_b16 v[38:39], v77 offset:8704
    s_waitcnt lgkmcnt(13)
    v_mfma_f32_32x32x16_bf16 v[96:111], v[40:43], v[240:243], v[96:111]
    v_add_u32 v70, s4, v70
    s_waitcnt lgkmcnt(11)
    v_mfma_f32_32x32x16_bf16 v[112:127], v[44:47], v[240:243], v[112:127]
    ds_read_b64_tr_b16 v[40:41], v76 offset:12288
    ds_read_b64_tr_b16 v[42:43], v76 offset:12800
    ds_read_b64_tr_b16 v[44:45], v77 offset:12288
    ds_read_b64_tr_b16 v[46:47], v77 offset:12800
    s_waitcnt lgkmcnt(10)
    v_mfma_f32_32x32x16_bf16 v[96:111], v[80:83], v[244:247], v[96:111]
    s_waitcnt lgkmcnt(8)
    v_mfma_f32_32x32x16_bf16 v[112:127], v[84:87], v[244:247], v[112:127]
    s_waitcnt lgkmcnt(6)
    v_mfma_f32_32x32x16_bf16 v[96:111], v[32:35], v[248:251], v[96:111]
    s_waitcnt lgkmcnt(4)
    v_mfma_f32_32x32x16_bf16 v[112:127], v[36:39], v[248:251], v[112:127]
    s_waitcnt lgkmcnt(2)
    v_mfma_f32_32x32x16_bf16 v[96:111], v[40:43], v[252:255], v[96:111]
    s_waitcnt lgkmcnt(0)
    v_mfma_f32_32x32x16_bf16 v[112:127], v[44:47], v[252:255], v[112:127]
    buffer_load_dwordx2 v[78:79], v70, s[60:63], 0 offen sc0 sc1
    s_barrier
    s_mov_b32 s7, 0x1c000
    v_and_b32 v49, 31, v0
    v_lshrrev_b32 v50, 5, v0
    v_and_b32 v51, 15, v0
    v_xor_b32 v50, v50, v51
    v_lshlrev_b32 v50, 4, v50
    v_lshl_add_u32 v8, v49, 9, v50
    v_add_u32 v48, s7, v8
    v_xor_b32 v49, 0, v48
    ds_read_b128 v[32:35], v49
    v_xor_b32 v50, 32, v48
    ds_read_b128 v[36:39], v50
    v_xor_b32 v49, 64, v48
    ds_read_b128 v[40:43], v49
    v_xor_b32 v50, 96, v48
    ds_read_b128 v[44:47], v50
    s_waitcnt vmcnt(1) lgkmcnt(3)
    v_mfma_f32_32x32x16_bf16 v[80:95], v[128:131], v[32:35], 0
    v_xor_b32 v49, 128, v48
    ds_read_b128 v[32:35], v49
    s_waitcnt lgkmcnt(3)
    v_mfma_f32_32x32x16_bf16 v[80:95], v[132:135], v[36:39], v[80:95]
    v_xor_b32 v50, 160, v48
    ds_read_b128 v[36:39], v50
    s_waitcnt lgkmcnt(3)
    v_mfma_f32_32x32x16_bf16 v[80:95], v[136:139], v[40:43], v[80:95]
    v_xor_b32 v49, 192, v48
    ds_read_b128 v[40:43], v49
    s_waitcnt lgkmcnt(3)
    v_mfma_f32_32x32x16_bf16 v[80:95], v[140:143], v[44:47], v[80:95]
    s_lshl_b32 s6, s93, 9
    s_add_u32 s6, s6, 0x24000
    v_and_b32 v18, 31, v0
    v_lshlrev_b32 v18, 3, v18
    v_add_u32 v18, s6, v18
    ds_read_b64 v[56:57], v18
    v_mov_b32 v58, 0
    v_mov_b32 v59, 0
    v_xor_b32 v50, 224, v48
    ds_read_b128 v[44:47], v50
    s_waitcnt lgkmcnt(4)
    v_mfma_f32_32x32x16_bf16 v[80:95], v[144:147], v[32:35], v[80:95]
    s_lshl_b32 s6, s93, 9
    s_add_u32 s6, s6, 0x24100
    v_and_b32 v18, 31, v0
    v_lshlrev_b32 v18, 3, v18
    v_add_u32 v18, s6, v18
    ds_read_b64 v[60:61], v18
    v_mov_b32 v62, 0
    v_mov_b32 v63, 0
    v_xor_b32 v49, 256, v48
    ds_read_b128 v[32:35], v49
    s_waitcnt lgkmcnt(5)
    v_mfma_f32_32x32x16_bf16 v[80:95], v[148:151], v[36:39], v[80:95]
    v_bfe_u32 v10, v0, 2, 1
    v_lshlrev_b32 v10, 4, v10
    v_bfe_u32 v11, v0, 3, 2
    v_xor_b32 v50, 288, v48
    ds_read_b128 v[36:39], v50
    s_waitcnt lgkmcnt(5)
    v_mfma_f32_32x32x16_bf16 v[80:95], v[152:155], v[40:43], v[80:95]
    v_lshl_add_u32 v10, v11, 2, v10
    v_and_b32 v11, 3, v0
    v_add_u32 v10, v10, v11
    s_lshl_b32 s4, s92, 5
    v_add_u32 v10, s4, v10
    v_xor_b32 v49, 320, v48
    ds_read_b128 v[40:43], v49
    s_waitcnt lgkmcnt(4)
    v_mfma_f32_32x32x16_bf16 v[80:95], v[156:159], v[44:47], v[80:95]
    v_lshlrev_b32 v10, 2, v10
    v_add_u32 v10, 0x24a00, v10
    ds_read_b32 v11, v10
    ds_read_b32 v12, v10 offset:512
    v_cmp_gt_u32 vcc, 32, v0
    v_mov_b32 v22, 0
    v_xor_b32 v50, 352, v48
    ds_read_b128 v[44:47], v50
    s_waitcnt lgkmcnt(5)
    v_mfma_f32_32x32x16_bf16 v[80:95], v[160:163], v[32:35], v[80:95]
    v_mov_b32 v23, 0
    s_waitcnt lgkmcnt(2)
    v_sub_f32 v11, 0, v11
    v_cvt_pk_bf16_f32 v20, v11, v11
    s_waitcnt lgkmcnt(1)
    v_mul_f32 v6, 0xbfb8aa3b, v12
    v_mul_f32 v7, v12, v12
    v_xor_b32 v49, 384, v48
    ds_read_b128 v[32:35], v49
    v_mfma_f32_32x32x16_bf16 v[80:95], v[164:167], v[36:39], v[80:95]
    v_and_b32 v13, 0xffff0000, v20
    v_sub_f32 v13, v11, v13
    v_rcp_f32 v7, v7
    v_cvt_pk_bf16_f32 v21, v13, 0
    v_xor_b32 v50, 416, v48
    ds_read_b128 v[36:39], v50
    v_mfma_f32_32x32x16_bf16 v[80:95], v[168:171], v[40:43], v[80:95]
    v_cndmask_b32 v20, 0, v20, vcc
    v_cndmask_b32 v21, 0, v21, vcc
    s_nop 1
    v_mfma_f32_32x32x16_bf16 v[96:111], v[56:59], v[20:23], v[96:111]
    v_mfma_f32_32x32x16_bf16 v[112:127], v[60:63], v[20:23], v[112:127]
    v_xor_b32 v49, 448, v48
    ds_read_b128 v[40:43], v49
    s_waitcnt lgkmcnt(3)
    v_mfma_f32_32x32x16_bf16 v[80:95], v[172:175], v[44:47], v[80:95]
    s_lshl_b32 s4, s89, 2
    s_lshl_b32 s5, s93, 1
    s_add_u32 s4, s4, s5
    s_add_u32 s4, s4, 0
    s_lshl_b32 s4, s4, 10
    s_mul_i32 s5, s88, 0xb0000
    s_add_u32 s4, s4, s5
    s_add_u32 s9, s4, 0x200000
    v_mul_f32 v10, v6, v96
    v_xor_b32 v50, 480, v48
    ds_read_b128 v[44:47], v50
    s_waitcnt lgkmcnt(3)
    v_mfma_f32_32x32x16_bf16 v[80:95], v[176:179], v[32:35], v[80:95]
    v_mul_f32 v11, v6, v97
    v_mul_f32 v12, v6, v98
    v_mul_f32 v13, v6, v99
    v_exp_f32 v10, v10
    s_waitcnt vmcnt(0)
    v_cmp_eq_u32 vcc, s26, v79
    s_nop 3
    s_cmp_eq_u64 vcc, exec
    s_cbranch_scc1 L_ssd22
    s_mov_b32 s97, 400000
L_ss21:
    s_sleep 1
    buffer_load_dwordx2 v[78:79], v70, s[60:63], 0 offen sc0 sc1
    s_waitcnt vmcnt(0)
    v_cmp_eq_u32 vcc, s26, v79
    s_nop 4
    s_cmp_eq_u64 vcc, exec
    s_cbranch_scc1 L_ssd22
    s_sub_u32 s97, s97, 1
    s_cmp_lg_u32 s97, 0
    s_cbranch_scc1 L_ss21
L_ssd22:
    s_nop 4
    v_cvt_pk_bf16_f32 v71, v78, 0
    v_lshlrev_b32 v69, 16, v71
    v_sub_f32 v69, v78, v69
    v_cvt_pk_bf16_f32 v69, v69, 0
    v_lshl_or_b32 v70, v69, 16, v71
    v_lshlrev_b32 v69, 3, v0
    v_add_u32 v69, 0x24800, v69
    ds_write_b64 v69, v[70:71]
    s_waitcnt lgkmcnt(0)
    s_barrier
    s_mov_b32 s7, 0x0
    v_add_u32 v48, s7, v8
    v_xor_b32 v49, 0, v48
    ds_read_b128 v[32:35], v49
    v_mfma_f32_32x32x16_bf16 v[80:95], v[180:183], v[36:39], v[80:95]
    v_xor_b32 v50, 32, v48
    ds_read_b128 v[36:39], v50
    v_mfma_f32_32x32x16_bf16 v[80:95], v[184:187], v[40:43], v[80:95]
    v_xor_b32 v49, 64, v48
    ds_read_b128 v[40:43], v49
    v_mfma_f32_32x32x16_bf16 v[80:95], v[188:191], v[44:47], v[80:95]
    v_xor_b32 v50, 96, v48
    ds_read_b128 v[44:47], v50
    s_waitcnt lgkmcnt(3)
    v_mfma_f32_32x32x16_bf16 v[80:95], v[192:195], v[32:35], v[80:95]
    s_lshl_b32 s6, s93, 8
    s_add_u32 s6, s6, 0x24800
    v_and_b32 v18, 31, v0
    v_lshlrev_b32 v18, 3, v18
    v_add_u32 v18, s6, v18
    ds_read_b64 v[64:65], v18
    v_mov_b32 v66, 0
    v_mov_b32 v67, 0
    v_xor_b32 v49, 128, v48
    ds_read_b128 v[32:35], v49
    s_waitcnt lgkmcnt(4)
    v_mfma_f32_32x32x16_bf16 v[80:95], v[196:199], v[36:39], v[80:95]
    v_exp_f32 v11, v11
    v_exp_f32 v12, v12
    v_xor_b32 v50, 160, v48
    ds_read_b128 v[36:39], v50
    s_waitcnt lgkmcnt(4)
    v_mfma_f32_32x32x16_bf16 v[80:95], v[200:203], v[40:43], v[80:95]
    v_exp_f32 v13, v13
    v_mul_f32 v14, v96, v104
    v_mul_f32 v15, v97, v105
    v_mul_f32 v16, v98, v106
    v_xor_b32 v49, 192, v48
    ds_read_b128 v[40:43], v49
    s_waitcnt lgkmcnt(4)
    v_mfma_f32_32x32x16_bf16 v[80:95], v[204:207], v[44:47], v[80:95]
    v_mul_f32 v17, v99, v107
    v_fma_f32 v10, v10, v7, v7
    v_fma_f32 v11, v11, v7, v7
    v_fma_f32 v12, v12, v7, v7
    v_fma_f32 v13, v13, v7, v7
    v_xor_b32 v50, 224, v48
    ds_read_b128 v[44:47], v50
    s_waitcnt lgkmcnt(3)
    v_mfma_f32_32x32x16_bf16 v[80:95], v[208:211], v[32:35], v[80:95]
    v_rcp_f32 v10, v10
    v_rcp_f32 v11, v11
    v_rcp_f32 v12, v12
    v_xor_b32 v49, 256, v48
    ds_read_b128 v[32:35], v49
    s_waitcnt lgkmcnt(3)
    v_mfma_f32_32x32x16_bf16 v[80:95], v[212:215], v[36:39], v[80:95]
    v_rcp_f32 v13, v13
    v_mul_f32 v14, v14, v10
    v_mul_f32 v15, v15, v11
    v_xor_b32 v50, 288, v48
    ds_read_b128 v[36:39], v50
    s_waitcnt lgkmcnt(3)
    v_mfma_f32_32x32x16_bf16 v[80:95], v[216:219], v[40:43], v[80:95]
    v_mul_f32 v16, v16, v12
    v_mul_f32 v17, v17, v13
    v_cvt_pk_bf16_f32 v96, v14, v15
    v_cvt_pk_bf16_f32 v97, v16, v17
    v_mul_f32 v10, v6, v100
    v_xor_b32 v49, 320, v48
    ds_read_b128 v[40:43], v49
    s_waitcnt lgkmcnt(3)
    v_mfma_f32_32x32x16_bf16 v[80:95], v[220:223], v[44:47], v[80:95]
    v_mul_f32 v11, v6, v101
    v_mul_f32 v12, v6, v102
    v_mul_f32 v13, v6, v103
    v_exp_f32 v10, v10
    v_xor_b32 v50, 352, v48
    ds_read_b128 v[44:47], v50
    s_waitcnt lgkmcnt(3)
    v_mfma_f32_32x32x16_bf16 v[80:95], v[224:227], v[32:35], v[80:95]
    v_exp_f32 v11, v11
    v_exp_f32 v12, v12
    v_exp_f32 v13, v13
    v_xor_b32 v49, 384, v48
    ds_read_b128 v[32:35], v49
    s_waitcnt lgkmcnt(3)
    v_mfma_f32_32x32x16_bf16 v[80:95], v[228:231], v[36:39], v[80:95]
    v_mul_f32 v14, v100, v108
    v_mul_f32 v15, v101, v109
    v_mul_f32 v16, v102, v110
    v_mul_f32 v17, v103, v111
    v_xor_b32 v50, 416, v48
    ds_read_b128 v[36:39], v50
    s_waitcnt lgkmcnt(3)
    v_mfma_f32_32x32x16_bf16 v[80:95], v[232:235], v[40:43], v[80:95]
    v_fma_f32 v10, v10, v7, v7
    v_fma_f32 v11, v11, v7, v7
    v_fma_f32 v12, v12, v7, v7
    v_fma_f32 v13, v13, v7, v7
    v_rcp_f32 v10, v10
    v_xor_b32 v49, 448, v48
    ds_read_b128 v[40:43], v49
    s_waitcnt lgkmcnt(3)
    v_mfma_f32_32x32x16_bf16 v[80:95], v[236:239], v[44:47], v[80:95]
    v_rcp_f32 v11, v11
    v_rcp_f32 v12, v12
    v_xor_b32 v50, 480, v48
    ds_read_b128 v[44:47], v50
    s_waitcnt lgkmcnt(3)
    v_mfma_f32_32x32x16_bf16 v[80:95], v[240:243], v[32:35], v[80:95]
    v_rcp_f32 v13, v13
    v_mul_f32 v14, v14, v10
    v_mul_f32 v15, v15, v11
    v_mul_f32 v16, v16, v12
    s_waitcnt lgkmcnt(2)
    v_mfma_f32_32x32x16_bf16 v[80:95], v[244:247], v[36:39], v[80:95]
    v_mul_f32 v17, v17, v13
    v_cvt_pk_bf16_f32 v98, v14, v15
    v_cvt_pk_bf16_f32 v99, v16, v17
    buffer_store_dwordx4 v[96:99], v1, s[60:63], s9 offen offset:0 sc1
    v_mul_f32 v10, v6, v112
    s_waitcnt lgkmcnt(1)
    v_mfma_f32_32x32x16_bf16 v[80:95], v[248:251], v[40:43], v[80:95]
    v_mul_f32 v11, v6, v113
    v_mul_f32 v12, v6, v114
    v_mul_f32 v13, v6, v115
    v_exp_f32 v10, v10
    s_waitcnt lgkmcnt(0)
    v_mfma_f32_32x32x16_bf16 v[80:95], v[252:255], v[44:47], v[80:95]
    v_exp_f32 v11, v11
    v_exp_f32 v12, v12
    v_exp_f32 v13, v13
    v_mul_f32 v14, v112, v120
    v_mul_f32 v15, v113, v121
    v_mul_f32 v16, v114, v122
    v_mul_f32 v17, v115, v123
    v_fma_f32 v10, v10, v7, v7
    v_fma_f32 v11, v11, v7, v7
    v_fma_f32 v12, v12, v7, v7
    v_fma_f32 v13, v13, v7, v7
    v_rcp_f32 v10, v10
    v_rcp_f32 v11, v11
    v_rcp_f32 v12, v12
    v_rcp_f32 v13, v13
    v_mul_f32 v14, v14, v10
    v_mul_f32 v15, v15, v11
    v_mul_f32 v16, v16, v12
    v_mul_f32 v17, v17, v13
    v_cvt_pk_bf16_f32 v112, v14, v15
    v_cvt_pk_bf16_f32 v113, v16, v17
    v_mul_f32 v10, v6, v116
    v_mul_f32 v11, v6, v117
    v_mul_f32 v12, v6, v118
    v_mul_f32 v13, v6, v119
    v_exp_f32 v10, v10
    v_exp_f32 v11, v11
    v_exp_f32 v12, v12
    v_exp_f32 v13, v13
    v_mul_f32 v14, v116, v124
    v_mul_f32 v15, v117, v125
    v_mul_f32 v16, v118, v126
    v_mul_f32 v17, v119, v127
    v_fma_f32 v10, v10, v7, v7
    v_fma_f32 v11, v11, v7, v7
    v_fma_f32 v12, v12, v7, v7
    v_fma_f32 v13, v13, v7, v7
    v_rcp_f32 v10, v10
    v_rcp_f32 v11, v11
    v_rcp_f32 v12, v12
    v_rcp_f32 v13, v13
    v_mul_f32 v14, v14, v10
    v_mul_f32 v15, v15, v11
    v_mul_f32 v16, v16, v12
    v_mul_f32 v17, v17, v13
    v_cvt_pk_bf16_f32 v114, v14, v15
    v_cvt_pk_bf16_f32 v115, v16, v17
    buffer_store_dwordx4 v[112:115], v1, s[60:63], s9 offen offset:1024 sc1
    v_mfma_f32_32x32x16_bf16 v[80:95], v[20:23], v[64:67], v[80:95]
    s_waitcnt vmcnt(0)
    s_nop 7
    v_and_b32 v10, 15, v0
    s_lshl_b32 s4, s93, 4
    v_add_u32 v10, s4, v10
    v_lshlrev_b32 v10, 6, v10
    v_add_u32 v10, 0x24e00, v10
    v_lshrrev_b32 v11, 4, v0
    v_lshlrev_b32 v11, 5, v11
    s_lshl_b32 s4, s92, 7
    s_add_u32 s4, s4, 0x24c00
    v_add_u32 v11, s4, v11
    ds_read_b128 v[108:111], v11
    ds_read_b128 v[112:115], v11 offset:16
    ds_read_b128 v[96:99], v10
    ds_read_b128 v[100:103], v10 offset:16
    ds_read_b128 v[104:107], v10 offset:32
    v_permlane16_swap_b32 v80, v88
    v_permlane16_swap_b32 v81, v89
    v_permlane16_swap_b32 v82, v90
    v_permlane16_swap_b32 v83, v91
    v_permlane16_swap_b32 v84, v92
    v_permlane16_swap_b32 v85, v93
    v_permlane16_swap_b32 v86, v94
    v_permlane16_swap_b32 v87, v95
    s_waitcnt lgkmcnt(4)
    v_mul_f32 v80, v108, v80
    v_mul_f32 v88, v108, v88
    v_mul_f32 v81, v109, v81
    v_mul_f32 v89, v109, v89
    v_mul_f32 v82, v110, v82
    v_mul_f32 v90, v110, v90
    v_mul_f32 v83, v111, v83
    v_mul_f32 v91, v111, v91
    s_waitcnt lgkmcnt(3)
    v_mul_f32 v84, v112, v84
    v_mul_f32 v92, v112, v92
    v_mul_f32 v85, v113, v85
    v_mul_f32 v93, v113, v93
    v_mul_f32 v86, v114, v86
    v_mul_f32 v94, v114, v94
    v_mul_f32 v87, v115, v87
    v_mul_f32 v95, v115, v95
    s_waitcnt lgkmcnt(2)
    v_fma_f32 v118, v98, v80, v81
    v_fma_f32 v119, v98, v88, v89
    v_fma_f32 v118, -v99, v88, v118
    v_fma_f32 v119, v99, v80, v119
    v_fma_f32 v120, v98, v118, v82
    v_fma_f32 v121, v98, v119, v90
    v_fma_f32 v120, -v99, v119, v120
    v_fma_f32 v121, v99, v118, v121
    v_fma_f32 v118, v98, v120, v83
    v_fma_f32 v119, v98, v121, v91
    v_fma_f32 v118, -v99, v121, v118
    v_fma_f32 v119, v99, v120, v119
    v_fma_f32 v120, v98, v118, v84
    v_fma_f32 v121, v98, v119, v92
    v_fma_f32 v120, -v99, v119, v120
    v_fma_f32 v121, v99, v118, v121
    v_fma_f32 v118, v98, v120, v85
    v_fma_f32 v119, v98, v121, v93
    v_fma_f32 v118, -v99, v121, v118
    v_fma_f32 v119, v99, v120, v119
    v_fma_f32 v120, v98, v118, v86
    v_fma_f32 v121, v98, v119, v94
    v_fma_f32 v120, -v99, v119, v120
    v_fma_f32 v121, v99, v118, v121
    v_fma_f32 v118, v98, v120, v87
    v_fma_f32 v119, v98, v121, v95
    v_fma_f32 v118, -v99, v121, v118
    v_fma_f32 v119, v99, v120, v119
    v_mov_b32 v120, v118
    v_mov_b32 v122, v118
    v_mov_b32 v121, v119
    v_mov_b32 v123, v119
    v_bfe_u32 v12, v0, 4, 1
    v_cmp_eq_u32 vcc, 1, v12
    v_permlane16_swap_b32 v120, v122
    v_permlane16_swap_b32 v121, v123
    v_lshrrev_b32 v12, 4, v0
    v_and_b32 v10, 15, v0
    v_lshlrev_b32 v10, 5, v10
    s_waitcnt lgkmcnt(1)
    v_fma_f32 v118, v102, v120, v122
    v_fma_f32 v119, v102, v121, v123
    v_fma_f32 v118, -v103, v121, v118
    v_fma_f32 v119, v103, v120, v119
    v_cndmask_b32 v116, 0, v120, vcc
    v_cndmask_b32 v117, 0, v121, vcc
    v_mov_b32 v124, v118
    v_mov_b32 v126, v118
    v_mov_b32 v125, v119
    v_mov_b32 v127, v119
    s_lshl_b32 s4, s93, 9
    s_lshl_b32 s5, s92, 3
    s_add_u32 s4, s4, s5
    s_add_u32 s4, s4, 0x25600
    v_permlane32_swap_b32 v124, v126
    v_permlane32_swap_b32 v125, v127
    v_add_u32 v10, s4, v10
    s_waitcnt lgkmcnt(0)
    v_fma_f32 v126, v104, v124, v126
    v_fma_f32 v127, v104, v125, v127
    v_fma_f32 v126, -v105, v125, v126
    v_fma_f32 v127, v105, v124, v127
    ds_write_b64 v10, v[126:127]
    v_fma_f32 v120, v102, v124, v116
    v_fma_f32 v121, v102, v125, v117
    v_fma_f32 v120, -v103, v125, v120
    v_fma_f32 v121, v103, v124, v121
    v_add_f32 v122, v124, v116
    v_add_f32 v123, v125, v117
    v_cmp_eq_u32 vcc, 2, v12
    s_nop 1
    v_cndmask_b32 v116, v116, v122, vcc
    v_cndmask_b32 v117, v117, v123, vcc
    v_cmp_eq_u32 vcc, 3, v12
    s_nop 1
    v_cndmask_b32 v116, v116, v120, vcc
    v_cndmask_b32 v117, v117, v121, vcc
    s_waitcnt lgkmcnt(0)
    s_barrier
    s_add_u32 s101, s26, 2
    v_mov_b32 v19, s101
    buffer_store_dword v19, v24, s[60:63], 0 offen offset:0 sc0 sc1
    v_and_b32 v10, 15, v0
    v_lshlrev_b32 v10, 5, v10
    s_lshl_b32 s4, s93, 9
    s_add_u32 s4, s4, 0x25600
    v_add_u32 v10, s4, v10
    ds_read_b128 v[108:111], v10
    ds_read_b128 v[112:115], v10 offset:16
    s_lshl_b32 s4, s89, 13
    s_lshl_b32 s5, s88, 9
    s_add_u32 s4, s4, s5
    s_lshl_b32 s5, s93, 8
    s_add_u32 s4, s4, s5
    s_add_u32 s4, s4, 0x10000
    s_cmp_eq_u32 s92, 0
    s_cselect_b32 s4, s4, 0x7ff00000
    v_lshlrev_b32 v11, 4, v0
    v_mov_b32 v12, 0x7ff00000
    v_cmp_gt_u32 vcc, 16, v0
    s_nop 1
    v_cndmask_b32 v11, v12, v11, vcc
    v_add_u32 v11, s4, v11
    v_mov_b32 v125, s26
    v_mov_b32 v127, s26
    s_waitcnt lgkmcnt(1)
    v_fma_f32 v110, v106, v108, v110
    v_fma_f32 v111, v106, v109, v111
    v_fma_f32 v110, -v107, v109, v110
    v_fma_f32 v111, v107, v108, v111
    s_waitcnt lgkmcnt(0)
    v_fma_f32 v112, v106, v110, v112
    v_fma_f32 v113, v106, v111, v113
    v_fma_f32 v112, -v107, v111, v112
    v_fma_f32 v113, v107, v110, v113
    v_fma_f32 v114, v106, v112, v114
    v_fma_f32 v115, v106, v113, v115
    v_fma_f32 v114, -v107, v113, v114
    v_fma_f32 v115, v107, v112, v115
    v_mov_b32 v124, v114
    v_mov_b32 v126, v115
    buffer_store_dwordx4 v[124:127], v11, s[60:63], 0 offen sc0 sc1
    v_mov_b32 v118, 0
    v_mov_b32 v119, 0
    s_cmp_eq_u32 s92, 1
    s_cselect_b64 s[98:99], -1, 0
    v_cndmask_b32 v118, v118, v108, s[98:99]
    v_cndmask_b32 v119, v119, v109, s[98:99]
    s_cmp_eq_u32 s92, 2
    s_cselect_b64 s[98:99], -1, 0
    v_cndmask_b32 v118, v118, v110, s[98:99]
    v_cndmask_b32 v119, v119, v111, s[98:99]
    s_cmp_eq_u32 s92, 3
    s_cselect_b64 s[98:99], -1, 0
    v_cndmask_b32 v118, v118, v112, s[98:99]
    v_cndmask_b32 v119, v119, v113, s[98:99]
    v_lshrrev_b32 v11, 4, v0
    v_lshlrev_b32 v11, 3, v11
    v_cvt_f32_u32 v12, v11
    s_lshl_b32 s4, s92, 5
    v_add_u32 v11, s4, v11
    v_cvt_f32_u32 v13, v11
    v_mul_f32 v14, v12, v96
    v_mul_f32 v121, v12, v97
    v_exp_f32 v14, v14
    v_fract_f32 v121, v121
    v_cos_f32 v120, v121
    v_sin_f32 v121, v121
    s_nop 0
    v_mul_f32 v120, v120, v14
    v_mul_f32 v121, v121, v14
    v_fma_f32 v116, v120, v118, v116
    v_fma_f32 v117, v120, v119, v117
    v_fma_f32 v116, -v121, v119, v116
    v_fma_f32 v117, v121, v118, v117
    v_mul_f32 v14, v13, v96
    v_mul_f32 v121, v13, v97
    v_exp_f32 v14, v14
    v_fract_f32 v121, v121
    v_cos_f32 v120, v121
    v_sin_f32 v121, v121
    s_nop 0
    v_mul_f32 v120, v120, v14
    v_mul_f32 v121, v121, v14
    v_mul_f32 v122, v120, v100
    v_mul_f32 v123, v120, v101
    v_fma_f32 v122, -v121, v101, v122
    v_fma_f32 v123, v121, v100, v123
    v_mul_f32 v120, v116, v100
    v_mul_f32 v121, v116, v101
    v_fma_f32 v120, -v117, v101, v120
    v_fma_f32 v121, v117, v100, v121
    v_mov_b32 v116, v120
    v_mov_b32 v117, v121
    v_mul_f32 v12, v100, v80
    v_mul_f32 v13, v101, v80
    v_fma_f32 v80, -v101, v88, v12
    v_fma_f32 v88, v100, v88, v13
    v_mul_f32 v10, v100, v81
    v_mul_f32 v11, v101, v81
    v_fma_f32 v81, -v101, v89, v10
    v_fma_f32 v89, v100, v89, v11
    v_mul_f32 v12, v100, v82
    v_mul_f32 v13, v101, v82
    v_fma_f32 v82, -v101, v90, v12
    v_fma_f32 v90, v100, v90, v13
    v_mul_f32 v10, v100, v83
    v_mul_f32 v11, v101, v83
    v_fma_f32 v83, -v101, v91, v10
    v_fma_f32 v91, v100, v91, v11
    v_mul_f32 v12, v100, v84
    v_mul_f32 v13, v101, v84
    v_fma_f32 v84, -v101, v92, v12
    v_fma_f32 v92, v100, v92, v13
    v_mul_f32 v10, v100, v85
    v_mul_f32 v11, v101, v85
    v_fma_f32 v85, -v101, v93, v10
    v_fma_f32 v93, v100, v93, v11
    v_mul_f32 v12, v100, v86
    v_mul_f32 v13, v101, v86
    v_fma_f32 v86, -v101, v94, v12
    v_fma_f32 v94, v100, v94, v13
    v_mul_f32 v10, v100, v87
    v_mul_f32 v11, v101, v87
    v_fma_f32 v87, -v101, v95, v10
    v_fma_f32 v95, v100, v95, v11
    s_lshl_b32 s4, s93, 2
    s_add_u32 s4, s4, s92
    s_lshl_b32 s4, s4, 10
    s_add_u32 s4, s4, 0x25b00
    v_and_b32 v10, 15, v0
    v_lshlrev_b32 v10, 6, v10
    v_lshrrev_b32 v11, 4, v0
    v_lshl_add_u32 v10, v11, 4, v10
    v_add_u32 v124, s4, v10
    v_lshrrev_b32 v11, 5, v0
    v_lshlrev_b32 v11, 9, v11
    v_bfe_u32 v12, v0, 2, 2
    v_lshl_add_u32 v11, v12, 6, v11
    v_and_b32 v12, 1, v0
    v_lshl_add_u32 v11, v12, 5, v11
    v_bfe_u32 v12, v0, 4, 1
    v_lshl_add_u32 v11, v12, 4, v11
    v_bfe_u32 v12, v0, 1, 1
    v_lshl_add_u32 v11, v12, 3, v11
    v_add_u32 v125, s4, v11
    s_lshl_b32 s4, s89, 1
    s_add_u32 s4, s4, s93
    s_lshr_b32 s5, s4, 2
    s_lshl_b32 s5, s5, 3
    s_and_b32 s4, s4, 3
    s_add_u32 s4, s4, s5
    s_add_u32 s4, s4, 64
    s_lshl_b32 s4, s4, 10
    s_mul_i32 s5, s88, 0xb0000
    s_add_u32 s4, s4, s5
    s_add_u32 s27, s4, 0x200000
    s_add_u32 s8, s27, 4096
    v_and_b32 v10, 15, v0
    s_lshl_b32 s4, s93, 4
    v_add_u32 v10, s4, v10
    v_lshlrev_b32 v10, 3, v10
    v_add_u32 v126, 0x25a00, v10
    s_mov_b32 s96, 0
    s_mov_b32 s95, 4096
    buffer_load_dwordx4 v[144:147], v28, s[60:63], s96 offen offset:0 sc0 sc1
    buffer_load_dwordx4 v[148:151], v28, s[60:63], s96 offen offset:2048 sc0 sc1
    buffer_load_dwordx4 v[152:155], v28, s[60:63], s95 offen offset:0 sc0 sc1
    buffer_load_dwordx4 v[156:159], v28, s[60:63], s95 offen offset:2048 sc0 sc1
    s_and_b32 s6, s92, 1
    v_and_b32 v113, 15, v0
    s_lshl_b32 s4, s6, 4
    v_add_u32 v113, s4, v113
    v_lshlrev_b32 v103, 6, v113
    v_add_u32 v103, 0x24e00, v103
    ds_read_b64 v[100:101], v103
    v_lshrrev_b32 v112, 4, v0
    v_lshlrev_b32 v113, 3, v113
    v_add_u32 v113, 0x25a00, v113
    s_sub_u32 s4, s88, 1
    v_sub_u32 v102, s4, v112
    v_cmp_le_i32 vcc, 0, v102
    v_max_i32 v102, 0, v102
    v_cvt_f32_i32 v102, v102
    v_mul_f32 v102, 0x43000000, v102
    s_waitcnt lgkmcnt(0)
    v_mul_f32 v103, v102, v100
    v_mul_f32 v105, v102, v101
    v_exp_f32 v103, v103
    v_fract_f32 v105, v105
    v_cos_f32 v104, v105
    v_sin_f32 v105, v105
    s_nop 0
    v_mul_f32 v104, v104, v103
    v_mul_f32 v105, v105, v103
    v_cndmask_b32 v104, 0, v104, vcc
    v_cndmask_b32 v105, 0, v105, vcc
    s_sub_u32 s4, s88, 5
    v_sub_u32 v102, s4, v112
    v_cmp_le_i32 vcc, 0, v102
    v_max_i32 v102, 0, v102
    v_cvt_f32_i32 v102, v102
    v_mul_f32 v102, 0x43000000, v102
    v_mul_f32 v103, v102, v100
    v_mul_f32 v107, v102, v101
    v_exp_f32 v103, v103
    v_fract_f32 v107, v107
    v_cos_f32 v106, v107
    v_sin_f32 v107, v107
    s_nop 0
    v_mul_f32 v106, v106, v103
    v_mul_f32 v107, v107, v103
    v_cndmask_b32 v106, 0, v106, vcc
    v_cndmask_b32 v107, 0, v107, vcc
    s_sub_u32 s4, s88, 9
    v_sub_u32 v102, s4, v112
    v_cmp_le_i32 vcc, 0, v102
    v_max_i32 v102, 0, v102
    v_cvt_f32_i32 v102, v102
    v_mul_f32 v102, 0x43000000, v102
    v_mul_f32 v103, v102, v100
    v_mul_f32 v109, v102, v101
    v_exp_f32 v103, v103
    v_fract_f32 v109, v109
    v_cos_f32 v108, v109
    v_sin_f32 v109, v109
    s_nop 0
    v_mul_f32 v108, v108, v103
    v_mul_f32 v109, v109, v103
    v_cndmask_b32 v108, 0, v108, vcc
    v_cndmask_b32 v109, 0, v109, vcc
    s_sub_u32 s4, s88, 13
    v_sub_u32 v102, s4, v112
    v_cmp_le_i32 vcc, 0, v102
    v_max_i32 v102, 0, v102
    v_cvt_f32_i32 v102, v102
    v_mul_f32 v102, 0x43000000, v102
    v_mul_f32 v103, v102, v100
    v_mul_f32 v111, v102, v101
    v_exp_f32 v103, v103
    v_fract_f32 v111, v111
    v_cos_f32 v110, v111
    v_sin_f32 v111, v111
    s_nop 0
    v_mul_f32 v110, v110, v103
    v_mul_f32 v111, v111, v103
    v_cndmask_b32 v110, 0, v110, vcc
    v_cndmask_b32 v111, 0, v111, vcc
    s_mov_b32 s96, 0
    s_mov_b32 s95, 4096
    v_mov_b32 v161, 0
    s_waitcnt vmcnt(0)
    v_mov_b32 v160, v156
    v_xor_b32 v160, s26, v145
    v_xor_b32 v163, s26, v147
    v_or_b32 v160, v160, v163
    v_lshrrev_b32 v163, 4, v0
    v_add_u32 v163, 0, v163
    v_cmp_le_u32 vcc, s88, v163
    s_nop 1
    v_cndmask_b32 v160, v160, v161, vcc
    v_mov_b32 v162, v160
    v_xor_b32 v160, s26, v149
    v_xor_b32 v163, s26, v151
    v_or_b32 v160, v160, v163
    v_lshrrev_b32 v163, 4, v0
    v_add_u32 v163, 4, v163
    v_cmp_le_u32 vcc, s88, v163
    s_nop 1
    v_cndmask_b32 v160, v160, v161, vcc
    v_or_b32 v162, v162, v160
    v_xor_b32 v160, s26, v153
    v_xor_b32 v163, s26, v155
    v_or_b32 v160, v160, v163
    v_lshrrev_b32 v163, 4, v0
    v_add_u32 v163, 8, v163
    v_cmp_le_u32 vcc, s88, v163
    s_nop 1
    v_cndmask_b32 v160, v160, v161, vcc
    v_or_b32 v162, v162, v160
    v_xor_b32 v160, s26, v157
    v_xor_b32 v163, s26, v159
    v_or_b32 v160, v160, v163
    v_lshrrev_b32 v163, 4, v0
    v_add_u32 v163, 12, v163
    v_cmp_le_u32 vcc, s88, v163
    s_nop 1
    v_cndmask_b32 v160, v160, v161, vcc
    v_or_b32 v162, v162, v160
    v_cmp_eq_u32 vcc, 0, v162
    s_nop 4
    s_cmp_eq_u64 vcc, exec
    s_cbranch_scc1 L_aggd24
    s_mov_b32 s97, 400000
L_agg23:
    s_sleep 1
    buffer_load_dwordx4 v[144:147], v28, s[60:63], s96 offen offset:0 sc0 sc1
    buffer_load_dwordx4 v[148:151], v28, s[60:63], s96 offen offset:2048 sc0 sc1
    buffer_load_dwordx4 v[152:155], v28, s[60:63], s95 offen offset:0 sc0 sc1
    buffer_load_dwordx4 v[156:159], v28, s[60:63], s95 offen offset:2048 sc0 sc1
    s_waitcnt vmcnt(0)
    v_xor_b32 v160, s26, v145
    v_xor_b32 v163, s26, v147
    v_or_b32 v160, v160, v163
    v_lshrrev_b32 v163, 4, v0
    v_add_u32 v163, 0, v163
    v_cmp_le_u32 vcc, s88, v163
    s_nop 1
    v_cndmask_b32 v160, v160, v161, vcc
    v_mov_b32 v162, v160
    v_xor_b32 v160, s26, v149
    v_xor_b32 v163, s26, v151
    v_or_b32 v160, v160, v163
    v_lshrrev_b32 v163, 4, v0
    v_add_u32 v163, 4, v163
    v_cmp_le_u32 vcc, s88, v163
    s_nop 1
    v_cndmask_b32 v160, v160, v161, vcc
    v_or_b32 v162, v162, v160
    v_xor_b32 v160, s26, v153
    v_xor_b32 v163, s26, v155
    v_or_b32 v160, v160, v163
    v_lshrrev_b32 v163, 4, v0
    v_add_u32 v163, 8, v163
    v_cmp_le_u32 vcc, s88, v163
    s_nop 1
    v_cndmask_b32 v160, v160, v161, vcc
    v_or_b32 v162, v162, v160
    v_xor_b32 v160, s26, v157
    v_xor_b32 v163, s26, v159
    v_or_b32 v160, v160, v163
    v_lshrrev_b32 v163, 4, v0
    v_add_u32 v163, 12, v163
    v_cmp_le_u32 vcc, s88, v163
    s_nop 1
    v_cndmask_b32 v160, v160, v161, vcc
    v_or_b32 v162, v162, v160
    v_cmp_eq_u32 vcc, 0, v162
    s_nop 4
    s_cmp_eq_u64 vcc, exec
    s_cbranch_scc1 L_aggd24
    s_sub_u32 s97, s97, 1
    s_cmp_lg_u32 s97, 0
    s_cbranch_scc1 L_agg23
L_aggd24:
    s_nop 4
    v_add_u32 v162, 0, v112
    v_cmp_gt_u32 vcc, s88, v162
    s_nop 1
    v_cndmask_b32 v144, 0, v144, vcc
    v_cndmask_b32 v146, 0, v146, vcc
    v_add_u32 v162, 4, v112
    v_cmp_gt_u32 vcc, s88, v162
    s_nop 1
    v_cndmask_b32 v148, 0, v148, vcc
    v_cndmask_b32 v150, 0, v150, vcc
    v_add_u32 v162, 8, v112
    v_cmp_gt_u32 vcc, s88, v162
    s_nop 1
    v_cndmask_b32 v152, 0, v152, vcc
    v_cndmask_b32 v154, 0, v154, vcc
    v_add_u32 v162, 12, v112
    v_cmp_gt_u32 vcc, s88, v162
    s_nop 1
    v_cndmask_b32 v156, 0, v156, vcc
    v_cndmask_b32 v158, 0, v158, vcc
    v_mov_b32 v160, 0
    v_mov_b32 v161, 0
    v_fma_f32 v160, v104, v144, v160
    v_fma_f32 v161, v104, v146, v161
    v_fma_f32 v160, -v105, v146, v160
    v_fma_f32 v161, v105, v144, v161
    v_fma_f32 v160, v106, v148, v160
    v_fma_f32 v161, v106, v150, v161
    v_fma_f32 v160, -v107, v150, v160
    v_fma_f32 v161, v107, v148, v161
    v_fma_f32 v160, v108, v152, v160
    v_fma_f32 v161, v108, v154, v161
    v_fma_f32 v160, -v109, v154, v160
    v_fma_f32 v161, v109, v152, v161
    v_fma_f32 v160, v110, v156, v160
    v_fma_f32 v161, v110, v158, v161
    v_fma_f32 v160, -v111, v158, v160
    v_fma_f32 v161, v111, v156, v161
    v_mov_b32 v162, v160
    v_mov_b32 v163, v161
    s_nop 0
    v_permlane16_swap_b32 v160, v162
    v_permlane16_swap_b32 v161, v163
    v_add_f32 v160, v160, v162
    v_add_f32 v161, v161, v163
    v_mov_b32 v162, v160
    v_mov_b32 v163, v161
    s_nop 0
    v_permlane32_swap_b32 v160, v162
    v_permlane32_swap_b32 v161, v163
    v_add_f32 v160, v160, v162
    v_add_f32 v161, v161, v163
    ds_write_b64 v113, v[160:161]
    buffer_load_dword v27, v25, s[60:63], 0 offen sc0 sc1
    s_add_u32 s101, s26, 2
    s_waitcnt vmcnt(0)
    v_subrev_u32 v27, s101, v27
    v_cmp_ge_u32 vcc, 5, v27
    s_nop 3
    s_cmp_eq_u64 vcc, exec
    s_cbranch_scc1 L_polld26
    s_mov_b32 s97, 400000
L_poll25:
    s_sleep 1
    buffer_load_dword v27, v25, s[60:63], 0 offen sc0 sc1
    s_waitcnt vmcnt(0)
    v_subrev_u32 v27, s101, v27
    v_cmp_ge_u32 vcc, 5, v27
    s_nop 4
    s_cmp_eq_u64 vcc, exec
    s_cbranch_scc1 L_polld26
    s_sub_u32 s97, s97, 1
    s_cmp_lg_u32 s97, 0
    s_cbranch_scc1 L_poll25
L_polld26:
    s_nop 4
    s_waitcnt lgkmcnt(0)
    s_barrier
    ds_read_b64 v[108:109], v126
    s_waitcnt lgkmcnt(0)
    v_fma_f32 v116, v122, v108, v116
    v_fma_f32 v117, v122, v109, v117
    v_fma_f32 v116, -v123, v109, v116
    v_fma_f32 v117, v123, v108, v117
    v_fma_f32 v80, v98, v116, v80
    v_fma_f32 v88, v98, v117, v88
    v_fma_f32 v80, -v99, v117, v80
    v_fma_f32 v88, v99, v116, v88
    v_fma_f32 v81, v98, v80, v81
    v_fma_f32 v89, v98, v88, v89
    v_fma_f32 v81, -v99, v88, v81
    v_fma_f32 v89, v99, v80, v89
    v_fma_f32 v82, v98, v81, v82
    v_fma_f32 v90, v98, v89, v90
    v_fma_f32 v82, -v99, v89, v82
    v_fma_f32 v90, v99, v81, v90
    v_fma_f32 v83, v98, v82, v83
    v_fma_f32 v91, v98, v90, v91
    v_fma_f32 v83, -v99, v90, v83
    v_fma_f32 v91, v99, v82, v91
    v_fma_f32 v84, v98, v83, v84
    v_fma_f32 v92, v98, v91, v92
    v_fma_f32 v84, -v99, v91, v84
    v_fma_f32 v92, v99, v83, v92
    v_fma_f32 v85, v98, v84, v85
    v_fma_f32 v93, v98, v92, v93
    v_fma_f32 v85, -v99, v92, v85
    v_fma_f32 v93, v99, v84, v93
    v_fma_f32 v86, v98, v85, v86
    v_fma_f32 v94, v98, v93, v94
    v_fma_f32 v86, -v99, v93, v86
    v_fma_f32 v94, v99, v85, v94
    v_fma_f32 v87, v98, v86, v87
    v_fma_f32 v95, v98, v94, v95
    v_fma_f32 v87, -v99, v94, v87
    v_fma_f32 v95, v99, v86, v95
    v_cvt_pk_bf16_f32 v108, v80, v81
    v_cvt_pk_bf16_f32 v109, v82, v83
    v_cvt_pk_bf16_f32 v110, v84, v85
    v_cvt_pk_bf16_f32 v111, v86, v87
    ds_write_b128 v124, v[108:111]
    ds_read_b64_tr_b16 v[96:97], v125 offset:0
    ds_read_b64_tr_b16 v[98:99], v125 offset:256
    v_cvt_pk_bf16_f32 v112, -v88, -v89
    v_cvt_pk_bf16_f32 v113, -v90, -v91
    v_cvt_pk_bf16_f32 v114, -v92, -v93
    v_cvt_pk_bf16_f32 v115, -v94, -v95
    ds_write_b128 v124, v[112:115]
    ds_read_b64_tr_b16 v[100:101], v125 offset:0
    ds_read_b64_tr_b16 v[102:103], v125 offset:256
    s_waitcnt lgkmcnt(3)
    buffer_store_dwordx4 v[96:99], v1, s[60:63], s27 offen sc1
    s_waitcnt lgkmcnt(0)
    buffer_store_dwordx4 v[100:103], v1, s[60:63], s8 offen sc1
    s_barrier
    v_add_u32 v5, 0x18000, v26
    v_add_u32 v8, 0x8000, v29
    ds_read_b128 v[128:131], v5 offset:0
    ds_read_b64_tr_b16 v[192:193], v8 offset:0
    ds_read_b64_tr_b16 v[194:195], v8 offset:512
    ds_read_b128 v[132:135], v5 offset:1024
    ds_read_b64_tr_b16 v[196:197], v8 offset:2048
    ds_read_b64_tr_b16 v[198:199], v8 offset:2560
    ds_read_b128 v[136:139], v5 offset:2048
    ds_read_b64_tr_b16 v[200:201], v8 offset:4096
    ds_read_b64_tr_b16 v[202:203], v8 offset:4608
    ds_read_b128 v[140:143], v5 offset:3072
    ds_read_b64_tr_b16 v[204:205], v8 offset:6144
    ds_read_b64_tr_b16 v[206:207], v8 offset:6656
    s_waitcnt lgkmcnt(9)
    v_mfma_f32_32x32x16_bf16 v[160:175], v[128:131], v[192:195], 0
    ds_read_b128 v[128:131], v5 offset:4096
    ds_read_b64_tr_b16 v[192:193], v8 offset:8192
    ds_read_b64_tr_b16 v[194:195], v8 offset:8704
    s_waitcnt lgkmcnt(9)
    v_mfma_f32_32x32x16_bf16 v[160:175], v[132:135], v[196:199], v[160:175]
    ds_read_b128 v[132:135], v5 offset:5120
    ds_read_b64_tr_b16 v[196:197], v8 offset:10240
    ds_read_b64_tr_b16 v[198:199], v8 offset:10752
    s_waitcnt lgkmcnt(9)
    v_mfma_f32_32x32x16_bf16 v[160:175], v[136:139], v[200:203], v[160:175]
    ds_read_b128 v[136:139], v5 offset:6144
    ds_read_b64_tr_b16 v[200:201], v8 offset:12288
    ds_read_b64_tr_b16 v[202:203], v8 offset:12800
    s_waitcnt lgkmcnt(9)
    v_mfma_f32_32x32x16_bf16 v[160:175], v[140:143], v[204:207], v[160:175]
    s_and_b32 s7, s92, 1
    s_mov_b32 s76, s34
    s_mov_b32 s77, s35
    s_mov_b32 s78, 0x400000
    s_mov_b32 s79, 0x20000
    s_lshl_b32 s4, s91, 6
    s_lshl_b32 s5, s7, 5
    s_add_u32 s4, s4, s5
    v_and_b32 v217, 31, v0
    v_add_u32 v217, s4, v217
    ds_read_b128 v[140:143], v5 offset:7168
    ds_read_b64_tr_b16 v[204:205], v8 offset:14336
    ds_read_b64_tr_b16 v[206:207], v8 offset:14848
    s_waitcnt lgkmcnt(9)
    v_mfma_f32_32x32x16_bf16 v[160:175], v[128:131], v[192:195], v[160:175]
    v_lshlrev_b32 v217, 1, v217
    global_load_ushort v23, v217, s[24:25]
    s_and_b32 s4, s90, 1
    s_lshl_b32 s4, s4, 6
    v_add_u32 v10, s4, v0
    v_lshlrev_b32 v10, 4, v10
    s_waitcnt vmcnt(1)
    s_waitcnt lgkmcnt(0)
    s_barrier
    s_add_u32 s101, s26, 1
    v_mov_b32 v19, s101
    buffer_store_dword v19, v24, s[60:63], 0 offen offset:4 sc0 sc1
    v_add_u32 v5, 0x1c000, v26
    v_add_u32 v8, 0xc000, v29
    ds_read_b128 v[128:131], v5 offset:0
    ds_read_b64_tr_b16 v[192:193], v8 offset:0
    ds_read_b64_tr_b16 v[194:195], v8 offset:512
    v_mfma_f32_32x32x16_bf16 v[160:175], v[132:135], v[196:199], v[160:175]
    ds_read_b128 v[132:135], v5 offset:1024
    ds_read_b64_tr_b16 v[196:197], v8 offset:2048
    ds_read_b64_tr_b16 v[198:199], v8 offset:2560
    v_mfma_f32_32x32x16_bf16 v[160:175], v[136:139], v[200:203], v[160:175]
    ds_read_b128 v[136:139], v5 offset:2048
    ds_read_b64_tr_b16 v[200:201], v8 offset:4096
    ds_read_b64_tr_b16 v[202:203], v8 offset:4608
    v_mfma_f32_32x32x16_bf16 v[160:175], v[140:143], v[204:207], v[160:175]
    ds_read_b128 v[140:143], v5 offset:3072
    ds_read_b64_tr_b16 v[204:205], v8 offset:6144
    ds_read_b64_tr_b16 v[206:207], v8 offset:6656
    s_waitcnt lgkmcnt(9)
    v_mfma_f32_32x32x16_bf16 v[160:175], v[128:131], v[192:195], v[160:175]
    s_lshl_b32 s4, s94, 11
    s_add_u32 s95, s4, 0x8000
    buffer_load_dwordx4 v[240:243], v10, s[60:63], s95 offen sc0 sc1
    ds_read_b128 v[128:131], v5 offset:4096
    ds_read_b64_tr_b16 v[192:193], v8 offset:8192
    ds_read_b64_tr_b16 v[194:195], v8 offset:8704
    s_waitcnt lgkmcnt(9)
    v_mfma_f32_32x32x16_bf16 v[160:175], v[132:135], v[196:199], v[160:175]
    ds_read_b128 v[132:135], v5 offset:5120
    ds_read_b64_tr_b16 v[196:197], v8 offset:10240
    ds_read_b64_tr_b16 v[198:199], v8 offset:10752
    s_waitcnt lgkmcnt(9)
    v_mfma_f32_32x32x16_bf16 v[160:175], v[136:139], v[200:203], v[160:175]
    ds_read_b128 v[136:139], v5 offset:6144
    ds_read_b64_tr_b16 v[200:201], v8 offset:12288
    ds_read_b64_tr_b16 v[202:203], v8 offset:12800
    s_waitcnt lgkmcnt(9)
    v_mfma_f32_32x32x16_bf16 v[160:175], v[140:143], v[204:207], v[160:175]
    ds_read_b128 v[140:143], v5 offset:7168
    ds_read_b64_tr_b16 v[204:205], v8 offset:14336
    ds_read_b64_tr_b16 v[206:207], v8 offset:14848
    s_waitcnt lgkmcnt(9)
    v_mfma_f32_32x32x16_bf16 v[160:175], v[128:131], v[192:195], v[160:175]
    s_waitcnt lgkmcnt(0)
    s_barrier
    v_add_u32 v5, 0x20000, v26
    v_add_u32 v8, 0x10000, v29
    ds_read_b128 v[128:131], v5 offset:0
    ds_read_b64_tr_b16 v[192:193], v8 offset:0
    ds_read_b64_tr_b16 v[194:195], v8 offset:512
    v_mfma_f32_32x32x16_bf16 v[160:175], v[132:135], v[196:199], v[160:175]
    ds_read_b128 v[132:135], v5 offset:1024
    ds_read_b64_tr_b16 v[196:197], v8 offset:2048
    ds_read_b64_tr_b16 v[198:199], v8 offset:2560
    v_mfma_f32_32x32x16_bf16 v[160:175], v[136:139], v[200:203], v[160:175]
    ds_read_b128 v[136:139], v5 offset:2048
    ds_read_b64_tr_b16 v[200:201], v8 offset:4096
    ds_read_b64_tr_b16 v[202:203], v8 offset:4608
    v_mfma_f32_32x32x16_bf16 v[160:175], v[140:143], v[204:207], v[160:175]
    ds_read_b128 v[140:143], v5 offset:3072
    ds_read_b64_tr_b16 v[204:205], v8 offset:6144
    ds_read_b64_tr_b16 v[206:207], v8 offset:6656
    s_waitcnt lgkmcnt(9)
    v_mfma_f32_32x32x16_bf16 v[160:175], v[128:131], v[192:195], v[160:175]
    ds_read_b128 v[128:131], v5 offset:4096
    ds_read_b64_tr_b16 v[192:193], v8 offset:8192
    ds_read_b64_tr_b16 v[194:195], v8 offset:8704
    s_waitcnt lgkmcnt(9)
    v_mfma_f32_32x32x16_bf16 v[160:175], v[132:135], v[196:199], v[160:175]
    ds_read_b128 v[132:135], v5 offset:5120
    ds_read_b64_tr_b16 v[196:197], v8 offset:10240
    ds_read_b64_tr_b16 v[198:199], v8 offset:10752
    s_waitcnt lgkmcnt(9)
    v_mfma_f32_32x32x16_bf16 v[160:175], v[136:139], v[200:203], v[160:175]
    ds_read_b128 v[136:139], v5 offset:6144
    ds_read_b64_tr_b16 v[200:201], v8 offset:12288
    ds_read_b64_tr_b16 v[202:203], v8 offset:12800
    s_waitcnt lgkmcnt(9)
    v_mfma_f32_32x32x16_bf16 v[160:175], v[140:143], v[204:207], v[160:175]
    ds_read_b128 v[140:143], v5 offset:7168
    ds_read_b64_tr_b16 v[204:205], v8 offset:14336
    ds_read_b64_tr_b16 v[206:207], v8 offset:14848
    s_waitcnt lgkmcnt(9)
    v_mfma_f32_32x32x16_bf16 v[160:175], v[128:131], v[192:195], v[160:175]
    s_waitcnt lgkmcnt(0)
    s_barrier
    v_add_u32 v5, 0x0, v26
    v_add_u32 v8, 0x14000, v29
    ds_read_b128 v[128:131], v5 offset:0
    ds_read_b64_tr_b16 v[192:193], v8 offset:0
    ds_read_b64_tr_b16 v[194:195], v8 offset:512
    v_mfma_f32_32x32x16_bf16 v[160:175], v[132:135], v[196:199], v[160:175]
    ds_read_b128 v[132:135], v5 offset:1024
    ds_read_b64_tr_b16 v[196:197], v8 offset:2048
    ds_read_b64_tr_b16 v[198:199], v8 offset:2560
    v_mfma_f32_32x32x16_bf16 v[160:175], v[136:139], v[200:203], v[160:175]
    ds_read_b128 v[136:139], v5 offset:2048
    ds_read_b64_tr_b16 v[200:201], v8 offset:4096
    ds_read_b64_tr_b16 v[202:203], v8 offset:4608
    v_mfma_f32_32x32x16_bf16 v[160:175], v[140:143], v[204:207], v[160:175]
    ds_read_b128 v[140:143], v5 offset:3072
    ds_read_b64_tr_b16 v[204:205], v8 offset:6144
    ds_read_b64_tr_b16 v[206:207], v8 offset:6656
    s_waitcnt lgkmcnt(9)
    v_mfma_f32_32x32x16_bf16 v[160:175], v[128:131], v[192:195], v[160:175]
    s_waitcnt vmcnt(0)
    v_mul_f32 v240, v240, v242
    v_sub_f32 v240, 0, v240
    v_lshlrev_b32 v10, 2, v0
    v_add_u32 v10, 0x24a00, v10
    ds_write_b32 v10, v240
    ds_write_b32 v10, v242 offset:512
    ds_read_b128 v[128:131], v5 offset:4096
    ds_read_b64_tr_b16 v[192:193], v8 offset:8192
    ds_read_b64_tr_b16 v[194:195], v8 offset:8704
    s_waitcnt lgkmcnt(11)
    v_mfma_f32_32x32x16_bf16 v[160:175], v[132:135], v[196:199], v[160:175]
    ds_read_b128 v[132:135], v5 offset:5120
    ds_read_b64_tr_b16 v[196:197], v8 offset:10240
    ds_read_b64_tr_b16 v[198:199], v8 offset:10752
    s_waitcnt lgkmcnt(11)
    v_mfma_f32_32x32x16_bf16 v[160:175], v[136:139], v[200:203], v[160:175]
    ds_read_b128 v[136:139], v5 offset:6144
    ds_read_b64_tr_b16 v[200:201], v8 offset:12288
    ds_read_b64_tr_b16 v[202:203], v8 offset:12800
    s_waitcnt lgkmcnt(11)
    v_mfma_f32_32x32x16_bf16 v[160:175], v[140:143], v[204:207], v[160:175]
    ds_read_b128 v[140:143], v5 offset:7168
    ds_read_b64_tr_b16 v[204:205], v8 offset:14336
    ds_read_b64_tr_b16 v[206:207], v8 offset:14848
    s_waitcnt lgkmcnt(9)
    v_mfma_f32_32x32x16_bf16 v[160:175], v[128:131], v[192:195], v[160:175]
    s_waitcnt lgkmcnt(0)
    s_barrier
    buffer_load_dword v27, v25, s[60:63], 0 offen offset:4 sc0 sc1
    v_add_u32 v5, 0x8000, v26
    v_add_u32 v8, 0x4000, v29
    ds_read_b128 v[128:131], v5 offset:0
    ds_read_b64_tr_b16 v[192:193], v8 offset:0
    ds_read_b64_tr_b16 v[194:195], v8 offset:512
    v_mfma_f32_32x32x16_bf16 v[160:175], v[132:135], v[196:199], v[160:175]
    ds_read_b128 v[132:135], v5 offset:1024
    ds_read_b64_tr_b16 v[196:197], v8 offset:2048
    ds_read_b64_tr_b16 v[198:199], v8 offset:2560
    v_mfma_f32_32x32x16_bf16 v[160:175], v[136:139], v[200:203], v[160:175]
    ds_read_b128 v[136:139], v5 offset:2048
    ds_read_b64_tr_b16 v[200:201], v8 offset:4096
    ds_read_b64_tr_b16 v[202:203], v8 offset:4608
    v_mfma_f32_32x32x16_bf16 v[160:175], v[140:143], v[204:207], v[160:175]
    ds_read_b128 v[140:143], v5 offset:3072
    ds_read_b64_tr_b16 v[204:205], v8 offset:6144
    ds_read_b64_tr_b16 v[206:207], v8 offset:6656
    s_waitcnt lgkmcnt(9)
    v_mfma_f32_32x32x16_bf16 v[160:175], v[128:131], v[192:195], v[160:175]
    ds_read_b128 v[128:131], v5 offset:4096
    ds_read_b64_tr_b16 v[192:193], v8 offset:8192
    ds_read_b64_tr_b16 v[194:195], v8 offset:8704
    s_waitcnt lgkmcnt(9)
    v_mfma_f32_32x32x16_bf16 v[160:175], v[132:135], v[196:199], v[160:175]
    ds_read_b128 v[132:135], v5 offset:5120
    ds_read_b64_tr_b16 v[196:197], v8 offset:10240
    ds_read_b64_tr_b16 v[198:199], v8 offset:10752
    s_waitcnt lgkmcnt(9)
    v_mfma_f32_32x32x16_bf16 v[160:175], v[136:139], v[200:203], v[160:175]
    ds_read_b128 v[136:139], v5 offset:6144
    ds_read_b64_tr_b16 v[200:201], v8 offset:12288
    ds_read_b64_tr_b16 v[202:203], v8 offset:12800
    s_waitcnt lgkmcnt(9)
    v_mfma_f32_32x32x16_bf16 v[160:175], v[140:143], v[204:207], v[160:175]
    ds_read_b128 v[140:143], v5 offset:7168
    ds_read_b64_tr_b16 v[204:205], v8 offset:14336
    ds_read_b64_tr_b16 v[206:207], v8 offset:14848
    s_waitcnt lgkmcnt(9)
    v_mfma_f32_32x32x16_bf16 v[160:175], v[128:131], v[192:195], v[160:175]
    s_add_u32 s101, s26, 1
    s_waitcnt vmcnt(0)
    v_subrev_u32 v27, s101, v27
    v_cmp_ge_u32 vcc, 6, v27
    s_nop 3
    s_cmp_eq_u64 vcc, exec
    s_cbranch_scc1 L_polld28
    s_mov_b32 s97, 400000
L_poll27:
    s_sleep 1
    buffer_load_dword v27, v25, s[60:63], 0 offen offset:4 sc0 sc1
    s_waitcnt vmcnt(0)
    v_subrev_u32 v27, s101, v27
    v_cmp_ge_u32 vcc, 6, v27
    s_nop 4
    s_cmp_eq_u64 vcc, exec
    s_cbranch_scc1 L_polld28
    s_sub_u32 s97, s97, 1
    s_cmp_lg_u32 s97, 0
    s_cbranch_scc1 L_poll27
L_polld28:
    s_nop 4
    s_waitcnt lgkmcnt(0)
    s_barrier
    v_add_u32 v5, 0xc000, v26
    v_add_u32 v8, 0x18000, v29
    ds_read_b128 v[128:131], v5 offset:0
    ds_read_b64_tr_b16 v[192:193], v8 offset:0
    ds_read_b64_tr_b16 v[194:195], v8 offset:512
    v_mfma_f32_32x32x16_bf16 v[160:175], v[132:135], v[196:199], v[160:175]
    ds_read_b128 v[132:135], v5 offset:1024
    ds_read_b64_tr_b16 v[196:197], v8 offset:2048
    ds_read_b64_tr_b16 v[198:199], v8 offset:2560
    v_mfma_f32_32x32x16_bf16 v[160:175], v[136:139], v[200:203], v[160:175]
    ds_read_b128 v[136:139], v5 offset:2048
    ds_read_b64_tr_b16 v[200:201], v8 offset:4096
    ds_read_b64_tr_b16 v[202:203], v8 offset:4608
    v_mfma_f32_32x32x16_bf16 v[160:175], v[140:143], v[204:207], v[160:175]
    ds_read_b128 v[140:143], v5 offset:3072
    ds_read_b64_tr_b16 v[204:205], v8 offset:6144
    ds_read_b64_tr_b16 v[206:207], v8 offset:6656
    s_waitcnt lgkmcnt(9)
    v_mfma_f32_32x32x16_bf16 v[160:175], v[128:131], v[192:195], v[160:175]
    ds_read_b128 v[128:131], v5 offset:4096
    ds_read_b64_tr_b16 v[192:193], v8 offset:8192
    ds_read_b64_tr_b16 v[194:195], v8 offset:8704
    s_waitcnt lgkmcnt(9)
    v_mfma_f32_32x32x16_bf16 v[160:175], v[132:135], v[196:199], v[160:175]
    ds_read_b128 v[132:135], v5 offset:5120
    ds_read_b64_tr_b16 v[196:197], v8 offset:10240
    ds_read_b64_tr_b16 v[198:199], v8 offset:10752
    s_waitcnt lgkmcnt(9)
    v_mfma_f32_32x32x16_bf16 v[160:175], v[136:139], v[200:203], v[160:175]
    ds_read_b128 v[136:139], v5 offset:6144
    ds_read_b64_tr_b16 v[200:201], v8 offset:12288
    ds_read_b64_tr_b16 v[202:203], v8 offset:12800
    s_waitcnt lgkmcnt(9)
    v_mfma_f32_32x32x16_bf16 v[160:175], v[140:143], v[204:207], v[160:175]
    ds_read_b128 v[140:143], v5 offset:7168
    ds_read_b64_tr_b16 v[204:205], v8 offset:14336
    ds_read_b64_tr_b16 v[206:207], v8 offset:14848
    s_waitcnt lgkmcnt(9)
    v_mfma_f32_32x32x16_bf16 v[160:175], v[128:131], v[192:195], v[160:175]
    s_waitcnt lgkmcnt(0)
    s_barrier
    v_add_u32 v5, 0x10000, v26
    v_add_u32 v8, 0x1c000, v29
    ds_read_b128 v[128:131], v5 offset:0
    ds_read_b64_tr_b16 v[192:193], v8 offset:0
    ds_read_b64_tr_b16 v[194:195], v8 offset:512
    v_mfma_f32_32x32x16_bf16 v[160:175], v[132:135], v[196:199], v[160:175]
    ds_read_b128 v[132:135], v5 offset:1024
    ds_read_b64_tr_b16 v[196:197], v8 offset:2048
    ds_read_b64_tr_b16 v[198:199], v8 offset:2560
    v_mfma_f32_32x32x16_bf16 v[160:175], v[136:139], v[200:203], v[160:175]
    ds_read_b128 v[136:139], v5 offset:2048
    ds_read_b64_tr_b16 v[200:201], v8 offset:4096
    ds_read_b64_tr_b16 v[202:203], v8 offset:4608
    v_mfma_f32_32x32x16_bf16 v[160:175], v[140:143], v[204:207], v[160:175]
    ds_read_b128 v[140:143], v5 offset:3072
    ds_read_b64_tr_b16 v[204:205], v8 offset:6144
    ds_read_b64_tr_b16 v[206:207], v8 offset:6656
    s_waitcnt lgkmcnt(9)
    v_mfma_f32_32x32x16_bf16 v[160:175], v[128:131], v[192:195], v[160:175]
    ds_read_b128 v[128:131], v5 offset:4096
    ds_read_b64_tr_b16 v[192:193], v8 offset:8192
    ds_read_b64_tr_b16 v[194:195], v8 offset:8704
    s_waitcnt lgkmcnt(9)
    v_mfma_f32_32x32x16_bf16 v[160:175], v[132:135], v[196:199], v[160:175]
    ds_read_b128 v[132:135], v5 offset:5120
    ds_read_b64_tr_b16 v[196:197], v8 offset:10240
    ds_read_b64_tr_b16 v[198:199], v8 offset:10752
    s_waitcnt lgkmcnt(9)
    v_mfma_f32_32x32x16_bf16 v[160:175], v[136:139], v[200:203], v[160:175]
    ds_read_b128 v[136:139], v5 offset:6144
    ds_read_b64_tr_b16 v[200:201], v8 offset:12288
    ds_read_b64_tr_b16 v[202:203], v8 offset:12800
    s_waitcnt lgkmcnt(9)
    v_mfma_f32_32x32x16_bf16 v[160:175], v[140:143], v[204:207], v[160:175]
    ds_read_b128 v[140:143], v5 offset:7168
    ds_read_b64_tr_b16 v[204:205], v8 offset:14336
    ds_read_b64_tr_b16 v[206:207], v8 offset:14848
    s_waitcnt lgkmcnt(9)
    v_mfma_f32_32x32x16_bf16 v[160:175], v[128:131], v[192:195], v[160:175]
    s_waitcnt lgkmcnt(0)
    s_barrier
    v_add_u32 v5, 0x14000, v26
    v_add_u32 v8, 0x20000, v29
    ds_read_b128 v[128:131], v5 offset:0
    ds_read_b64_tr_b16 v[192:193], v8 offset:0
    ds_read_b64_tr_b16 v[194:195], v8 offset:512
    v_mfma_f32_32x32x16_bf16 v[160:175], v[132:135], v[196:199], v[160:175]
    ds_read_b128 v[132:135], v5 offset:1024
    ds_read_b64_tr_b16 v[196:197], v8 offset:2048
    ds_read_b64_tr_b16 v[198:199], v8 offset:2560
    v_mfma_f32_32x32x16_bf16 v[160:175], v[136:139], v[200:203], v[160:175]
    ds_read_b128 v[136:139], v5 offset:2048
    ds_read_b64_tr_b16 v[200:201], v8 offset:4096
    ds_read_b64_tr_b16 v[202:203], v8 offset:4608
    v_mfma_f32_32x32x16_bf16 v[160:175], v[140:143], v[204:207], v[160:175]
    ds_read_b128 v[140:143], v5 offset:3072
    ds_read_b64_tr_b16 v[204:205], v8 offset:6144
    ds_read_b64_tr_b16 v[206:207], v8 offset:6656
    s_waitcnt lgkmcnt(9)
    v_mfma_f32_32x32x16_bf16 v[160:175], v[128:131], v[192:195], v[160:175]
    ds_read_b128 v[128:131], v5 offset:4096
    ds_read_b64_tr_b16 v[192:193], v8 offset:8192
    ds_read_b64_tr_b16 v[194:195], v8 offset:8704
    s_waitcnt lgkmcnt(9)
    v_mfma_f32_32x32x16_bf16 v[160:175], v[132:135], v[196:199], v[160:175]
    ds_read_b128 v[132:135], v5 offset:5120
    ds_read_b64_tr_b16 v[196:197], v8 offset:10240
    ds_read_b64_tr_b16 v[198:199], v8 offset:10752
    s_waitcnt lgkmcnt(9)
    v_mfma_f32_32x32x16_bf16 v[160:175], v[136:139], v[200:203], v[160:175]
    ds_read_b128 v[136:139], v5 offset:6144
    ds_read_b64_tr_b16 v[200:201], v8 offset:12288
    ds_read_b64_tr_b16 v[202:203], v8 offset:12800
    s_waitcnt lgkmcnt(9)
    v_mfma_f32_32x32x16_bf16 v[160:175], v[140:143], v[204:207], v[160:175]
    ds_read_b128 v[140:143], v5 offset:7168
    ds_read_b64_tr_b16 v[204:205], v8 offset:14336
    ds_read_b64_tr_b16 v[206:207], v8 offset:14848
    s_waitcnt lgkmcnt(9)
    v_mfma_f32_32x32x16_bf16 v[160:175], v[128:131], v[192:195], v[160:175]
    s_waitcnt lgkmcnt(0)
    s_barrier
    s_add_u32 s101, s26, 3
    v_mov_b32 v19, s101
    buffer_store_dword v19, v24, s[60:63], 0 offen offset:0 sc0 sc1
    v_add_u32 v5, 0x4000, v26
    v_add_u32 v9, 0x0, v30
    v_xor_b32 v20, 32, v9
    v_xor_b32 v21, 64, v9
    v_xor_b32 v22, 96, v9
    ds_read_b128 v[128:131], v5 offset:0
    ds_read_b128 v[192:195], v9 offset:0
    v_mfma_f32_32x32x16_bf16 v[160:175], v[132:135], v[196:199], v[160:175]
    ds_read_b128 v[132:135], v5 offset:1024
    ds_read_b128 v[196:199], v20 offset:0
    v_mfma_f32_32x32x16_bf16 v[160:175], v[136:139], v[200:203], v[160:175]
    ds_read_b128 v[136:139], v5 offset:2048
    ds_read_b128 v[200:203], v21 offset:0
    v_mfma_f32_32x32x16_bf16 v[160:175], v[140:143], v[204:207], v[160:175]
    ds_read_b128 v[140:143], v5 offset:3072
    ds_read_b128 v[204:207], v22 offset:0
    s_waitcnt lgkmcnt(6)
    v_mfma_f32_32x32x16_bf16 v[176:191], v[128:131], v[192:195], 0
    ds_read_b128 v[128:131], v5 offset:4096
    ds_read_b128 v[192:195], v9 offset:8192
    s_waitcnt lgkmcnt(6)
    v_mfma_f32_32x32x16_bf16 v[176:191], v[132:135], v[196:199], v[176:191]
    ds_read_b128 v[132:135], v5 offset:5120
    ds_read_b128 v[196:199], v20 offset:8192
    s_waitcnt lgkmcnt(6)
    v_mfma_f32_32x32x16_bf16 v[176:191], v[136:139], v[200:203], v[176:191]
    ds_read_b128 v[136:139], v5 offset:6144
    ds_read_b128 v[200:203], v21 offset:8192
    s_waitcnt lgkmcnt(6)
    v_mfma_f32_32x32x16_bf16 v[176:191], v[140:143], v[204:207], v[176:191]
    ds_read_b128 v[140:143], v5 offset:7168
    ds_read_b128 v[204:207], v22 offset:8192
    s_waitcnt lgkmcnt(6)
    v_mfma_f32_32x32x16_bf16 v[176:191], v[128:131], v[192:195], v[176:191]
    s_waitcnt lgkmcnt(0)
    s_barrier
    v_add_u32 v5, 0x18000, v26
    v_add_u32 v9, 0x8000, v30
    v_xor_b32 v20, 32, v9
    v_xor_b32 v21, 64, v9
    v_xor_b32 v22, 96, v9
    ds_read_b128 v[128:131], v5 offset:0
    ds_read_b128 v[192:195], v9 offset:0
    v_mfma_f32_32x32x16_bf16 v[176:191], v[132:135], v[196:199], v[176:191]
    ds_read_b128 v[132:135], v5 offset:1024
    ds_read_b128 v[196:199], v20 offset:0
    v_mfma_f32_32x32x16_bf16 v[176:191], v[136:139], v[200:203], v[176:191]
    ds_read_b128 v[136:139], v5 offset:2048
    ds_read_b128 v[200:203], v21 offset:0
    v_mfma_f32_32x32x16_bf16 v[176:191], v[140:143], v[204:207], v[176:191]
    ds_read_b128 v[140:143], v5 offset:3072
    ds_read_b128 v[204:207], v22 offset:0
    s_waitcnt lgkmcnt(6)
    v_mfma_f32_32x32x16_bf16 v[176:191], v[128:131], v[192:195], v[176:191]
    ds_read_b128 v[128:131], v5 offset:4096
    ds_read_b128 v[192:195], v9 offset:8192
    s_waitcnt lgkmcnt(6)
    v_mfma_f32_32x32x16_bf16 v[176:191], v[132:135], v[196:199], v[176:191]
    ds_read_b128 v[132:135], v5 offset:5120
    ds_read_b128 v[196:199], v20 offset:8192
    s_waitcnt lgkmcnt(6)
    v_mfma_f32_32x32x16_bf16 v[176:191], v[136:139], v[200:203], v[176:191]
    ds_read_b128 v[136:139], v5 offset:6144
    ds_read_b128 v[200:203], v21 offset:8192
    s_waitcnt lgkmcnt(6)
    v_mfma_f32_32x32x16_bf16 v[176:191], v[140:143], v[204:207], v[176:191]
    ds_read_b128 v[140:143], v5 offset:7168
    ds_read_b128 v[204:207], v22 offset:8192
    s_waitcnt lgkmcnt(6)
    v_mfma_f32_32x32x16_bf16 v[176:191], v[128:131], v[192:195], v[176:191]
    s_waitcnt lgkmcnt(0)
    s_barrier
    v_add_u32 v5, 0x1c000, v26
    v_add_u32 v9, 0xc000, v30
    v_xor_b32 v20, 32, v9
    v_xor_b32 v21, 64, v9
    v_xor_b32 v22, 96, v9
    ds_read_b128 v[128:131], v5 offset:0
    ds_read_b128 v[192:195], v9 offset:0
    v_mfma_f32_32x32x16_bf16 v[176:191], v[132:135], v[196:199], v[176:191]
    ds_read_b128 v[132:135], v5 offset:1024
    ds_read_b128 v[196:199], v20 offset:0
    v_mfma_f32_32x32x16_bf16 v[176:191], v[136:139], v[200:203], v[176:191]
    ds_read_b128 v[136:139], v5 offset:2048
    ds_read_b128 v[200:203], v21 offset:0
    v_mfma_f32_32x32x16_bf16 v[176:191], v[140:143], v[204:207], v[176:191]
    ds_read_b128 v[140:143], v5 offset:3072
    ds_read_b128 v[204:207], v22 offset:0
    s_waitcnt lgkmcnt(6)
    v_mfma_f32_32x32x16_bf16 v[176:191], v[128:131], v[192:195], v[176:191]
    s_lshr_b32 s6, s92, 1
    s_and_b32 s7, s92, 1
    s_lshl_b32 s4, s6, 7
    v_lshrrev_b32 v14, 5, v0
    v_lshlrev_b32 v10, 6, v14
    v_add_u32 v10, s4, v10
    v_add_u32 v10, 0x24a00, v10
    ds_read_b128 v[128:131], v5 offset:4096
    ds_read_b128 v[192:195], v9 offset:8192
    s_waitcnt lgkmcnt(6)
    v_mfma_f32_32x32x16_bf16 v[176:191], v[132:135], v[196:199], v[176:191]
    s_lshl_b32 s4, s6, 12
    s_lshl_b32 s5, s7, 6
    s_add_u32 s4, s4, s5
    s_add_u32 s4, s4, 0x25b00
    v_lshlrev_b32 v14, 11, v14
    v_and_b32 v15, 31, v0
    v_lshl_add_u32 v14, v15, 1, v14
    v_add_u32 v14, s4, v14
    ds_read_b128 v[132:135], v5 offset:5120
    ds_read_b128 v[196:199], v20 offset:8192
    s_waitcnt lgkmcnt(6)
    v_mfma_f32_32x32x16_bf16 v[176:191], v[136:139], v[200:203], v[176:191]
    ds_read_u16 v208, v14 offset:0
    ds_read_u16 v209, v14 offset:128
    ds_read_u16 v210, v14 offset:256
    ds_read_u16 v211, v14 offset:384
    ds_read_u16 v212, v14 offset:512
    ds_read_u16 v213, v14 offset:640
    ds_read_u16 v214, v14 offset:768
    ds_read_b128 v[136:139], v5 offset:6144
    ds_read_b128 v[200:203], v21 offset:8192
    s_waitcnt lgkmcnt(13)
    v_mfma_f32_32x32x16_bf16 v[176:191], v[140:143], v[204:207], v[176:191]
    ds_read_u16 v215, v14 offset:896
    ds_read_u16 v216, v14 offset:1024
    ds_read_u16 v217, v14 offset:1152
    ds_read_u16 v218, v14 offset:1280
    ds_read_u16 v219, v14 offset:1408
    ds_read_u16 v220, v14 offset:1536
    ds_read_u16 v221, v14 offset:1664
    ds_read_u16 v222, v14 offset:1792
    ds_read_u16 v223, v14 offset:1920
    ds_read_b128 v[140:143], v5 offset:7168
    ds_read_b128 v[204:207], v22 offset:8192
    s_waitcnt lgkmcnt(15)
    v_mfma_f32_32x32x16_bf16 v[176:191], v[128:131], v[192:195], v[176:191]
    ds_read_b128 v[96:99], v10 offset:0
    ds_read_b128 v[80:83], v10 offset:512
    ds_read_b128 v[100:103], v10 offset:16
    ds_read_b128 v[84:87], v10 offset:528
    ds_read_b128 v[104:107], v10 offset:32
    ds_read_b128 v[88:91], v10 offset:544
    ds_read_b128 v[108:111], v10 offset:48
    ds_read_b128 v[92:95], v10 offset:560
    s_waitcnt lgkmcnt(0)
    s_barrier
    buffer_load_dword v27, v25, s[60:63], 0 offen sc0 sc1
    v_add_u32 v5, 0x20000, v26
    v_add_u32 v9, 0x10000, v30
    v_xor_b32 v20, 32, v9
    v_xor_b32 v21, 64, v9
    v_xor_b32 v22, 96, v9
    ds_read_b128 v[128:131], v5 offset:0
    ds_read_b128 v[192:195], v9 offset:0
    v_mfma_f32_32x32x16_bf16 v[176:191], v[132:135], v[196:199], v[176:191]
    ds_read_b128 v[132:135], v5 offset:1024
    ds_read_b128 v[196:199], v20 offset:0
    v_mfma_f32_32x32x16_bf16 v[176:191], v[136:139], v[200:203], v[176:191]
    ds_read_b128 v[136:139], v5 offset:2048
    ds_read_b128 v[200:203], v21 offset:0
    v_mfma_f32_32x32x16_bf16 v[176:191], v[140:143], v[204:207], v[176:191]
    ds_read_b128 v[140:143], v5 offset:3072
    ds_read_b128 v[204:207], v22 offset:0
    s_waitcnt lgkmcnt(6)
    v_mfma_f32_32x32x16_bf16 v[176:191], v[128:131], v[192:195], v[176:191]
    v_lshlrev_b32 v23, 16, v23
    v_lshlrev_b32 v208, 16, v208
    v_lshlrev_b32 v209, 16, v209
    v_lshlrev_b32 v210, 16, v210
    v_lshlrev_b32 v211, 16, v211
    ds_read_b128 v[128:131], v5 offset:4096
    ds_read_b128 v[192:195], v9 offset:8192
    s_waitcnt lgkmcnt(6)
    v_mfma_f32_32x32x16_bf16 v[176:191], v[132:135], v[196:199], v[176:191]
    v_lshlrev_b32 v212, 16, v212
    v_lshlrev_b32 v213, 16, v213
    v_lshlrev_b32 v214, 16, v214
    v_lshlrev_b32 v215, 16, v215
    v_lshlrev_b32 v216, 16, v216
    ds_read_b128 v[132:135], v5 offset:5120
    ds_read_b128 v[196:199], v20 offset:8192
    s_waitcnt lgkmcnt(6)
    v_mfma_f32_32x32x16_bf16 v[176:191], v[136:139], v[200:203], v[176:191]
    v_lshlrev_b32 v217, 16, v217
    v_lshlrev_b32 v218, 16, v218
    v_lshlrev_b32 v219, 16, v219
    v_lshlrev_b32 v220, 16, v220
    v_lshlrev_b32 v221, 16, v221
    ds_read_b128 v[136:139], v5 offset:6144
    ds_read_b128 v[200:203], v21 offset:8192
    s_waitcnt lgkmcnt(6)
    v_mfma_f32_32x32x16_bf16 v[176:191], v[140:143], v[204:207], v[176:191]
    v_lshlrev_b32 v222, 16, v222
    v_lshlrev_b32 v223, 16, v223
    v_fma_f32 v80, v208, v80, v96
    v_fma_f32 v81, v209, v81, v97
    v_fma_f32 v82, v210, v82, v98
    ds_read_b128 v[140:143], v5 offset:7168
    ds_read_b128 v[204:207], v22 offset:8192
    s_waitcnt lgkmcnt(6)
    v_mfma_f32_32x32x16_bf16 v[176:191], v[128:131], v[192:195], v[176:191]
    v_fma_f32 v83, v211, v83, v99
    v_fma_f32 v84, v212, v84, v100
    v_fma_f32 v85, v213, v85, v101
    v_fma_f32 v86, v214, v86, v102
    v_fma_f32 v87, v215, v87, v103
    s_add_u32 s101, s26, 3
    s_waitcnt vmcnt(0)
    v_subrev_u32 v27, s101, v27
    v_cmp_ge_u32 vcc, 4, v27
    s_nop 3
    s_cmp_eq_u64 vcc, exec
    s_cbranch_scc1 L_polld30
    s_mov_b32 s97, 400000
L_poll29:
    s_sleep 1
    buffer_load_dword v27, v25, s[60:63], 0 offen sc0 sc1
    s_waitcnt vmcnt(0)
    v_subrev_u32 v27, s101, v27
    v_cmp_ge_u32 vcc, 4, v27
    s_nop 4
    s_cmp_eq_u64 vcc, exec
    s_cbranch_scc1 L_polld30
    s_sub_u32 s97, s97, 1
    s_cmp_lg_u32 s97, 0
    s_cbranch_scc1 L_poll29
L_polld30:
    s_nop 4
    s_waitcnt lgkmcnt(0)
    s_barrier
    v_add_u32 v5, 0x0, v26
    v_add_u32 v9, 0x14000, v30
    v_xor_b32 v20, 32, v9
    v_xor_b32 v21, 64, v9
    v_xor_b32 v22, 96, v9
    ds_read_b128 v[128:131], v5 offset:0
    ds_read_b128 v[192:195], v9 offset:0
    v_mfma_f32_32x32x16_bf16 v[176:191], v[132:135], v[196:199], v[176:191]
    ds_read_b128 v[132:135], v5 offset:1024
    ds_read_b128 v[196:199], v20 offset:0
    v_mfma_f32_32x32x16_bf16 v[176:191], v[136:139], v[200:203], v[176:191]
    ds_read_b128 v[136:139], v5 offset:2048
    ds_read_b128 v[200:203], v21 offset:0
    v_mfma_f32_32x32x16_bf16 v[176:191], v[140:143], v[204:207], v[176:191]
    ds_read_b128 v[140:143], v5 offset:3072
    ds_read_b128 v[204:207], v22 offset:0
    s_waitcnt lgkmcnt(6)
    v_mfma_f32_32x32x16_bf16 v[176:191], v[128:131], v[192:195], v[176:191]
    v_fma_f32 v88, v216, v88, v104
    v_fma_f32 v89, v217, v89, v105
    v_fma_f32 v90, v218, v90, v106
    v_fma_f32 v91, v219, v91, v107
    v_fma_f32 v92, v220, v92, v108
    ds_read_b128 v[128:131], v5 offset:4096
    ds_read_b128 v[192:195], v9 offset:8192
    s_waitcnt lgkmcnt(6)
    v_mfma_f32_32x32x16_bf16 v[176:191], v[132:135], v[196:199], v[176:191]
    v_fma_f32 v93, v221, v93, v109
    v_fma_f32 v94, v222, v94, v110
    v_fma_f32 v95, v223, v95, v111
    s_mul_i32 s4, s92, 4608
    v_lshrrev_b32 v10, 5, v0
    v_mul_u32_u24 v10, 2304, v10
    ds_read_b128 v[132:135], v5 offset:5120
    ds_read_b128 v[196:199], v20 offset:8192
    s_waitcnt lgkmcnt(6)
    v_mfma_f32_32x32x16_bf16 v[176:191], v[136:139], v[200:203], v[176:191]
    v_and_b32 v11, 31, v0
    v_lshl_add_u32 v10, v11, 2, v10
    v_add_u32 v112, s4, v10
    v_lshrrev_b32 v10, 3, v0
    v_mul_u32_u24 v10, 144, v10
    ds_read_b128 v[136:139], v5 offset:6144
    ds_read_b128 v[200:203], v21 offset:8192
    s_waitcnt lgkmcnt(6)
    v_mfma_f32_32x32x16_bf16 v[176:191], v[140:143], v[204:207], v[176:191]
    v_and_b32 v11, 7, v0
    v_lshl_add_u32 v10, v11, 4, v10
    v_add_u32 v113, s4, v10
    s_lshl_b32 s4, s90, 6
    s_lshl_b32 s5, s6, 5
    s_add_u32 s4, s4, s5
    v_lshrrev_b32 v10, 3, v0
    ds_read_b128 v[140:143], v5 offset:7168
    ds_read_b128 v[204:207], v22 offset:8192
    s_waitcnt lgkmcnt(6)
    v_mfma_f32_32x32x16_bf16 v[176:191], v[128:131], v[192:195], v[176:191]
    v_add_u32 v10, s4, v10
    v_lshlrev_b32 v10, 11, v10
    s_lshl_b32 s4, s91, 8
    s_lshl_b32 s5, s7, 7
    s_add_u32 s4, s4, s5
    v_and_b32 v11, 7, v0
    v_lshl_add_u32 v10, v11, 4, v10
    s_waitcnt lgkmcnt(0)
    s_barrier
    v_add_u32 v5, 0x8000, v26
    v_add_u32 v9, 0x4000, v30
    v_xor_b32 v20, 32, v9
    v_xor_b32 v21, 64, v9
    v_xor_b32 v22, 96, v9
    ds_read_b128 v[128:131], v5 offset:0
    ds_read_b128 v[192:195], v9 offset:0
    v_mfma_f32_32x32x16_bf16 v[176:191], v[132:135], v[196:199], v[176:191]
    ds_read_b128 v[132:135], v5 offset:1024
    ds_read_b128 v[196:199], v20 offset:0
    v_mfma_f32_32x32x16_bf16 v[176:191], v[136:139], v[200:203], v[176:191]
    ds_read_b128 v[136:139], v5 offset:2048
    ds_read_b128 v[200:203], v21 offset:0
    v_mfma_f32_32x32x16_bf16 v[176:191], v[140:143], v[204:207], v[176:191]
    ds_read_b128 v[140:143], v5 offset:3072
    ds_read_b128 v[204:207], v22 offset:0
    s_waitcnt lgkmcnt(6)
    v_mfma_f32_32x32x16_bf16 v[176:191], v[128:131], v[192:195], v[176:191]
    v_add_u32 v31, s4, v10
    ds_read_b128 v[128:131], v5 offset:4096
    ds_read_b128 v[192:195], v9 offset:8192
    s_waitcnt lgkmcnt(6)
    v_mfma_f32_32x32x16_bf16 v[176:191], v[132:135], v[196:199], v[176:191]
    ds_read_b128 v[132:135], v5 offset:5120
    ds_read_b128 v[196:199], v20 offset:8192
    s_waitcnt lgkmcnt(6)
    v_mfma_f32_32x32x16_bf16 v[176:191], v[136:139], v[200:203], v[176:191]
    ds_read_b128 v[136:139], v5 offset:6144
    ds_read_b128 v[200:203], v21 offset:8192
    s_waitcnt lgkmcnt(6)
    v_mfma_f32_32x32x16_bf16 v[176:191], v[140:143], v[204:207], v[176:191]
    ds_read_b128 v[140:143], v5 offset:7168
    ds_read_b128 v[204:207], v22 offset:8192
    s_waitcnt lgkmcnt(6)
    v_mfma_f32_32x32x16_bf16 v[176:191], v[128:131], v[192:195], v[176:191]
    s_waitcnt lgkmcnt(0)
    s_barrier
    v_add_u32 v5, 0xc000, v26
    v_add_u32 v9, 0x18000, v30
    v_xor_b32 v20, 32, v9
    v_xor_b32 v21, 64, v9
    v_xor_b32 v22, 96, v9
    ds_read_b128 v[128:131], v5 offset:0
    ds_read_b128 v[192:195], v9 offset:0
    v_mfma_f32_32x32x16_bf16 v[176:191], v[132:135], v[196:199], v[176:191]
    ds_read_b128 v[132:135], v5 offset:1024
    ds_read_b128 v[196:199], v20 offset:0
    v_mfma_f32_32x32x16_bf16 v[176:191], v[136:139], v[200:203], v[176:191]
    ds_read_b128 v[136:139], v5 offset:2048
    ds_read_b128 v[200:203], v21 offset:0
    v_mfma_f32_32x32x16_bf16 v[176:191], v[140:143], v[204:207], v[176:191]
    ds_read_b128 v[140:143], v5 offset:3072
    ds_read_b128 v[204:207], v22 offset:0
    s_waitcnt lgkmcnt(6)
    v_mfma_f32_32x32x16_bf16 v[176:191], v[128:131], v[192:195], v[176:191]
    ds_read_b128 v[128:131], v5 offset:4096
    ds_read_b128 v[192:195], v9 offset:8192
    s_waitcnt lgkmcnt(6)
    v_mfma_f32_32x32x16_bf16 v[176:191], v[132:135], v[196:199], v[176:191]
    ds_read_b128 v[132:135], v5 offset:5120
    ds_read_b128 v[196:199], v20 offset:8192
    s_waitcnt lgkmcnt(6)
    v_mfma_f32_32x32x16_bf16 v[176:191], v[136:139], v[200:203], v[176:191]
    ds_read_b128 v[136:139], v5 offset:6144
    ds_read_b128 v[200:203], v21 offset:8192
    s_waitcnt lgkmcnt(6)
    v_mfma_f32_32x32x16_bf16 v[176:191], v[140:143], v[204:207], v[176:191]
    ds_read_b128 v[140:143], v5 offset:7168
    ds_read_b128 v[204:207], v22 offset:8192
    s_waitcnt lgkmcnt(6)
    v_mfma_f32_32x32x16_bf16 v[176:191], v[128:131], v[192:195], v[176:191]
    s_waitcnt lgkmcnt(0)
    s_barrier
    v_add_u32 v5, 0x10000, v26
    v_add_u32 v9, 0x1c000, v30
    v_xor_b32 v20, 32, v9
    v_xor_b32 v21, 64, v9
    v_xor_b32 v22, 96, v9
    ds_read_b128 v[128:131], v5 offset:0
    ds_read_b128 v[192:195], v9 offset:0
    v_mfma_f32_32x32x16_bf16 v[176:191], v[132:135], v[196:199], v[176:191]
    ds_read_b128 v[132:135], v5 offset:1024
    ds_read_b128 v[196:199], v20 offset:0
    v_mfma_f32_32x32x16_bf16 v[176:191], v[136:139], v[200:203], v[176:191]
    ds_read_b128 v[136:139], v5 offset:2048
    ds_read_b128 v[200:203], v21 offset:0
    v_mfma_f32_32x32x16_bf16 v[176:191], v[140:143], v[204:207], v[176:191]
    ds_read_b128 v[140:143], v5 offset:3072
    ds_read_b128 v[204:207], v22 offset:0
    s_waitcnt lgkmcnt(6)
    v_mfma_f32_32x32x16_bf16 v[176:191], v[128:131], v[192:195], v[176:191]
    ds_read_b128 v[128:131], v5 offset:4096
    ds_read_b128 v[192:195], v9 offset:8192
    s_waitcnt lgkmcnt(6)
    v_mfma_f32_32x32x16_bf16 v[176:191], v[132:135], v[196:199], v[176:191]
    ds_read_b128 v[132:135], v5 offset:5120
    ds_read_b128 v[196:199], v20 offset:8192
    s_waitcnt lgkmcnt(6)
    v_mfma_f32_32x32x16_bf16 v[176:191], v[136:139], v[200:203], v[176:191]
    ds_read_b128 v[136:139], v5 offset:6144
    ds_read_b128 v[200:203], v21 offset:8192
    s_waitcnt lgkmcnt(6)
    v_mfma_f32_32x32x16_bf16 v[176:191], v[140:143], v[204:207], v[176:191]
    ds_read_b128 v[140:143], v5 offset:7168
    ds_read_b128 v[204:207], v22 offset:8192
    s_waitcnt lgkmcnt(6)
    v_mfma_f32_32x32x16_bf16 v[176:191], v[128:131], v[192:195], v[176:191]
    s_waitcnt lgkmcnt(0)
    s_barrier
    v_add_u32 v5, 0x14000, v26
    v_add_u32 v8, 0x20000, v29
    ds_read_b128 v[128:131], v5 offset:0
    ds_read_b64_tr_b16 v[192:193], v8 offset:0
    ds_read_b64_tr_b16 v[194:195], v8 offset:512
    v_mfma_f32_32x32x16_bf16 v[176:191], v[132:135], v[196:199], v[176:191]
    ds_read_b128 v[132:135], v5 offset:1024
    ds_read_b64_tr_b16 v[196:197], v8 offset:2048
    ds_read_b64_tr_b16 v[198:199], v8 offset:2560
    v_mfma_f32_32x32x16_bf16 v[176:191], v[136:139], v[200:203], v[176:191]
    ds_read_b128 v[136:139], v5 offset:2048
    ds_read_b64_tr_b16 v[200:201], v8 offset:4096
    ds_read_b64_tr_b16 v[202:203], v8 offset:4608
    v_mfma_f32_32x32x16_bf16 v[176:191], v[140:143], v[204:207], v[176:191]
    ds_read_b128 v[140:143], v5 offset:3072
    ds_read_b64_tr_b16 v[204:205], v8 offset:6144
    ds_read_b64_tr_b16 v[206:207], v8 offset:6656
    s_waitcnt lgkmcnt(9)
    v_mfma_f32_32x32x16_bf16 v[160:175], v[128:131], v[192:195], v[160:175]
    ds_read_b128 v[128:131], v5 offset:4096
    ds_read_b64_tr_b16 v[192:193], v8 offset:8192
    ds_read_b64_tr_b16 v[194:195], v8 offset:8704
    s_waitcnt lgkmcnt(9)
    v_mfma_f32_32x32x16_bf16 v[160:175], v[132:135], v[196:199], v[160:175]
    ds_read_b128 v[132:135], v5 offset:5120
    ds_read_b64_tr_b16 v[196:197], v8 offset:10240
    ds_read_b64_tr_b16 v[198:199], v8 offset:10752
    s_waitcnt lgkmcnt(9)
    v_mfma_f32_32x32x16_bf16 v[160:175], v[136:139], v[200:203], v[160:175]
    ds_read_b128 v[136:139], v5 offset:6144
    ds_read_b64_tr_b16 v[200:201], v8 offset:12288
    ds_read_b64_tr_b16 v[202:203], v8 offset:12800
    s_waitcnt lgkmcnt(9)
    v_mfma_f32_32x32x16_bf16 v[160:175], v[140:143], v[204:207], v[160:175]
    v_fma_f32 v176, v80, v23, v176
    v_fma_f32 v177, v81, v23, v177
    v_fma_f32 v178, v82, v23, v178
    v_fma_f32 v179, v83, v23, v179
    v_fma_f32 v180, v84, v23, v180
    v_fma_f32 v181, v85, v23, v181
    v_fma_f32 v182, v86, v23, v182
    v_fma_f32 v183, v87, v23, v183
    v_fma_f32 v184, v88, v23, v184
    v_fma_f32 v185, v89, v23, v185
    ds_read_b128 v[140:143], v5 offset:7168
    ds_read_b64_tr_b16 v[204:205], v8 offset:14336
    ds_read_b64_tr_b16 v[206:207], v8 offset:14848
    s_waitcnt lgkmcnt(9)
    v_mfma_f32_32x32x16_bf16 v[160:175], v[128:131], v[192:195], v[160:175]
    v_fma_f32 v186, v90, v23, v186
    v_fma_f32 v187, v91, v23, v187
    v_fma_f32 v188, v92, v23, v188
    v_fma_f32 v189, v93, v23, v189
    v_fma_f32 v190, v94, v23, v190
    s_waitcnt lgkmcnt(0)
    s_barrier
    v_add_u32 v5, 0x4000, v26
    v_add_u32 v8, 0x0, v29
    ds_read_b128 v[128:131], v5 offset:0
    ds_read_b64_tr_b16 v[192:193], v8 offset:0
    ds_read_b64_tr_b16 v[194:195], v8 offset:512
    v_mfma_f32_32x32x16_bf16 v[160:175], v[132:135], v[196:199], v[160:175]
    ds_read_b128 v[132:135], v5 offset:1024
    ds_read_b64_tr_b16 v[196:197], v8 offset:2048
    ds_read_b64_tr_b16 v[198:199], v8 offset:2560
    v_mfma_f32_32x32x16_bf16 v[160:175], v[136:139], v[200:203], v[160:175]
    ds_read_b128 v[136:139], v5 offset:2048
    ds_read_b64_tr_b16 v[200:201], v8 offset:4096
    ds_read_b64_tr_b16 v[202:203], v8 offset:4608
    v_mfma_f32_32x32x16_bf16 v[160:175], v[140:143], v[204:207], v[160:175]
    ds_read_b128 v[140:143], v5 offset:3072
    ds_read_b64_tr_b16 v[204:205], v8 offset:6144
    ds_read_b64_tr_b16 v[206:207], v8 offset:6656
    s_waitcnt lgkmcnt(9)
    v_mfma_f32_32x32x16_bf16 v[160:175], v[128:131], v[192:195], v[160:175]
    v_fma_f32 v191, v95, v23, v191
    ds_read_b128 v[128:131], v5 offset:4096
    ds_read_b64_tr_b16 v[192:193], v8 offset:8192
    ds_read_b64_tr_b16 v[194:195], v8 offset:8704
    s_waitcnt lgkmcnt(9)
    v_mfma_f32_32x32x16_bf16 v[160:175], v[132:135], v[196:199], v[160:175]
    ds_read_b128 v[132:135], v5 offset:5120
    ds_read_b64_tr_b16 v[196:197], v8 offset:10240
    ds_read_b64_tr_b16 v[198:199], v8 offset:10752
    s_waitcnt lgkmcnt(9)
    v_mfma_f32_32x32x16_bf16 v[160:175], v[136:139], v[200:203], v[160:175]
    ds_read_b128 v[136:139], v5 offset:6144
    ds_read_b64_tr_b16 v[200:201], v8 offset:12288
    ds_read_b64_tr_b16 v[202:203], v8 offset:12800
    s_waitcnt lgkmcnt(9)
    v_mfma_f32_32x32x16_bf16 v[160:175], v[140:143], v[204:207], v[160:175]
    ds_read_b128 v[140:143], v5 offset:7168
    ds_read_b64_tr_b16 v[204:205], v8 offset:14336
    ds_read_b64_tr_b16 v[206:207], v8 offset:14848
    s_waitcnt lgkmcnt(9)
    v_mfma_f32_32x32x16_bf16 v[160:175], v[128:131], v[192:195], v[160:175]
    s_waitcnt lgkmcnt(0)
    s_barrier
    v_add_u32 v5, 0x18000, v26
    v_add_u32 v8, 0x8000, v29
    ds_read_b128 v[128:131], v5 offset:0
    ds_read_b64_tr_b16 v[192:193], v8 offset:0
    ds_read_b64_tr_b16 v[194:195], v8 offset:512
    v_mfma_f32_32x32x16_bf16 v[160:175], v[132:135], v[196:199], v[160:175]
    ds_read_b128 v[132:135], v5 offset:1024
    ds_read_b64_tr_b16 v[196:197], v8 offset:2048
    ds_read_b64_tr_b16 v[198:199], v8 offset:2560
    v_mfma_f32_32x32x16_bf16 v[160:175], v[136:139], v[200:203], v[160:175]
    ds_read_b128 v[136:139], v5 offset:2048
    ds_read_b64_tr_b16 v[200:201], v8 offset:4096
    ds_read_b64_tr_b16 v[202:203], v8 offset:4608
    v_mfma_f32_32x32x16_bf16 v[160:175], v[140:143], v[204:207], v[160:175]
    ds_read_b128 v[140:143], v5 offset:3072
    ds_read_b64_tr_b16 v[204:205], v8 offset:6144
    ds_read_b64_tr_b16 v[206:207], v8 offset:6656
    s_waitcnt lgkmcnt(9)
    v_mfma_f32_32x32x16_bf16 v[160:175], v[128:131], v[192:195], v[160:175]
    ds_read_b128 v[128:131], v5 offset:4096
    ds_read_b64_tr_b16 v[192:193], v8 offset:8192
    ds_read_b64_tr_b16 v[194:195], v8 offset:8704
    s_waitcnt lgkmcnt(9)
    v_mfma_f32_32x32x16_bf16 v[160:175], v[132:135], v[196:199], v[160:175]
    ds_read_b128 v[132:135], v5 offset:5120
    ds_read_b64_tr_b16 v[196:197], v8 offset:10240
    ds_read_b64_tr_b16 v[198:199], v8 offset:10752
    s_waitcnt lgkmcnt(9)
    v_mfma_f32_32x32x16_bf16 v[160:175], v[136:139], v[200:203], v[160:175]
    ds_read_b128 v[136:139], v5 offset:6144
    ds_read_b64_tr_b16 v[200:201], v8 offset:12288
    ds_read_b64_tr_b16 v[202:203], v8 offset:12800
    s_waitcnt lgkmcnt(9)
    v_mfma_f32_32x32x16_bf16 v[160:175], v[140:143], v[204:207], v[160:175]
    ds_read_b128 v[140:143], v5 offset:7168
    ds_read_b64_tr_b16 v[204:205], v8 offset:14336
    ds_read_b64_tr_b16 v[206:207], v8 offset:14848
    s_waitcnt lgkmcnt(9)
    v_mfma_f32_32x32x16_bf16 v[160:175], v[128:131], v[192:195], v[160:175]
    s_waitcnt lgkmcnt(0)
    s_barrier
    v_add_u32 v5, 0x1c000, v26
    v_add_u32 v8, 0xc000, v29
    ds_read_b128 v[128:131], v5 offset:0
    ds_read_b64_tr_b16 v[192:193], v8 offset:0
    ds_read_b64_tr_b16 v[194:195], v8 offset:512
    v_mfma_f32_32x32x16_bf16 v[160:175], v[132:135], v[196:199], v[160:175]
    ds_read_b128 v[132:135], v5 offset:1024
    ds_read_b64_tr_b16 v[196:197], v8 offset:2048
    ds_read_b64_tr_b16 v[198:199], v8 offset:2560
    v_mfma_f32_32x32x16_bf16 v[160:175], v[136:139], v[200:203], v[160:175]
    ds_read_b128 v[136:139], v5 offset:2048
    ds_read_b64_tr_b16 v[200:201], v8 offset:4096
    ds_read_b64_tr_b16 v[202:203], v8 offset:4608
    v_mfma_f32_32x32x16_bf16 v[160:175], v[140:143], v[204:207], v[160:175]
    ds_read_b128 v[140:143], v5 offset:3072
    ds_read_b64_tr_b16 v[204:205], v8 offset:6144
    ds_read_b64_tr_b16 v[206:207], v8 offset:6656
    s_waitcnt lgkmcnt(9)
    v_mfma_f32_32x32x16_bf16 v[160:175], v[128:131], v[192:195], v[160:175]
    ds_read_b128 v[128:131], v5 offset:4096
    ds_read_b64_tr_b16 v[192:193], v8 offset:8192
    ds_read_b64_tr_b16 v[194:195], v8 offset:8704
    s_waitcnt lgkmcnt(9)
    v_mfma_f32_32x32x16_bf16 v[160:175], v[132:135], v[196:199], v[160:175]
    ds_read_b128 v[132:135], v5 offset:5120
    ds_read_b64_tr_b16 v[196:197], v8 offset:10240
    ds_read_b64_tr_b16 v[198:199], v8 offset:10752
    s_waitcnt lgkmcnt(9)
    v_mfma_f32_32x32x16_bf16 v[160:175], v[136:139], v[200:203], v[160:175]
    ds_read_b128 v[136:139], v5 offset:6144
    ds_read_b64_tr_b16 v[200:201], v8 offset:12288
    ds_read_b64_tr_b16 v[202:203], v8 offset:12800
    s_waitcnt lgkmcnt(9)
    v_mfma_f32_32x32x16_bf16 v[160:175], v[140:143], v[204:207], v[160:175]
    ds_read_b128 v[140:143], v5 offset:7168
    ds_read_b64_tr_b16 v[204:205], v8 offset:14336
    ds_read_b64_tr_b16 v[206:207], v8 offset:14848
    s_waitcnt lgkmcnt(9)
    v_mfma_f32_32x32x16_bf16 v[160:175], v[128:131], v[192:195], v[160:175]
    s_waitcnt lgkmcnt(0)
    s_barrier
    v_add_u32 v5, 0x20000, v26
    v_add_u32 v8, 0x10000, v29
    ds_read_b128 v[128:131], v5 offset:0
    ds_read_b64_tr_b16 v[192:193], v8 offset:0
    ds_read_b64_tr_b16 v[194:195], v8 offset:512
    v_mfma_f32_32x32x16_bf16 v[160:175], v[132:135], v[196:199], v[160:175]
    ds_read_b128 v[132:135], v5 offset:1024
    ds_read_b64_tr_b16 v[196:197], v8 offset:2048
    ds_read_b64_tr_b16 v[198:199], v8 offset:2560
    v_mfma_f32_32x32x16_bf16 v[160:175], v[136:139], v[200:203], v[160:175]
    ds_read_b128 v[136:139], v5 offset:2048
    ds_read_b64_tr_b16 v[200:201], v8 offset:4096
    ds_read_b64_tr_b16 v[202:203], v8 offset:4608
    v_mfma_f32_32x32x16_bf16 v[160:175], v[140:143], v[204:207], v[160:175]
    ds_read_b128 v[140:143], v5 offset:3072
    ds_read_b64_tr_b16 v[204:205], v8 offset:6144
    ds_read_b64_tr_b16 v[206:207], v8 offset:6656
    s_waitcnt lgkmcnt(9)
    v_mfma_f32_32x32x16_bf16 v[160:175], v[128:131], v[192:195], v[160:175]
    ds_read_b128 v[128:131], v5 offset:4096
    ds_read_b64_tr_b16 v[192:193], v8 offset:8192
    ds_read_b64_tr_b16 v[194:195], v8 offset:8704
    s_waitcnt lgkmcnt(9)
    v_mfma_f32_32x32x16_bf16 v[160:175], v[132:135], v[196:199], v[160:175]
    ds_read_b128 v[132:135], v5 offset:5120
    ds_read_b64_tr_b16 v[196:197], v8 offset:10240
    ds_read_b64_tr_b16 v[198:199], v8 offset:10752
    s_waitcnt lgkmcnt(9)
    v_mfma_f32_32x32x16_bf16 v[160:175], v[136:139], v[200:203], v[160:175]
    ds_read_b128 v[136:139], v5 offset:6144
    ds_read_b64_tr_b16 v[200:201], v8 offset:12288
    ds_read_b64_tr_b16 v[202:203], v8 offset:12800
    s_waitcnt lgkmcnt(9)
    v_mfma_f32_32x32x16_bf16 v[160:175], v[140:143], v[204:207], v[160:175]
    ds_read_b128 v[140:143], v5 offset:7168
    ds_read_b64_tr_b16 v[204:205], v8 offset:14336
    ds_read_b64_tr_b16 v[206:207], v8 offset:14848
    s_waitcnt lgkmcnt(9)
    v_mfma_f32_32x32x16_bf16 v[160:175], v[128:131], v[192:195], v[160:175]
    s_waitcnt lgkmcnt(0)
    s_barrier
    v_add_u32 v5, 0x0, v26
    v_add_u32 v8, 0x14000, v29
    ds_read_b128 v[128:131], v5 offset:0
    ds_read_b64_tr_b16 v[192:193], v8 offset:0
    ds_read_b64_tr_b16 v[194:195], v8 offset:512
    v_mfma_f32_32x32x16_bf16 v[160:175], v[132:135], v[196:199], v[160:175]
    ds_read_b128 v[132:135], v5 offset:1024
    ds_read_b64_tr_b16 v[196:197], v8 offset:2048
    ds_read_b64_tr_b16 v[198:199], v8 offset:2560
    v_mfma_f32_32x32x16_bf16 v[160:175], v[136:139], v[200:203], v[160:175]
    ds_read_b128 v[136:139], v5 offset:2048
    ds_read_b64_tr_b16 v[200:201], v8 offset:4096
    ds_read_b64_tr_b16 v[202:203], v8 offset:4608
    v_mfma_f32_32x32x16_bf16 v[160:175], v[140:143], v[204:207], v[160:175]
    ds_read_b128 v[140:143], v5 offset:3072
    ds_read_b64_tr_b16 v[204:205], v8 offset:6144
    ds_read_b64_tr_b16 v[206:207], v8 offset:6656
    s_waitcnt lgkmcnt(9)
    v_mfma_f32_32x32x16_bf16 v[160:175], v[128:131], v[192:195], v[160:175]
    ds_read_b128 v[128:131], v5 offset:4096
    ds_read_b64_tr_b16 v[192:193], v8 offset:8192
    ds_read_b64_tr_b16 v[194:195], v8 offset:8704
    s_waitcnt lgkmcnt(9)
    v_mfma_f32_32x32x16_bf16 v[160:175], v[132:135], v[196:199], v[160:175]
    ds_read_b128 v[132:135], v5 offset:5120
    ds_read_b64_tr_b16 v[196:197], v8 offset:10240
    ds_read_b64_tr_b16 v[198:199], v8 offset:10752
    s_waitcnt lgkmcnt(9)
    v_mfma_f32_32x32x16_bf16 v[160:175], v[136:139], v[200:203], v[160:175]
    ds_read_b128 v[136:139], v5 offset:6144
    ds_read_b64_tr_b16 v[200:201], v8 offset:12288
    ds_read_b64_tr_b16 v[202:203], v8 offset:12800
    s_waitcnt lgkmcnt(9)
    v_mfma_f32_32x32x16_bf16 v[160:175], v[140:143], v[204:207], v[160:175]
    ds_read_b128 v[140:143], v5 offset:7168
    ds_read_b64_tr_b16 v[204:205], v8 offset:14336
    ds_read_b64_tr_b16 v[206:207], v8 offset:14848
    s_waitcnt lgkmcnt(9)
    v_mfma_f32_32x32x16_bf16 v[160:175], v[128:131], v[192:195], v[160:175]
    s_waitcnt lgkmcnt(6)
    v_mfma_f32_32x32x16_bf16 v[160:175], v[132:135], v[196:199], v[160:175]
    s_waitcnt lgkmcnt(3)
    v_mfma_f32_32x32x16_bf16 v[160:175], v[136:139], v[200:203], v[160:175]
    s_waitcnt lgkmcnt(0)
    v_mfma_f32_32x32x16_bf16 v[160:175], v[140:143], v[204:207], v[160:175]
    v_add_u32 v112, 0x4000, v112
    v_add_u32 v113, 0x4000, v113
    s_nop 9
    v_mul_f32 v10, 0xbfb8aa3b, v160
    v_mul_f32 v11, 0xbfb8aa3b, v161
    v_mul_f32 v12, 0xbfb8aa3b, v162
    v_mul_f32 v13, 0xbfb8aa3b, v163
    v_exp_f32 v10, v10
    v_exp_f32 v11, v11
    v_exp_f32 v12, v12
    v_exp_f32 v13, v13
    v_mul_f32 v14, v160, v176
    v_mul_f32 v15, v161, v177
    v_mul_f32 v16, v162, v178
    v_mul_f32 v17, v163, v179
    v_add_f32 v10, 1.0, v10
    v_add_f32 v11, 1.0, v11
    v_add_f32 v12, 1.0, v12
    v_add_f32 v13, 1.0, v13
    v_rcp_f32 v10, v10
    v_rcp_f32 v11, v11
    v_rcp_f32 v12, v12
    v_rcp_f32 v13, v13
    v_fma_f32 v14, v14, v10, v208
    v_fma_f32 v15, v15, v11, v209
    v_fma_f32 v16, v16, v12, v210
    v_fma_f32 v17, v17, v13, v211
    ds_write_b32 v112, v14 offset:0
    ds_write_b32 v112, v15 offset:144
    ds_write_b32 v112, v16 offset:288
    ds_write_b32 v112, v17 offset:432
    v_mul_f32 v10, 0xbfb8aa3b, v164
    v_mul_f32 v11, 0xbfb8aa3b, v165
    v_mul_f32 v12, 0xbfb8aa3b, v166
    v_mul_f32 v13, 0xbfb8aa3b, v167
    v_exp_f32 v10, v10
    v_exp_f32 v11, v11
    v_exp_f32 v12, v12
    v_exp_f32 v13, v13
    v_mul_f32 v14, v164, v180
    v_mul_f32 v15, v165, v181
    v_mul_f32 v16, v166, v182
    v_mul_f32 v17, v167, v183
    v_add_f32 v10, 1.0, v10
    v_add_f32 v11, 1.0, v11
    v_add_f32 v12, 1.0, v12
    v_add_f32 v13, 1.0, v13
    v_rcp_f32 v10, v10
    v_rcp_f32 v11, v11
    v_rcp_f32 v12, v12
    v_rcp_f32 v13, v13
    v_fma_f32 v14, v14, v10, v212
    v_fma_f32 v15, v15, v11, v213
    v_fma_f32 v16, v16, v12, v214
    v_fma_f32 v17, v17, v13, v215
    ds_write_b32 v112, v14 offset:576
    ds_write_b32 v112, v15 offset:720
    ds_write_b32 v112, v16 offset:864
    ds_write_b32 v112, v17 offset:1008
    v_mul_f32 v10, 0xbfb8aa3b, v168
    v_mul_f32 v11, 0xbfb8aa3b, v169
    v_mul_f32 v12, 0xbfb8aa3b, v170
    v_mul_f32 v13, 0xbfb8aa3b, v171
    v_exp_f32 v10, v10
    v_exp_f32 v11, v11
    v_exp_f32 v12, v12
    v_exp_f32 v13, v13
    v_mul_f32 v14, v168, v184
    v_mul_f32 v15, v169, v185
    v_mul_f32 v16, v170, v186
    v_mul_f32 v17, v171, v187
    v_add_f32 v10, 1.0, v10
    v_add_f32 v11, 1.0, v11
    v_add_f32 v12, 1.0, v12
    v_add_f32 v13, 1.0, v13
    v_rcp_f32 v10, v10
    v_rcp_f32 v11, v11
    v_rcp_f32 v12, v12
    v_rcp_f32 v13, v13
    v_fma_f32 v14, v14, v10, v216
    v_fma_f32 v15, v15, v11, v217
    v_fma_f32 v16, v16, v12, v218
    v_fma_f32 v17, v17, v13, v219
    ds_write_b32 v112, v14 offset:1152
    ds_write_b32 v112, v15 offset:1296
    ds_write_b32 v112, v16 offset:1440
    ds_write_b32 v112, v17 offset:1584
    v_mul_f32 v10, 0xbfb8aa3b, v172
    v_mul_f32 v11, 0xbfb8aa3b, v173
    v_mul_f32 v12, 0xbfb8aa3b, v174
    v_mul_f32 v13, 0xbfb8aa3b, v175
    v_exp_f32 v10, v10
    v_exp_f32 v11, v11
    v_exp_f32 v12, v12
    v_exp_f32 v13, v13
    v_mul_f32 v14, v172, v188
    v_mul_f32 v15, v173, v189
    v_mul_f32 v16, v174, v190
    v_mul_f32 v17, v175, v191
    v_add_f32 v10, 1.0, v10
    v_add_f32 v11, 1.0, v11
    v_add_f32 v12, 1.0, v12
    v_add_f32 v13, 1.0, v13
    v_rcp_f32 v10, v10
    v_rcp_f32 v11, v11
    v_rcp_f32 v12, v12
    v_rcp_f32 v13, v13
    v_fma_f32 v14, v14, v10, v220
    v_fma_f32 v15, v15, v11, v221
    v_fma_f32 v16, v16, v12, v222
    v_fma_f32 v17, v17, v13, v223
    ds_write_b32 v112, v14 offset:1728
    ds_write_b32 v112, v15 offset:1872
    ds_write_b32 v112, v16 offset:2016
    ds_write_b32 v112, v17 offset:2160
    ds_read_b128 v[128:131], v113 offset:0
    ds_read_b128 v[132:135], v113 offset:1152
    ds_read_b128 v[136:139], v113 offset:2304
    ds_read_b128 v[140:143], v113 offset:3456
    s_mov_b32 s95, 0
    s_waitcnt lgkmcnt(3)
    buffer_store_dwordx4 v[128:131], v31, s[76:79], s95 offen sc0 sc1
    s_mov_b32 s95, 16384
    s_waitcnt lgkmcnt(2)
    buffer_store_dwordx4 v[132:135], v31, s[76:79], s95 offen sc0 sc1
    s_mov_b32 s95, 32768
    s_waitcnt lgkmcnt(1)
    buffer_store_dwordx4 v[136:139], v31, s[76:79], s95 offen sc0 sc1
    s_mov_b32 s95, 49152
    s_waitcnt lgkmcnt(0)
    buffer_store_dwordx4 v[140:143], v31, s[76:79], s95 offen sc0 sc1
    s_waitcnt vmcnt(0)
    s_branch L_end
L_end:
    s_endpgm
.section .rodata,"a"
.p2align 6
.amdhsa_kernel recurrent_scan__ssm_conv_s5__swiglu_ffn__prompt_kernel
  .amdhsa_next_free_vgpr 256
  .amdhsa_next_free_sgpr 102
  .amdhsa_accum_offset 256
  .amdhsa_group_segment_fixed_size 0
  .amdhsa_kernarg_size 128
  .amdhsa_user_sgpr_count 2
  .amdhsa_user_sgpr_kernarg_segment_ptr 1
  .amdhsa_system_sgpr_workgroup_id_x 1
  .amdhsa_float_denorm_mode_32 3
.end_amdhsa_kernel
```
